```python
import torch

def _softmax(x, axis=-1):
    return torch.softmax(x, dim=axis)

def _gelu(x):
    return torch.nn.functional.gelu(x, approximate='tanh')

def _silu(x):
    return torch.nn.functional.silu(x)

def _sigmoid(x):
    return torch.sigmoid(x)

def _layernorm(x, axis=-1, eps=1e-05):
    m = x.mean(dim=axis, keepdim=True)
    v = x.var(dim=axis, keepdim=True, unbiased=False)
    return (x - m) / torch.sqrt(v + eps)

def _scatter_add(tgt, idx, src, axis=0):
    return tgt.clone().index_add_(axis, idx, src)

def _segment_sum(src, seg, n):
    out = torch.zeros((n,) + src.shape[1:], dtype=src.dtype)
    return out.index_add_(0, seg, src)

def _pad(x, pw):
    flat = tuple((v for pair in reversed(pw) for v in pair))
    return torch.nn.functional.pad(x, flat)
kernel_name = 'gated_mix__grouped_kv_mqa__mixer_gmlp__prompt'

def setup_inputs():

    _w = lambda a: (lambda t: t.to(torch.bfloat16) if t.is_floating_point() else t)(torch.as_tensor(a))

    def _A_setup():
        B, S, D, H = (1, 2048, 640, 32)
        Dh = D // H
        return {'x': _w((lambda *s: torch.randn(*s, dtype=torch.bfloat16) * 0.05)(B, S, D)), 'wq': _w((lambda *s: torch.randn(*s, dtype=torch.bfloat16) * 1.6)(D, H * Dh)), 'wk': _w((lambda *s: torch.randn(*s, dtype=torch.bfloat16) * 1.6)(D, Dh)), 'wv': _w((lambda *s: torch.randn(*s, dtype=torch.bfloat16) * 0.2)(D, Dh)), 'wo': _w((lambda *s: torch.randn(*s, dtype=torch.bfloat16) * 0.2)(H * Dh, D))}
    _A_in = _A_setup()

    def _B_setup():
        B, S, D, F = (1, 2048, 640, 1728)
        Fh = F // 2
        return {'x': _w((lambda *s: torch.randn(*s, dtype=torch.bfloat16) * 0.05)(B, S, D)), 'w_in': _w((lambda *s: torch.randn(*s, dtype=torch.bfloat16) * 0.8)(D, 2 * Fh)), 'w_sp': _w(0.01 * (lambda *s: torch.randn(*s, dtype=torch.bfloat16) * 0.8)(S, S)), 'b_sp': _w(1.0 + 0.01 * (lambda *s: torch.randn(*s, dtype=torch.bfloat16) * 0.05)(S)), 'w_out': _w((lambda *s: torch.randn(*s, dtype=torch.bfloat16) * 0.05)(Fh, D))}
    _B_in = _B_setup()
    return {'A_x': _A_in['x'], 'A_wq': _A_in['wq'], 'A_wk': _A_in['wk'], 'A_wv': _A_in['wv'], 'A_wo': _A_in['wo'], 'B_x': _B_in['x'], 'B_w_in': _B_in['w_in'], 'B_w_sp': _B_in['w_sp'], 'B_b_sp': _B_in['b_sp'], 'B_w_out': _B_in['w_out'], 'gate_w': _w((lambda *s: torch.randn(*s, dtype=torch.bfloat16) * 0.05)(640) * 16.0)}

def reference(A_x, A_wq, A_wk, A_wv, A_wo, B_x, B_w_in, B_w_sp, B_b_sp, B_w_out, gate_w):

    def _A_ref(x, wq, wk, wv, wo):
        B, S, D = x.shape
        H = 32
        Dh = D // H
        q = (lambda x, *d: x.permute(*d))((x @ wq).reshape(B, S, H, Dh), 0, 2, 1, 3)
        k = x @ wk
        v = x @ wv
        scores = torch.einsum('bhqd,bkd->bhqk', q, k) * Dh ** (-0.5)
        p = _softmax(scores, axis=-1)
        o = torch.einsum('bhqk,bkd->bhqd', p, v)
        return (lambda x, *d: x.permute(*d))(o, 0, 2, 1, 3).reshape(B, S, H * Dh) @ wo

    def _B_ref(x, w_in, w_sp, b_sp, w_out):
        B, S, D = x.shape
        F = w_in.shape[-1]
        Fh = F // 2
        z = _gelu(torch.einsum('bsd,df->bsf', x, w_in))
        z1 = z[..., :Fh].clone()
        z2 = _layernorm(z[..., Fh:], axis=-1)
        g = torch.einsum('ts,bsf->btf', w_sp, z2) + b_sp[None, :, None]
        return torch.einsum('bsf,fd->bsd', z1 * g, w_out)
    x = A_x
    g = _sigmoid((x * gate_w).sum(-1, keepdims=True))
    a = _A_ref(x, A_wq, A_wk, A_wv, A_wo)
    b = _B_ref(x, B_w_in, B_w_sp, B_b_sp, B_w_out)
    return g * a + (1 - g) * b
```

```asm
; @launch grid=(256,1,1) block=(256,1,1) lds=163840
.amdgcn_target "amdgcn-amd-amdhsa--gfx950"
.text
.globl gated_mix__grouped_kv_mqa__mixer_gmlp__prompt_kernel
.p2align 8
.type gated_mix__grouped_kv_mqa__mixer_gmlp__prompt_kernel,@function
gated_mix__grouped_kv_mqa__mixer_gmlp__prompt_kernel:
    s_cmp_ge_u32 s2, 256
    s_cbranch_scc1 M_end
    s_load_dwordx2 s[24:25], s[0:1], 0
    s_load_dwordx2 s[18:19], s[0:1], 8
    s_load_dwordx4 s[20:23], s[0:1], 16
    s_load_dwordx2 s[28:29], s[0:1], 48
    s_load_dwordx2 s[48:49], s[0:1], 80
    s_load_dwordx2 s[44:45], s[0:1], 96
    s_load_dwordx2 s[40:41], s[0:1], 104
    s_load_dwordx2 s[70:71], s[0:1], 32
    s_load_dwordx4 s[72:75], s[0:1], 56
    s_load_dwordx2 s[76:77], s[0:1], 72
    s_load_dwordx2 s[78:79], s[0:1], 88
    v_and_b32 v1, 63, v0
    v_lshrrev_b32 v19, 6, v0
    s_getpc_b64 s[6:7]
PF0:
    s_lshl_b32 s63, s2, 12
    s_and_b32 s63, s63, 0x8000
    v_lshlrev_b32 v252, 7, v0
    v_add_u32 v252, s63, v252
    v_min_u32 v252, CODE_END-PF0-4, v252
    global_load_dword v253, v252, s[6:7]
    v_readfirstlane_b32 s3, v19
    s_and_b32 s63, s2, 7
    s_lshr_b32 s64, s2, 3
    s_and_b32 s4, s63, 1
    s_lshl_b32 s4, s4, 3
    s_and_b32 s65, s64, 7
    s_add_u32 s4, s4, s65
    s_lshr_b32 s67, s64, 3
    s_lshl_b32 s62, s4, 2
    s_add_u32 s62, s62, s3
    s_mul_i32 s68, s67, 5
    s_add_u32 s68, s68, 1
    s_lshr_b32 s68, s68, 1
    s_add_u32 s68, s68, s65
    s_lshr_b32 s5, s63, 1
    s_lshl_b32 s5, s5, 2
    s_add_u32 s5, s5, s67
    s_sub_u32 s64, s68, 10
    s_cmp_ge_u32 s68, 10
    s_cselect_b32 s68, s64, s68
    s_lshl_b32 s8, s68, 7
    s_add_u32 s68, s68, 1
    s_sub_u32 s64, s68, 10
    s_cmp_ge_u32 s68, 10
    s_cselect_b32 s68, s64, s68
    s_lshl_b32 s9, s68, 7
    s_add_u32 s68, s68, 1
    s_mul_i32 s63, s62, 40960
    v_lshrrev_b32 v19, 3, v1
    v_mul_u32_u24 v22, 1280, v19
    v_add_u32 v22, s63, v22
    v_and_b32 v20, 7, v1
    v_lshrrev_b32 v21, 4, v1
    v_xor_b32 v23, v20, v21
    v_lshlrev_b32 v23, 4, v23
    v_add_u32 v6, v22, v23
    v_xor_b32 v23, 64, v23
    v_add_u32 v7, v22, v23
    v_add_u32 v7, 10240, v7
    v_add_u32 v8, 20480, v6
    v_add_u32 v9, 20480, v7
    s_lshl_b32 s58, s3, 12
    s_add_u32 s58, s58, 98304
    s_mov_b32 s26, 2621440
    s_mov_b32 s27, 0x00020000
    s_waitcnt lgkmcnt(0)
    s_add_u32 m0, s58, 0
    s_nop 0
    buffer_load_dwordx4 v6, s[24:27], s8 offen lds
    s_add_u32 m0, s58, 1024
    s_nop 0
    buffer_load_dwordx4 v7, s[24:27], s8 offen lds
    s_add_u32 m0, s58, 2048
    s_nop 0
    buffer_load_dwordx4 v8, s[24:27], s8 offen lds
    s_add_u32 m0, s58, 3072
    s_nop 0
    buffer_load_dwordx4 v9, s[24:27], s8 offen lds
    s_add_u32 m0, s58, 16384
    s_nop 0
    buffer_load_dwordx4 v6, s[24:27], s9 offen lds
    s_add_u32 m0, s58, 17408
    s_nop 0
    buffer_load_dwordx4 v7, s[24:27], s9 offen lds
    s_add_u32 m0, s58, 18432
    s_nop 0
    buffer_load_dwordx4 v8, s[24:27], s9 offen lds
    s_add_u32 m0, s58, 19456
    s_nop 0
    buffer_load_dwordx4 v9, s[24:27], s9 offen lds
    v_lshrrev_b32 v2, 5, v1
    s_lshl_b32 s60, s3, 11
    s_lshl_b32 s63, s5, 1
    s_add_u32 s52, s63, 26
    s_sub_u32 s64, s63, 28
    s_cmp_ge_u32 s5, 14
    s_cselect_b32 s52, s64, s52
    s_cselect_b32 s56, 0, 1.0
    s_cmp_ge_u32 s52, 27
    s_cselect_b32 s55, 1.0, 0
    s_mov_b32 s66, 0
    s_movk_i32 s61, 1280
    s_sub_u32 s54, s63, 2
    s_mov_b64 s[32:33], s[18:19]
    s_mov_b64 s[36:37], s[18:19]
    s_cmp_eq_u32 s5, 11
    s_cselect_b32 s66, 1, s66
    s_cselect_b32 s61, 40, s61
    s_cselect_b64 s[32:33], s[20:21], s[32:33]
    s_cselect_b64 s[36:37], s[22:23], s[36:37]
    s_cmp_ge_u32 s5, 12
    s_cselect_b32 s66, 3, s66
    s_sub_u32 s63, s54, 6
    s_cmp_eq_u32 s5, 0
    s_cselect_b32 s63, 24, s63
    s_cmp_eq_u32 s55, 0
    s_cselect_b32 s66, 2, s66
    s_cselect_b32 s54, s63, s54
    s_cselect_b32 s61, 3456, s61
    s_cselect_b64 s[32:33], s[28:29], s[32:33]
    s_cselect_b64 s[36:37], s[28:29], s[36:37]
    s_lshr_b32 s57, s61, 1
    s_mul_i32 s34, s61, 640
    s_cmp_eq_u32 s66, 3
    s_cselect_b32 s34, 0, s34
    s_mov_b32 s38, s34
    s_mov_b32 s35, 0x00020000
    s_mov_b32 s39, 0x00020000
    s_lshl_b32 s63, s3, 4
    v_add_u32 v24, s63, v19
    v_and_b32 v21, 1, v21
    v_lshlrev_b32 v21, 2, v21
    v_xor_b32 v25, v20, v21
    v_lshlrev_b32 v25, 4, v25
    v_bfe_u32 v26, v1, 4, 1
    v_lshlrev_b32 v26, 3, v26
    v_lshl_add_u32 v26, v2, 2, v26
    v_bfe_u32 v27, v1, 2, 2
    v_add3_u32 v26, v26, v27, s63
    v_and_b32 v27, 3, v1
    v_lshlrev_b32 v27, 4, v27
    s_lshl_b32 s64, s54, 6
    s_lshl_b32 s63, s61, 3
    v_mul_u32_u24 v14, s61, v24
    v_add3_u32 v14, v14, v25, s64
    v_add_u32 v15, s63, v14
    s_cmp_lg_u32 s66, 1
    s_cbranch_scc1 M_notkv
    v_mul_u32_u24 v14, 40, v26
    v_add_u32 v14, v14, v27
    v_mov_b32 v15, v14
M_notkv:
    s_add_u32 m0, s60, 0
    s_mul_i32 s67, s8, s57
    buffer_load_dwordx4 v14, s[32:35], s67 offen lds
    s_add_u32 m0, s60, 1024
    s_nop 0
    buffer_load_dwordx4 v15, s[36:39], s67 offen lds
    s_add_u32 m0, s60, 8192
    s_mul_i32 s67, s9, s57
    buffer_load_dwordx4 v14, s[32:35], s67 offen lds
    s_add_u32 m0, s60, 9216
    s_nop 0
    buffer_load_dwordx4 v15, s[36:39], s67 offen lds
    v_and_b32 v3, 31, v1
    v_lshlrev_b32 v4, 4, v1
    v_lshlrev_b32 v5, 3, v1
    v_mov_b32 v83, 0
    s_lshl_b32 s59, s3, 10
    s_add_u32 s53, s5, 4
    s_mov_b32 s42, 20971520
    s_mov_b32 s43, 0x00020000
    s_mov_b32 s30, 2211840
    s_mov_b32 s31, 0x00020000
    s_mov_b32 s46, 256
    s_mov_b32 s47, 0x00020000
    s_mov_b32 s50, 1280
    s_mov_b32 s51, 0x00020000
    s_lshl_b32 s64, s52, 6
    v_mul_u32_u24 v236, 3456, v24
    v_add3_u32 v236, v236, v25, s64
    v_add_u32 v237, 27648, v236
    s_lshl_b32 s64, s53, 6
    v_mul_u32_u24 v238, 3456, v26
    v_add3_u32 v238, v238, v27, s64
    s_sub_u32 s64, s68, 10
    s_cmp_ge_u32 s68, 10
    s_cselect_b32 s68, s64, s68
    s_lshl_b32 s10, s68, 7
    s_add_u32 s68, s68, 1
    s_sub_u32 s64, s68, 10
    s_cmp_ge_u32 s68, 10
    s_cselect_b32 s68, s64, s68
    s_lshl_b32 s11, s68, 7
    s_add_u32 s68, s68, 1
    s_sub_u32 s64, s68, 10
    s_cmp_ge_u32 s68, 10
    s_cselect_b32 s68, s64, s68
    s_lshl_b32 s12, s68, 7
    s_add_u32 s68, s68, 1
    s_sub_u32 s64, s68, 10
    s_cmp_ge_u32 s68, 10
    s_cselect_b32 s68, s64, s68
    s_lshl_b32 s13, s68, 7
    s_add_u32 s68, s68, 1
    s_sub_u32 s64, s68, 10
    s_cmp_ge_u32 s68, 10
    s_cselect_b32 s68, s64, s68
    s_lshl_b32 s14, s68, 7
    s_add_u32 s68, s68, 1
    s_sub_u32 s64, s68, 10
    s_cmp_ge_u32 s68, 10
    s_cselect_b32 s68, s64, s68
    s_lshl_b32 s15, s68, 7
    s_add_u32 s68, s68, 1
    s_sub_u32 s64, s68, 10
    s_cmp_ge_u32 s68, 10
    s_cselect_b32 s68, s64, s68
    s_lshl_b32 s16, s68, 7
    s_add_u32 s68, s68, 1
    s_sub_u32 s64, s68, 10
    s_cmp_ge_u32 s68, 10
    s_cselect_b32 s68, s64, s68
    s_lshl_b32 s17, s68, 7
    s_or_b32 s63, s2, s3
    s_cmp_lg_u32 s63, 0
    s_cbranch_scc1 M_noepoch
    s_mov_b32 s63, 2827264
    buffer_load_dword v28, v83, s[40:43], s63 offen sc1
M_noepoch:
    s_add_u32 m0, s60, 49152
    s_mul_i32 s67, s8, 1728
    buffer_load_dwordx4 v236, s[28:31], s67 offen lds
    s_add_u32 m0, s60, 50176
    s_nop 0
    buffer_load_dwordx4 v237, s[28:31], s67 offen lds
    s_lshl_b32 s63, s2, 3
    s_lshl_b32 s64, s3, 1
    s_add_u32 s63, s63, s64
    v_add_u32 v22, s63, v2
    v_lshlrev_b32 v23, 3, v3
    v_mul_u32_u24 v30, 1280, v22
    v_add_u32 v30, v30, v23
    v_lshlrev_b32 v82, 3, v22
    v_mov_b32 v31, v23
    s_add_u32 m0, s60, 57344
    s_mul_i32 s67, s9, 1728
    buffer_load_dwordx4 v236, s[28:31], s67 offen lds
    s_add_u32 m0, s60, 58368
    s_nop 0
    buffer_load_dwordx4 v237, s[28:31], s67 offen lds
    s_add_u32 m0, s59, 81920
    s_mul_i32 s67, s8, 1728
    buffer_load_dwordx4 v238, s[28:31], s67 offen lds
    s_add_u32 m0, s58, 32768
    s_nop 0
    buffer_load_dwordx4 v6, s[24:27], s10 offen lds
    s_add_u32 m0, s58, 33792
    s_nop 0
    buffer_load_dwordx4 v7, s[24:27], s10 offen lds
    s_add_u32 m0, s58, 34816
    s_nop 0
    buffer_load_dwordx4 v8, s[24:27], s10 offen lds
    s_add_u32 m0, s58, 35840
    s_nop 0
    buffer_load_dwordx4 v9, s[24:27], s10 offen lds
    s_add_u32 m0, s60, 16384
    s_mul_i32 s67, s10, s57
    buffer_load_dwordx4 v14, s[32:35], s67 offen lds
    s_add_u32 m0, s60, 17408
    s_nop 0
    buffer_load_dwordx4 v15, s[36:39], s67 offen lds
    v_bfe_u32 v19, v1, 4, 1
    v_lshlrev_b32 v19, 5, v19
    v_and_b32 v20, 3, v1
    v_lshl_add_u32 v19, v20, 3, v19
    v_bfe_u32 v20, v1, 2, 2
    v_lshl_add_u32 v21, v2, 3, v20
    v_lshl_add_u32 v21, v21, 7, v19
    v_bfe_u32 v24, v1, 3, 1
    v_lshl_add_u32 v72, v24, 6, v21
    v_xor_b32 v73, 64, v72
    v_lshl_add_u32 v21, v2, 2, v20
    v_lshl_add_u32 v78, v21, 6, v19
    v_add_u32 v79, 65536, v78
    v_add_u32 v74, 65536, v72
    v_add_u32 v75, 65536, v73
    v_add_u32 v80, 131072, v78
    v_add_u32 v76, 131072, v72
    v_add_u32 v77, 131072, v73
    v_mov_b32 v70, v72
    v_mov_b32 v71, v73
    s_cmp_lg_u32 s66, 1
    s_cbranch_scc1 M_notkv2
    v_mov_b32 v70, v78
    v_add_u32 v71, 1024, v78
M_notkv2:
    v_lshrrev_b32 v19, 1, v3
    v_and_b32 v19, 7, v19
    v_lshlrev_b32 v20, 7, v3
    v_add_u32 v20, s58, v20
    v_add_u32 v21, 0, v2
    v_xor_b32 v21, v21, v19
    v_lshl_add_u32 v10, v21, 4, v20
    v_add_u32 v21, 2, v2
    v_xor_b32 v21, v21, v19
    v_lshl_add_u32 v11, v21, 4, v20
    v_add_u32 v21, 4, v2
    v_xor_b32 v21, v21, v19
    v_lshl_add_u32 v12, v21, 4, v20
    v_add_u32 v21, 6, v2
    v_xor_b32 v21, v21, v19
    v_lshl_add_u32 v13, v21, 4, v20
    v_mov_b32 v60, 0xc0135761
    v_mov_b32 v61, 0xc0135761
    v_mov_b32 v62, 0xbdd2d3e8
    v_mov_b32 v63, 0xbdd2d3e8
    v_mov_b32 v64, 1.0
    v_mov_b32 v65, 1.0
    v_mov_b32 v66, 0x3ea52b5c
    v_mov_b32 v67, 0x3ea52b5c
    s_lshl_b32 s64, s2, 2
    s_add_u32 s64, s64, s3
    s_and_b32 s64, s64, 511
    s_lshl_b32 s64, s64, 7
    s_add_u32 s64, s64, 0x2B0000
    buffer_load_dword v253, v83, s[40:43], s64 offen sc1
    s_lshl_b32 s67, s3, 8
    s_add_u32 s67, s67, s2
    s_lshr_b32 s68, s67, 3
    s_and_b32 s67, s67, 7
    s_movk_i32 s6, 20
    s_movk_i32 s7, 8
    s_movk_i32 s65, 4
    s_mul_i32 s100, s68, 40
    s_mul_i32 s63, s68, 160
    s_sub_u32 s63, s63, 2544
    s_cmp_ge_u32 s68, 16
    s_cselect_b32 s6, 80, s6
    s_cselect_b32 s7, 20, s7
    s_cselect_b32 s65, 40, s65
    s_cselect_b32 s100, s63, s100
    s_lshl_b32 s63, s68, 5
    s_sub_u32 s63, s63, 640
    s_cmp_ge_u32 s68, 20
    s_cselect_b32 s6, 16, s6
    s_cselect_b32 s7, 8, s7
    s_cselect_b32 s65, 4, s65
    s_cselect_b32 s100, s63, s100
    s_mul_i32 s100, s100, 1280
    s_mul_i32 s63, s67, 160
    s_add_u32 s100, s100, s63
    v_add_u32 v16, 0, v1
    v_mul_u32_u24 v17, 6554, v16
    v_lshrrev_b32 v17, 16, v17
    v_mul_u32_u24 v18, 10, v17
    v_sub_u32 v16, v16, v18
    v_and_b32 v18, 3, v17
    v_bfe_u32 v19, v17, 3, 1
    v_mad_u32_u24 v18, v19, s6, v18
    v_lshrrev_b32 v19, 4, v17
    v_mad_u32_u24 v18, v19, s7, v18
    v_bfe_u32 v19, v17, 2, 1
    v_mad_u32_u24 v18, v19, s65, v18
    v_mul_u32_u24 v18, 1280, v18
    v_lshl_add_u32 v18, v16, 4, v18
    v_accvgpr_write_b32 a160, v18
    v_add_u32 v16, 64, v1
    v_mul_u32_u24 v17, 6554, v16
    v_lshrrev_b32 v17, 16, v17
    v_mul_u32_u24 v18, 10, v17
    v_sub_u32 v16, v16, v18
    v_and_b32 v18, 3, v17
    v_bfe_u32 v19, v17, 3, 1
    v_mad_u32_u24 v18, v19, s6, v18
    v_lshrrev_b32 v19, 4, v17
    v_mad_u32_u24 v18, v19, s7, v18
    v_bfe_u32 v19, v17, 2, 1
    v_mad_u32_u24 v18, v19, s65, v18
    v_mul_u32_u24 v18, 1280, v18
    v_lshl_add_u32 v18, v16, 4, v18
    v_accvgpr_write_b32 a161, v18
    v_add_u32 v16, 128, v1
    v_mul_u32_u24 v17, 6554, v16
    v_lshrrev_b32 v17, 16, v17
    v_mul_u32_u24 v18, 10, v17
    v_sub_u32 v16, v16, v18
    v_and_b32 v18, 3, v17
    v_bfe_u32 v19, v17, 3, 1
    v_mad_u32_u24 v18, v19, s6, v18
    v_lshrrev_b32 v19, 4, v17
    v_mad_u32_u24 v18, v19, s7, v18
    v_bfe_u32 v19, v17, 2, 1
    v_mad_u32_u24 v18, v19, s65, v18
    v_mul_u32_u24 v18, 1280, v18
    v_lshl_add_u32 v18, v16, 4, v18
    v_accvgpr_write_b32 a162, v18
    v_add_u32 v16, 192, v1
    v_mul_u32_u24 v17, 6554, v16
    v_lshrrev_b32 v17, 16, v17
    v_mul_u32_u24 v18, 10, v17
    v_sub_u32 v16, v16, v18
    v_and_b32 v18, 3, v17
    v_bfe_u32 v19, v17, 3, 1
    v_mad_u32_u24 v18, v19, s6, v18
    v_lshrrev_b32 v19, 4, v17
    v_mad_u32_u24 v18, v19, s7, v18
    v_bfe_u32 v19, v17, 2, 1
    v_mad_u32_u24 v18, v19, s65, v18
    v_mul_u32_u24 v18, 1280, v18
    v_lshl_add_u32 v18, v16, 4, v18
    v_accvgpr_write_b32 a163, v18
    v_add_u32 v16, 256, v1
    v_mul_u32_u24 v17, 6554, v16
    v_lshrrev_b32 v17, 16, v17
    v_mul_u32_u24 v18, 10, v17
    v_sub_u32 v16, v16, v18
    v_and_b32 v18, 3, v17
    v_bfe_u32 v19, v17, 3, 1
    v_mad_u32_u24 v18, v19, s6, v18
    v_lshrrev_b32 v19, 4, v17
    v_mad_u32_u24 v18, v19, s7, v18
    v_bfe_u32 v19, v17, 2, 1
    v_mad_u32_u24 v18, v19, s65, v18
    v_mul_u32_u24 v18, 1280, v18
    v_lshl_add_u32 v18, v16, 4, v18
    v_accvgpr_write_b32 a164, v18
    s_mul_i32 s65, s3, 5120
    s_add_u32 s65, s65, 122880
    v_lshrrev_b32 v16, 2, v1
    v_mul_u32_u24 v16, 160, v16
    v_and_b32 v17, 3, v1
    v_lshl_add_u32 v16, v17, 3, v16
    v_add_u32 v16, s65, v16
    v_accvgpr_write_b32 a165, v16
    s_mul_i32 s101, s67, 47
    s_add_u32 s101, s101, s68
    s_mul_i32 s101, s101, 5120
    s_add_u32 s101, s101, 17825792
    s_lshl_b32 s61, s67, 8
    s_lshl_b32 s64, s68, 2
    s_add_u32 s61, s61, s64
    s_add_u32 s61, s61, 2867200
    s_cmp_ge_u32 s68, 47
    s_cselect_b32 s101, 0x40000000, s101
    s_cselect_b32 s61, 0x40000000, s61
    s_waitcnt vmcnt(10)
    s_barrier
    ds_read_b128 a[0:3], v10 offset:0
    ds_read_b64_tr_b16 v[32:33], v70 offset:0
    ds_read_b64_tr_b16 v[34:35], v70 offset:512
    ds_read_b64_tr_b16 v[36:37], v71 offset:0
    ds_read_b64_tr_b16 v[38:39], v71 offset:512
    ds_read_b128 a[4:7], v11 offset:0
    ds_read_b64_tr_b16 v[40:41], v70 offset:2048
    ds_read_b64_tr_b16 v[42:43], v70 offset:2560
    ds_read_b64_tr_b16 v[44:45], v71 offset:2048
    ds_read_b64_tr_b16 v[46:47], v71 offset:2560
    ds_read_b128 a[8:11], v12 offset:0
    ds_read_b64_tr_b16 v[48:49], v70 offset:4096
    ds_read_b64_tr_b16 v[50:51], v70 offset:4608
    ds_read_b64_tr_b16 v[52:53], v71 offset:4096
    ds_read_b64_tr_b16 v[54:55], v71 offset:4608
    s_waitcnt lgkmcnt(10)
    v_mfma_f32_32x32x16_bf16 v[136:151], v[32:35], a[0:3], 0
    s_add_u32 m0, s58, 49152
    ds_read_b128 a[12:15], v13 offset:0
    ds_read_b64_tr_b16 v[56:57], v70 offset:6144
    ds_read_b64_tr_b16 v[58:59], v70 offset:6656
    buffer_load_dwordx4 v6, s[24:27], s11 offen lds
    s_add_u32 m0, s58, 50176
    s_nop 0
    buffer_load_dwordx4 v7, s[24:27], s11 offen lds
    s_or_b32 s63, s2, s3
    s_cmp_lg_u32 s63, 0
    s_cbranch_scc1 M_noepoch2
    v_add_u32 v28, 1, v28
    v_mov_b32 v29, 1
    s_mov_b32 s63, 2827264
    s_mov_b64 exec, 1
    buffer_store_dwordx2 v[28:29], v83, s[44:47], 0 offen sc1
    buffer_store_dword v28, v83, s[40:43], s63 offen sc1
    s_mov_b64 exec, -1
M_noepoch2:
    v_mfma_f32_32x32x16_bf16 v[152:167], v[36:39], a[0:3], 0
    s_add_u32 m0, s58, 51200
    ds_read_b64_tr_b16 v[32:33], v71 offset:6144
    ds_read_b64_tr_b16 v[34:35], v71 offset:6656
    buffer_load_dwordx4 v8, s[24:27], s11 offen lds
    s_add_u32 m0, s58, 52224
    s_nop 0
    buffer_load_dwordx4 v9, s[24:27], s11 offen lds
    s_waitcnt lgkmcnt(10)
    v_mfma_f32_32x32x16_bf16 v[136:151], v[40:43], a[4:7], v[136:151]
    s_add_u32 m0, s60, 24576
    s_mul_i32 s67, s11, s57
    ds_read_b64_tr_b16 v[36:37], v72 offset:49152
    ds_read_b64_tr_b16 v[38:39], v72 offset:49664
    buffer_load_dwordx4 v14, s[32:35], s67 offen lds
    v_mfma_f32_32x32x16_bf16 v[152:167], v[44:47], a[4:7], v[152:167]
    s_add_u32 m0, s60, 25600
    ds_read_b64_tr_b16 v[40:41], v73 offset:49152
    ds_read_b64_tr_b16 v[42:43], v73 offset:49664
    buffer_load_dwordx4 v15, s[36:39], s67 offen lds
    s_waitcnt lgkmcnt(9)
    v_mfma_f32_32x32x16_bf16 v[136:151], v[48:51], a[8:11], v[136:151]
    s_add_u32 m0, s60, 65536
    s_mul_i32 s67, s10, 1728
    ds_read_b64_tr_b16 v[44:45], v72 offset:51200
    ds_read_b64_tr_b16 v[46:47], v72 offset:51712
    buffer_load_dwordx4 v236, s[28:31], s67 offen lds
    v_mfma_f32_32x32x16_bf16 v[152:167], v[52:55], a[8:11], v[152:167]
    s_add_u32 m0, s60, 66560
    ds_read_b64_tr_b16 v[48:49], v73 offset:51200
    ds_read_b64_tr_b16 v[50:51], v73 offset:51712
    buffer_load_dwordx4 v237, s[28:31], s67 offen lds
    s_waitcnt lgkmcnt(8)
    v_mfma_f32_32x32x16_bf16 v[136:151], v[56:59], a[12:15], v[136:151]
    s_add_u32 m0, s59, 86016
    s_mul_i32 s67, s9, 1728
    ds_read_b64_tr_b16 v[52:53], v72 offset:53248
    ds_read_b64_tr_b16 v[54:55], v72 offset:53760
    buffer_load_dwordx4 v238, s[28:31], s67 offen lds
    buffer_load_dwordx2 v[168:169], v30, s[24:27], 0 offen offset:0
    buffer_load_dwordx2 v[178:179], v31, s[48:51], 0 offen offset:0
    v_mfma_f32_32x32x16_bf16 v[152:167], v[32:35], a[12:15], v[152:167]
    buffer_load_dwordx2 v[170:171], v30, s[24:27], 0 offen offset:256
    ds_read_b64_tr_b16 v[56:57], v73 offset:53248
    ds_read_b64_tr_b16 v[58:59], v73 offset:53760
    buffer_load_dwordx2 v[180:181], v31, s[48:51], 0 offen offset:256
    buffer_load_dwordx2 v[172:173], v30, s[24:27], 0 offen offset:512
    buffer_load_dwordx2 v[182:183], v31, s[48:51], 0 offen offset:512
    s_waitcnt lgkmcnt(8)
    v_mfma_f32_32x32x16_bf16 v[104:119], v[36:39], a[0:3], 0
    buffer_load_dwordx2 v[174:175], v30, s[24:27], 0 offen offset:768
    ds_read_b64_tr_b16 v[32:33], v72 offset:55296
    ds_read_b64_tr_b16 v[34:35], v72 offset:55808
    buffer_load_dwordx2 v[184:185], v31, s[48:51], 0 offen offset:768
    buffer_load_dwordx2 v[176:177], v30, s[24:27], 0 offen offset:1024
    buffer_load_dwordx2 v[186:187], v31, s[48:51], 0 offen offset:1024
    v_mfma_f32_32x32x16_bf16 v[120:135], v[40:43], a[0:3], 0
    s_add_u32 m0, s60, 32768
    s_mul_i32 s67, s12, s57
    ds_read_b64_tr_b16 v[36:37], v73 offset:55296
    ds_read_b64_tr_b16 v[38:39], v73 offset:55808
    buffer_load_dwordx4 v14, s[32:35], s67 offen lds
    s_waitcnt lgkmcnt(8)
    v_mfma_f32_32x32x16_bf16 v[104:119], v[44:47], a[4:7], v[104:119]
    s_add_u32 m0, s60, 33792
    s_waitcnt vmcnt(28)
    s_barrier
    ds_read_b128 a[16:19], v10 offset:16384
    ds_read_b64_tr_b16 v[40:41], v70 offset:8192
    ds_read_b64_tr_b16 v[42:43], v70 offset:8704
    buffer_load_dwordx4 v15, s[36:39], s67 offen lds
    v_mfma_f32_32x32x16_bf16 v[120:135], v[48:51], a[4:7], v[120:135]
    s_add_u32 m0, s60, 73728
    s_mul_i32 s67, s11, 1728
    ds_read_b64_tr_b16 v[44:45], v71 offset:8192
    ds_read_b64_tr_b16 v[46:47], v71 offset:8704
    buffer_load_dwordx4 v236, s[28:31], s67 offen lds
    s_waitcnt lgkmcnt(9)
    v_mfma_f32_32x32x16_bf16 v[104:119], v[52:55], a[8:11], v[104:119]
    s_add_u32 m0, s60, 74752
    ds_read_b128 a[20:23], v11 offset:16384
    ds_read_b64_tr_b16 v[48:49], v70 offset:10240
    ds_read_b64_tr_b16 v[50:51], v70 offset:10752
    buffer_load_dwordx4 v237, s[28:31], s67 offen lds
    v_mfma_f32_32x32x16_bf16 v[120:135], v[56:59], a[8:11], v[120:135]
    s_add_u32 m0, s60, 40960
    s_mul_i32 s67, s13, s57
    ds_read_b64_tr_b16 v[52:53], v71 offset:10240
    ds_read_b64_tr_b16 v[54:55], v71 offset:10752
    buffer_load_dwordx4 v14, s[32:35], s67 offen lds
    s_waitcnt lgkmcnt(10)
    v_mfma_f32_32x32x16_bf16 v[104:119], v[32:35], a[12:15], v[104:119]
    s_add_u32 m0, s60, 41984
    ds_read_b128 a[24:27], v12 offset:16384
    ds_read_b64_tr_b16 v[56:57], v70 offset:12288
    ds_read_b64_tr_b16 v[58:59], v70 offset:12800
    buffer_load_dwordx4 v15, s[36:39], s67 offen lds
    v_mfma_f32_32x32x16_bf16 v[120:135], v[36:39], a[12:15], v[120:135]
    s_add_u32 m0, s59, 90112
    s_mul_i32 s67, s10, 1728
    ds_read_b64_tr_b16 v[32:33], v71 offset:12288
    ds_read_b64_tr_b16 v[34:35], v71 offset:12800
    buffer_load_dwordx4 v238, s[28:31], s67 offen lds
    s_waitcnt lgkmcnt(10)
    v_mfma_f32_32x32x16_bf16 v[136:151], v[40:43], a[16:19], v[136:151]
    s_add_u32 m0, s59, 94208
    s_mul_i32 s67, s11, 1728
    ds_read_b128 a[28:31], v13 offset:16384
    ds_read_b64_tr_b16 v[36:37], v70 offset:14336
    ds_read_b64_tr_b16 v[38:39], v70 offset:14848
    buffer_load_dwordx4 v238, s[28:31], s67 offen lds
    v_mfma_f32_32x32x16_bf16 v[152:167], v[44:47], a[16:19], v[152:167]
    s_add_u32 m0, s58, 0
    ds_read_b64_tr_b16 v[40:41], v71 offset:14336
    ds_read_b64_tr_b16 v[42:43], v71 offset:14848
    buffer_load_dwordx4 v6, s[24:27], s12 offen lds
    s_waitcnt lgkmcnt(10)
    v_mfma_f32_32x32x16_bf16 v[136:151], v[48:51], a[20:23], v[136:151]
    s_add_u32 m0, s58, 1024
    ds_read_b64_tr_b16 v[44:45], v72 offset:57344
    ds_read_b64_tr_b16 v[46:47], v72 offset:57856
    buffer_load_dwordx4 v7, s[24:27], s12 offen lds
    v_mfma_f32_32x32x16_bf16 v[152:167], v[52:55], a[20:23], v[152:167]
    s_add_u32 m0, s58, 2048
    ds_read_b64_tr_b16 v[48:49], v73 offset:57344
    ds_read_b64_tr_b16 v[50:51], v73 offset:57856
    buffer_load_dwordx4 v8, s[24:27], s12 offen lds
    s_waitcnt lgkmcnt(9)
    v_mfma_f32_32x32x16_bf16 v[136:151], v[56:59], a[24:27], v[136:151]
    s_add_u32 m0, s58, 3072
    ds_read_b64_tr_b16 v[52:53], v72 offset:59392
    ds_read_b64_tr_b16 v[54:55], v72 offset:59904
    buffer_load_dwordx4 v9, s[24:27], s12 offen lds
    v_mfma_f32_32x32x16_bf16 v[152:167], v[32:35], a[24:27], v[152:167]
    ds_read_b64_tr_b16 v[56:57], v73 offset:59392
    ds_read_b64_tr_b16 v[58:59], v73 offset:59904
    s_waitcnt lgkmcnt(8)
    v_mfma_f32_32x32x16_bf16 v[136:151], v[36:39], a[28:31], v[136:151]
    ds_read_b64_tr_b16 v[32:33], v72 offset:61440
    ds_read_b64_tr_b16 v[34:35], v72 offset:61952
    v_mfma_f32_32x32x16_bf16 v[152:167], v[40:43], a[28:31], v[152:167]
    s_add_u32 m0, s58, 16384
    ds_read_b64_tr_b16 v[36:37], v73 offset:61440
    ds_read_b64_tr_b16 v[38:39], v73 offset:61952
    buffer_load_dwordx4 v6, s[24:27], s13 offen lds
    s_waitcnt lgkmcnt(8)
    v_mfma_f32_32x32x16_bf16 v[104:119], v[44:47], a[16:19], v[104:119]
    s_add_u32 m0, s58, 17408
    ds_read_b64_tr_b16 v[40:41], v72 offset:63488
    ds_read_b64_tr_b16 v[42:43], v72 offset:64000
    buffer_load_dwordx4 v7, s[24:27], s13 offen lds
    v_mfma_f32_32x32x16_bf16 v[120:135], v[48:51], a[16:19], v[120:135]
    s_add_u32 m0, s58, 18432
    ds_read_b64_tr_b16 v[44:45], v73 offset:63488
    ds_read_b64_tr_b16 v[46:47], v73 offset:64000
    buffer_load_dwordx4 v8, s[24:27], s13 offen lds
    s_waitcnt lgkmcnt(8)
    v_mfma_f32_32x32x16_bf16 v[104:119], v[52:55], a[20:23], v[104:119]
    s_add_u32 m0, s58, 19456
    s_waitcnt vmcnt(35)
    s_barrier
    ds_read_b128 a[32:35], v10 offset:32768
    ds_read_b64_tr_b16 v[48:49], v70 offset:16384
    ds_read_b64_tr_b16 v[50:51], v70 offset:16896
    buffer_load_dwordx4 v9, s[24:27], s13 offen lds
    v_mfma_f32_32x32x16_bf16 v[120:135], v[56:59], a[20:23], v[120:135]
    s_add_u32 m0, s60, 0
    s_mul_i32 s67, s14, s57
    ds_read_b64_tr_b16 v[52:53], v71 offset:16384
    ds_read_b64_tr_b16 v[54:55], v71 offset:16896
    buffer_load_dwordx4 v14, s[32:35], s67 offen lds
    s_waitcnt lgkmcnt(9)
    v_mfma_f32_32x32x16_bf16 v[104:119], v[32:35], a[24:27], v[104:119]
    s_add_u32 m0, s60, 1024
    ds_read_b128 a[36:39], v11 offset:32768
    ds_read_b64_tr_b16 v[56:57], v70 offset:18432
    ds_read_b64_tr_b16 v[58:59], v70 offset:18944
    buffer_load_dwordx4 v15, s[36:39], s67 offen lds
    v_mfma_f32_32x32x16_bf16 v[120:135], v[36:39], a[24:27], v[120:135]
    ds_read_b64_tr_b16 v[32:33], v71 offset:18432
    ds_read_b64_tr_b16 v[34:35], v71 offset:18944
    s_waitcnt lgkmcnt(10)
    v_mfma_f32_32x32x16_bf16 v[104:119], v[40:43], a[28:31], v[104:119]
    ds_read_b128 a[40:43], v12 offset:32768
    ds_read_b64_tr_b16 v[36:37], v70 offset:20480
    ds_read_b64_tr_b16 v[38:39], v70 offset:20992
    v_mfma_f32_32x32x16_bf16 v[120:135], v[44:47], a[28:31], v[120:135]
    ds_read_b64_tr_b16 v[40:41], v71 offset:20480
    ds_read_b64_tr_b16 v[42:43], v71 offset:20992
    s_waitcnt lgkmcnt(10)
    v_mfma_f32_32x32x16_bf16 v[136:151], v[48:51], a[32:35], v[136:151]
    ds_read_b128 a[44:47], v13 offset:32768
    ds_read_b64_tr_b16 v[44:45], v70 offset:22528
    ds_read_b64_tr_b16 v[46:47], v70 offset:23040
    v_mfma_f32_32x32x16_bf16 v[152:167], v[52:55], a[32:35], v[152:167]
    ds_read_b64_tr_b16 v[48:49], v71 offset:22528
    ds_read_b64_tr_b16 v[50:51], v71 offset:23040
    s_waitcnt lgkmcnt(10)
    v_mfma_f32_32x32x16_bf16 v[136:151], v[56:59], a[36:39], v[136:151]
    s_waitcnt vmcnt(29)
    s_barrier
    ds_read_b128 a[48:51], v10 offset:49152
    ds_read_b64_tr_b16 v[52:53], v70 offset:24576
    ds_read_b64_tr_b16 v[54:55], v70 offset:25088
    v_mfma_f32_32x32x16_bf16 v[152:167], v[32:35], a[36:39], v[152:167]
    s_add_u32 m0, s60, 8192
    s_mul_i32 s67, s15, s57
    ds_read_b64_tr_b16 v[56:57], v71 offset:24576
    ds_read_b64_tr_b16 v[58:59], v71 offset:25088
    buffer_load_dwordx4 v14, s[32:35], s67 offen lds
    s_waitcnt lgkmcnt(10)
    v_mfma_f32_32x32x16_bf16 v[136:151], v[36:39], a[40:43], v[136:151]
    s_add_u32 m0, s60, 9216
    ds_read_b128 a[52:55], v11 offset:49152
    ds_read_b64_tr_b16 v[32:33], v70 offset:26624
    ds_read_b64_tr_b16 v[34:35], v70 offset:27136
    buffer_load_dwordx4 v15, s[36:39], s67 offen lds
    v_mfma_f32_32x32x16_bf16 v[152:167], v[40:43], a[40:43], v[152:167]
    ds_read_b64_tr_b16 v[36:37], v71 offset:26624
    ds_read_b64_tr_b16 v[38:39], v71 offset:27136
    s_waitcnt lgkmcnt(10)
    v_mfma_f32_32x32x16_bf16 v[136:151], v[44:47], a[44:47], v[136:151]
    ds_read_b128 a[56:59], v12 offset:49152
    ds_read_b64_tr_b16 v[40:41], v70 offset:28672
    ds_read_b64_tr_b16 v[42:43], v70 offset:29184
    v_mfma_f32_32x32x16_bf16 v[152:167], v[48:51], a[44:47], v[152:167]
    s_add_u32 m0, s58, 32768
    ds_read_b64_tr_b16 v[44:45], v71 offset:28672
    ds_read_b64_tr_b16 v[46:47], v71 offset:29184
    buffer_load_dwordx4 v6, s[24:27], s14 offen lds
    s_waitcnt lgkmcnt(10)
    v_mfma_f32_32x32x16_bf16 v[136:151], v[52:55], a[48:51], v[136:151]
    s_add_u32 m0, s58, 33792
    ds_read_b128 a[60:63], v13 offset:49152
    ds_read_b64_tr_b16 v[48:49], v70 offset:30720
    ds_read_b64_tr_b16 v[50:51], v70 offset:31232
    buffer_load_dwordx4 v7, s[24:27], s14 offen lds
    v_mfma_f32_32x32x16_bf16 v[152:167], v[56:59], a[48:51], v[152:167]
    s_add_u32 m0, s58, 34816
    ds_read_b64_tr_b16 v[52:53], v71 offset:30720
    ds_read_b64_tr_b16 v[54:55], v71 offset:31232
    buffer_load_dwordx4 v8, s[24:27], s14 offen lds
    s_waitcnt lgkmcnt(10)
    v_mfma_f32_32x32x16_bf16 v[136:151], v[32:35], a[52:55], v[136:151]
    s_add_u32 m0, s58, 35840
    ds_read_b64_tr_b16 v[56:57], v74 offset:0
    ds_read_b64_tr_b16 v[58:59], v74 offset:512
    buffer_load_dwordx4 v9, s[24:27], s14 offen lds
    v_mfma_f32_32x32x16_bf16 v[152:167], v[36:39], a[52:55], v[152:167]
    ds_read_b64_tr_b16 v[32:33], v75 offset:0
    ds_read_b64_tr_b16 v[34:35], v75 offset:512
    s_waitcnt lgkmcnt(9)
    v_mfma_f32_32x32x16_bf16 v[136:151], v[40:43], a[56:59], v[136:151]
    ds_read_b64_tr_b16 v[36:37], v74 offset:2048
    ds_read_b64_tr_b16 v[38:39], v74 offset:2560
    v_mfma_f32_32x32x16_bf16 v[152:167], v[44:47], a[56:59], v[152:167]
    ds_read_b64_tr_b16 v[40:41], v75 offset:2048
    ds_read_b64_tr_b16 v[42:43], v75 offset:2560
    s_waitcnt lgkmcnt(8)
    v_mfma_f32_32x32x16_bf16 v[136:151], v[48:51], a[60:63], v[136:151]
    ds_read_b64_tr_b16 v[44:45], v74 offset:4096
    ds_read_b64_tr_b16 v[46:47], v74 offset:4608
    v_mfma_f32_32x32x16_bf16 v[152:167], v[52:55], a[60:63], v[152:167]
    s_add_u32 m0, s58, 49152
    ds_read_b64_tr_b16 v[48:49], v75 offset:4096
    ds_read_b64_tr_b16 v[50:51], v75 offset:4608
    buffer_load_dwordx4 v6, s[24:27], s15 offen lds
    s_waitcnt lgkmcnt(8)
    v_mfma_f32_32x32x16_bf16 v[104:119], v[56:59], a[32:35], v[104:119]
    s_add_u32 m0, s58, 50176
    ds_read_b64_tr_b16 v[52:53], v74 offset:6144
    ds_read_b64_tr_b16 v[54:55], v74 offset:6656
    buffer_load_dwordx4 v7, s[24:27], s15 offen lds
    v_mfma_f32_32x32x16_bf16 v[120:135], v[32:35], a[32:35], v[120:135]
    s_add_u32 m0, s58, 51200
    ds_read_b64_tr_b16 v[56:57], v75 offset:6144
    ds_read_b64_tr_b16 v[58:59], v75 offset:6656
    buffer_load_dwordx4 v8, s[24:27], s15 offen lds
    s_waitcnt lgkmcnt(8)
    v_mfma_f32_32x32x16_bf16 v[104:119], v[36:39], a[36:39], v[104:119]
    s_add_u32 m0, s58, 52224
    s_waitcnt vmcnt(15)
    s_barrier
    ds_read_b128 a[64:67], v10 offset:0
    ds_read_b64_tr_b16 v[32:33], v70 offset:32768
    ds_read_b64_tr_b16 v[34:35], v70 offset:33280
    buffer_load_dwordx4 v9, s[24:27], s15 offen lds
    v_mfma_f32_32x32x16_bf16 v[120:135], v[40:43], a[36:39], v[120:135]
    s_add_u32 m0, s60, 16384
    s_mul_i32 s67, s16, s57
    ds_read_b64_tr_b16 v[36:37], v71 offset:32768
    ds_read_b64_tr_b16 v[38:39], v71 offset:33280
    buffer_load_dwordx4 v14, s[32:35], s67 offen lds
    s_waitcnt lgkmcnt(9)
    v_mfma_f32_32x32x16_bf16 v[104:119], v[44:47], a[40:43], v[104:119]
    s_add_u32 m0, s60, 17408
    ds_read_b128 a[68:71], v11 offset:0
    ds_read_b64_tr_b16 v[40:41], v70 offset:34816
    ds_read_b64_tr_b16 v[42:43], v70 offset:35328
    buffer_load_dwordx4 v15, s[36:39], s67 offen lds
    v_mfma_f32_32x32x16_bf16 v[120:135], v[48:51], a[40:43], v[120:135]
    ds_read_b64_tr_b16 v[44:45], v71 offset:34816
    ds_read_b64_tr_b16 v[46:47], v71 offset:35328
    s_waitcnt lgkmcnt(10)
    v_mfma_f32_32x32x16_bf16 v[104:119], v[52:55], a[44:47], v[104:119]
    ds_read_b128 a[72:75], v12 offset:0
    ds_read_b64_tr_b16 v[48:49], v70 offset:36864
    ds_read_b64_tr_b16 v[50:51], v70 offset:37376
    v_mfma_f32_32x32x16_bf16 v[120:135], v[56:59], a[44:47], v[120:135]
    ds_read_b64_tr_b16 v[52:53], v71 offset:36864
    ds_read_b64_tr_b16 v[54:55], v71 offset:37376
    s_waitcnt lgkmcnt(10)
    v_mfma_f32_32x32x16_bf16 v[136:151], v[32:35], a[64:67], v[136:151]
    ds_read_b128 a[76:79], v13 offset:0
    ds_read_b64_tr_b16 v[56:57], v70 offset:38912
    ds_read_b64_tr_b16 v[58:59], v70 offset:39424
    v_mfma_f32_32x32x16_bf16 v[152:167], v[36:39], a[64:67], v[152:167]
    ds_read_b64_tr_b16 v[32:33], v71 offset:38912
    ds_read_b64_tr_b16 v[34:35], v71 offset:39424
    s_waitcnt lgkmcnt(10)
    v_mfma_f32_32x32x16_bf16 v[136:151], v[40:43], a[68:71], v[136:151]
    ds_read_b64_tr_b16 v[36:37], v74 offset:8192
    ds_read_b64_tr_b16 v[38:39], v74 offset:8704
    v_mfma_f32_32x32x16_bf16 v[152:167], v[44:47], a[68:71], v[152:167]
    ds_read_b64_tr_b16 v[40:41], v75 offset:8192
    ds_read_b64_tr_b16 v[42:43], v75 offset:8704
    s_waitcnt lgkmcnt(9)
    v_mfma_f32_32x32x16_bf16 v[136:151], v[48:51], a[72:75], v[136:151]
    ds_read_b64_tr_b16 v[44:45], v74 offset:10240
    ds_read_b64_tr_b16 v[46:47], v74 offset:10752
    v_mfma_f32_32x32x16_bf16 v[152:167], v[52:55], a[72:75], v[152:167]
    ds_read_b64_tr_b16 v[48:49], v75 offset:10240
    ds_read_b64_tr_b16 v[50:51], v75 offset:10752
    s_waitcnt lgkmcnt(8)
    v_mfma_f32_32x32x16_bf16 v[136:151], v[56:59], a[76:79], v[136:151]
    ds_read_b64_tr_b16 v[52:53], v74 offset:12288
    ds_read_b64_tr_b16 v[54:55], v74 offset:12800
    v_mfma_f32_32x32x16_bf16 v[152:167], v[32:35], a[76:79], v[152:167]
    s_add_u32 m0, s58, 0
    ds_read_b64_tr_b16 v[56:57], v75 offset:12288
    ds_read_b64_tr_b16 v[58:59], v75 offset:12800
    buffer_load_dwordx4 v6, s[24:27], s16 offen lds
    s_waitcnt lgkmcnt(8)
    v_mfma_f32_32x32x16_bf16 v[104:119], v[36:39], a[48:51], v[104:119]
    s_add_u32 m0, s58, 1024
    ds_read_b64_tr_b16 v[32:33], v74 offset:14336
    ds_read_b64_tr_b16 v[34:35], v74 offset:14848
    buffer_load_dwordx4 v7, s[24:27], s16 offen lds
    v_mfma_f32_32x32x16_bf16 v[120:135], v[40:43], a[48:51], v[120:135]
    s_add_u32 m0, s58, 2048
    ds_read_b64_tr_b16 v[36:37], v75 offset:14336
    ds_read_b64_tr_b16 v[38:39], v75 offset:14848
    buffer_load_dwordx4 v8, s[24:27], s16 offen lds
    s_waitcnt lgkmcnt(8)
    v_mfma_f32_32x32x16_bf16 v[104:119], v[44:47], a[52:55], v[104:119]
    s_add_u32 m0, s58, 3072
    s_waitcnt vmcnt(17)
    s_barrier
    ds_read_b128 a[80:83], v10 offset:16384
    ds_read_b64_tr_b16 v[40:41], v70 offset:40960
    ds_read_b64_tr_b16 v[42:43], v70 offset:41472
    buffer_load_dwordx4 v9, s[24:27], s16 offen lds
    v_mfma_f32_32x32x16_bf16 v[120:135], v[48:51], a[52:55], v[120:135]
    s_add_u32 m0, s60, 24576
    s_mul_i32 s67, s17, s57
    ds_read_b64_tr_b16 v[44:45], v71 offset:40960
    ds_read_b64_tr_b16 v[46:47], v71 offset:41472
    buffer_load_dwordx4 v14, s[32:35], s67 offen lds
    s_waitcnt lgkmcnt(9)
    v_mfma_f32_32x32x16_bf16 v[104:119], v[52:55], a[56:59], v[104:119]
    s_add_u32 m0, s60, 25600
    ds_read_b128 a[84:87], v11 offset:16384
    ds_read_b64_tr_b16 v[48:49], v70 offset:43008
    ds_read_b64_tr_b16 v[50:51], v70 offset:43520
    buffer_load_dwordx4 v15, s[36:39], s67 offen lds
    v_mfma_f32_32x32x16_bf16 v[120:135], v[56:59], a[56:59], v[120:135]
    ds_read_b64_tr_b16 v[52:53], v71 offset:43008
    ds_read_b64_tr_b16 v[54:55], v71 offset:43520
    s_waitcnt lgkmcnt(10)
    v_mfma_f32_32x32x16_bf16 v[104:119], v[32:35], a[60:63], v[104:119]
    ds_read_b128 a[88:91], v12 offset:16384
    ds_read_b64_tr_b16 v[56:57], v70 offset:45056
    ds_read_b64_tr_b16 v[58:59], v70 offset:45568
    v_mfma_f32_32x32x16_bf16 v[120:135], v[36:39], a[60:63], v[120:135]
    ds_read_b64_tr_b16 v[32:33], v71 offset:45056
    ds_read_b64_tr_b16 v[34:35], v71 offset:45568
    s_waitcnt lgkmcnt(10)
    v_mfma_f32_32x32x16_bf16 v[136:151], v[40:43], a[80:83], v[136:151]
    ds_read_b128 a[92:95], v13 offset:16384
    ds_read_b64_tr_b16 v[36:37], v70 offset:47104
    ds_read_b64_tr_b16 v[38:39], v70 offset:47616
    v_mov_b32 v25, 0
    v_mov_b32 v26, 0
    v_dot2_f32_bf16 v25, v168, v178, v25
    v_dot2_f32_bf16 v26, v169, v179, v26
    v_dot2_f32_bf16 v25, v170, v180, v25
    v_dot2_f32_bf16 v26, v171, v181, v26
    v_dot2_f32_bf16 v25, v172, v182, v25
    v_dot2_f32_bf16 v26, v173, v183, v26
    v_dot2_f32_bf16 v25, v174, v184, v25
    v_dot2_f32_bf16 v26, v175, v185, v26
    v_dot2_f32_bf16 v25, v176, v186, v25
    v_dot2_f32_bf16 v26, v177, v187, v26
    s_nop 2
    v_add_f32 v25, v25, v26
    s_nop 1
    v_add_f32_dpp v25, v25, v25 row_shr:1 row_mask:0xf bank_mask:0xf bound_ctrl:0
    s_nop 1
    v_add_f32_dpp v25, v25, v25 row_shr:2 row_mask:0xf bank_mask:0xf bound_ctrl:0
    s_nop 1
    v_add_f32_dpp v25, v25, v25 row_shr:4 row_mask:0xf bank_mask:0xf bound_ctrl:0
    s_nop 1
    v_add_f32_dpp v25, v25, v25 row_shr:8 row_mask:0xf bank_mask:0xf bound_ctrl:0
    s_nop 1
    v_add_f32_dpp v25, v25, v25 row_bcast:15 row_mask:0xa bank_mask:0xf
    v_mul_f32 v25, 0xbfb8aa3b, v25
    v_exp_f32 v25, v25
    s_nop 0
    v_add_f32 v25, 1.0, v25
    v_rcp_f32 v81, v25
    s_lshl_b32 s63, s3, 8
    s_add_u32 s63, s63, s2
    s_mov_b32 s50, 819200
    s_cmp_ge_u32 s63, 160
    s_cselect_b64 s[48:49], s[76:77], s[70:71]
    s_cselect_b32 s50, 1105920, s50
    v_mfma_f32_32x32x16_bf16 v[152:167], v[44:47], a[80:83], v[152:167]
    ds_read_b64_tr_b16 v[40:41], v71 offset:47104
    ds_read_b64_tr_b16 v[42:43], v71 offset:47616
    s_waitcnt lgkmcnt(10)
    v_mfma_f32_32x32x16_bf16 v[136:151], v[48:51], a[84:87], v[136:151]
    s_waitcnt vmcnt(12)
    s_barrier
    ds_read_b128 a[96:99], v10 offset:32768
    ds_read_b64_tr_b16 v[44:45], v70 offset:0
    ds_read_b64_tr_b16 v[46:47], v70 offset:512
    v_mfma_f32_32x32x16_bf16 v[152:167], v[52:55], a[84:87], v[152:167]
    s_add_u32 m0, s60, 32768
    s_mul_i32 s67, s12, 1728
    ds_read_b64_tr_b16 v[48:49], v71 offset:0
    ds_read_b64_tr_b16 v[50:51], v71 offset:512
    buffer_load_dwordx4 v236, s[28:31], s67 offen lds
    s_waitcnt lgkmcnt(10)
    v_mfma_f32_32x32x16_bf16 v[136:151], v[56:59], a[88:91], v[136:151]
    s_add_u32 m0, s60, 33792
    ds_read_b128 a[100:103], v11 offset:32768
    ds_read_b64_tr_b16 v[52:53], v70 offset:2048
    ds_read_b64_tr_b16 v[54:55], v70 offset:2560
    buffer_load_dwordx4 v237, s[28:31], s67 offen lds
    v_mfma_f32_32x32x16_bf16 v[152:167], v[32:35], a[88:91], v[152:167]
    ds_read_b64_tr_b16 v[56:57], v71 offset:2048
    ds_read_b64_tr_b16 v[58:59], v71 offset:2560
    s_waitcnt lgkmcnt(10)
    v_mfma_f32_32x32x16_bf16 v[136:151], v[36:39], a[92:95], v[136:151]
    ds_read_b128 a[104:107], v12 offset:32768
    ds_read_b64_tr_b16 v[32:33], v70 offset:4096
    ds_read_b64_tr_b16 v[34:35], v70 offset:4608
    v_mfma_f32_32x32x16_bf16 v[152:167], v[40:43], a[92:95], v[152:167]
    s_add_u32 m0, s58, 16384
    ds_read_b64_tr_b16 v[36:37], v71 offset:4096
    ds_read_b64_tr_b16 v[38:39], v71 offset:4608
    buffer_load_dwordx4 v6, s[24:27], s17 offen lds
    s_waitcnt lgkmcnt(10)
    v_mfma_f32_32x32x16_bf16 v[136:151], v[44:47], a[96:99], v[136:151]
    s_add_u32 m0, s58, 17408
    ds_read_b128 a[108:111], v13 offset:32768
    ds_read_b64_tr_b16 v[40:41], v70 offset:6144
    ds_read_b64_tr_b16 v[42:43], v70 offset:6656
    buffer_load_dwordx4 v7, s[24:27], s17 offen lds
    v_mfma_f32_32x32x16_bf16 v[152:167], v[48:51], a[96:99], v[152:167]
    s_add_u32 m0, s58, 18432
    ds_read_b64_tr_b16 v[44:45], v71 offset:6144
    ds_read_b64_tr_b16 v[46:47], v71 offset:6656
    buffer_load_dwordx4 v8, s[24:27], s17 offen lds
    s_waitcnt lgkmcnt(10)
    v_mfma_f32_32x32x16_bf16 v[136:151], v[52:55], a[100:103], v[136:151]
    s_add_u32 m0, s58, 19456
    s_waitcnt vmcnt(13)
    s_barrier
    ds_read_b128 a[112:115], v10 offset:49152
    ds_read_b64_tr_b16 v[48:49], v70 offset:8192
    ds_read_b64_tr_b16 v[50:51], v70 offset:8704
    buffer_load_dwordx4 v9, s[24:27], s17 offen lds
    v_mfma_f32_32x32x16_bf16 v[152:167], v[56:59], a[100:103], v[152:167]
    s_add_u32 m0, s60, 40960
    s_mul_i32 s67, s13, 1728
    ds_read_b64_tr_b16 v[52:53], v71 offset:8192
    ds_read_b64_tr_b16 v[54:55], v71 offset:8704
    buffer_load_dwordx4 v236, s[28:31], s67 offen lds
    s_waitcnt lgkmcnt(10)
    v_mfma_f32_32x32x16_bf16 v[136:151], v[32:35], a[104:107], v[136:151]
    s_add_u32 m0, s60, 41984
    ds_read_b128 a[116:119], v11 offset:49152
    ds_read_b64_tr_b16 v[56:57], v70 offset:10240
    ds_read_b64_tr_b16 v[58:59], v70 offset:10752
    buffer_load_dwordx4 v237, s[28:31], s67 offen lds
    v_mfma_f32_32x32x16_bf16 v[152:167], v[36:39], a[104:107], v[152:167]
    ds_read_b64_tr_b16 v[32:33], v71 offset:10240
    ds_read_b64_tr_b16 v[34:35], v71 offset:10752
    s_waitcnt lgkmcnt(10)
    v_mfma_f32_32x32x16_bf16 v[136:151], v[40:43], a[108:111], v[136:151]
    ds_read_b128 a[120:123], v12 offset:49152
    ds_read_b64_tr_b16 v[36:37], v70 offset:12288
    ds_read_b64_tr_b16 v[38:39], v70 offset:12800
    v_mfma_f32_32x32x16_bf16 v[152:167], v[44:47], a[108:111], v[152:167]
    s_add_u32 m0, s58, 32768
    s_mul_i32 s67, s14, 1728
    ds_read_b64_tr_b16 v[40:41], v71 offset:12288
    ds_read_b64_tr_b16 v[42:43], v71 offset:12800
    buffer_load_dwordx4 v236, s[28:31], s67 offen lds
    s_waitcnt lgkmcnt(10)
    v_mfma_f32_32x32x16_bf16 v[136:151], v[48:51], a[112:115], v[136:151]
    s_add_u32 m0, s58, 33792
    ds_read_b128 a[124:127], v13 offset:49152
    ds_read_b64_tr_b16 v[44:45], v70 offset:14336
    ds_read_b64_tr_b16 v[46:47], v70 offset:14848
    buffer_load_dwordx4 v237, s[28:31], s67 offen lds
    buffer_load_dwordx2 v[68:69], v83, s[44:47], 0 offen sc1
    v_mfma_f32_32x32x16_bf16 v[152:167], v[52:55], a[112:115], v[152:167]
    s_add_u32 m0, s58, 34816
    s_mul_i32 s67, s15, 1728
    ds_read_b64_tr_b16 v[48:49], v71 offset:14336
    ds_read_b64_tr_b16 v[50:51], v71 offset:14848
    buffer_load_dwordx4 v236, s[28:31], s67 offen lds
    s_waitcnt lgkmcnt(10)
    v_mfma_f32_32x32x16_bf16 v[136:151], v[56:59], a[116:119], v[136:151]
    s_add_u32 m0, s58, 35840
    s_waitcnt vmcnt(14)
    s_barrier
    ds_read_b128 a[128:131], v10 offset:0
    ds_read_b64_tr_b16 v[52:53], v70 offset:16384
    ds_read_b64_tr_b16 v[54:55], v70 offset:16896
    buffer_load_dwordx4 v237, s[28:31], s67 offen lds
    v_mfma_f32_32x32x16_bf16 v[152:167], v[32:35], a[116:119], v[152:167]
    ds_read_b64_tr_b16 v[56:57], v71 offset:16384
    ds_read_b64_tr_b16 v[58:59], v71 offset:16896
    s_waitcnt lgkmcnt(10)
    v_mfma_f32_32x32x16_bf16 v[136:151], v[36:39], a[120:123], v[136:151]
    ds_read_b128 a[132:135], v11 offset:0
    ds_read_b64_tr_b16 v[32:33], v70 offset:18432
    ds_read_b64_tr_b16 v[34:35], v70 offset:18944
    v_mfma_f32_32x32x16_bf16 v[152:167], v[40:43], a[120:123], v[152:167]
    ds_read_b64_tr_b16 v[36:37], v71 offset:18432
    ds_read_b64_tr_b16 v[38:39], v71 offset:18944
    s_waitcnt lgkmcnt(10)
    v_mfma_f32_32x32x16_bf16 v[136:151], v[44:47], a[124:127], v[136:151]
    ds_read_b128 a[136:139], v12 offset:0
    ds_read_b64_tr_b16 v[40:41], v70 offset:20480
    ds_read_b64_tr_b16 v[42:43], v70 offset:20992
    v_mfma_f32_32x32x16_bf16 v[152:167], v[48:51], a[124:127], v[152:167]
    s_add_u32 m0, s58, 49152
    s_mul_i32 s67, s16, 1728
    ds_read_b64_tr_b16 v[44:45], v71 offset:20480
    ds_read_b64_tr_b16 v[46:47], v71 offset:20992
    buffer_load_dwordx4 v236, s[28:31], s67 offen lds
    s_waitcnt lgkmcnt(10)
    v_mfma_f32_32x32x16_bf16 v[136:151], v[52:55], a[128:131], v[136:151]
    s_add_u32 m0, s58, 50176
    ds_read_b128 a[140:143], v13 offset:0
    ds_read_b64_tr_b16 v[48:49], v70 offset:22528
    ds_read_b64_tr_b16 v[50:51], v70 offset:23040
    buffer_load_dwordx4 v237, s[28:31], s67 offen lds
    v_mfma_f32_32x32x16_bf16 v[152:167], v[56:59], a[128:131], v[152:167]
    s_add_u32 m0, s58, 51200
    s_mul_i32 s67, s17, 1728
    ds_read_b64_tr_b16 v[52:53], v71 offset:22528
    ds_read_b64_tr_b16 v[54:55], v71 offset:23040
    buffer_load_dwordx4 v236, s[28:31], s67 offen lds
    s_waitcnt lgkmcnt(10)
    v_mfma_f32_32x32x16_bf16 v[136:151], v[32:35], a[132:135], v[136:151]
    s_add_u32 m0, s58, 52224
    s_waitcnt vmcnt(10)
    s_barrier
    ds_read_b128 a[144:147], v10 offset:16384
    ds_read_b64_tr_b16 v[56:57], v70 offset:24576
    ds_read_b64_tr_b16 v[58:59], v70 offset:25088
    buffer_load_dwordx4 v237, s[28:31], s67 offen lds
    v_mfma_f32_32x32x16_bf16 v[152:167], v[36:39], a[132:135], v[152:167]
    ds_read_b64_tr_b16 v[32:33], v71 offset:24576
    ds_read_b64_tr_b16 v[34:35], v71 offset:25088
    s_waitcnt lgkmcnt(10)
    v_mfma_f32_32x32x16_bf16 v[136:151], v[40:43], a[136:139], v[136:151]
    ds_read_b128 a[148:151], v11 offset:16384
    ds_read_b64_tr_b16 v[36:37], v70 offset:26624
    ds_read_b64_tr_b16 v[38:39], v70 offset:27136
    v_mfma_f32_32x32x16_bf16 v[152:167], v[44:47], a[136:139], v[152:167]
    ds_read_b64_tr_b16 v[40:41], v71 offset:26624
    ds_read_b64_tr_b16 v[42:43], v71 offset:27136
    s_waitcnt lgkmcnt(10)
    v_mfma_f32_32x32x16_bf16 v[136:151], v[48:51], a[140:143], v[136:151]
    ds_read_b128 a[152:155], v12 offset:16384
    ds_read_b64_tr_b16 v[44:45], v70 offset:28672
    ds_read_b64_tr_b16 v[46:47], v70 offset:29184
    v_mfma_f32_32x32x16_bf16 v[152:167], v[52:55], a[140:143], v[152:167]
    ds_read_b64_tr_b16 v[48:49], v71 offset:28672
    ds_read_b64_tr_b16 v[50:51], v71 offset:29184
    s_waitcnt lgkmcnt(10)
    v_mfma_f32_32x32x16_bf16 v[136:151], v[56:59], a[144:147], v[136:151]
    ds_read_b128 a[156:159], v13 offset:16384
    ds_read_b64_tr_b16 v[52:53], v70 offset:30720
    ds_read_b64_tr_b16 v[54:55], v70 offset:31232
    v_mfma_f32_32x32x16_bf16 v[152:167], v[32:35], a[144:147], v[152:167]
    ds_read_b64_tr_b16 v[56:57], v71 offset:30720
    ds_read_b64_tr_b16 v[58:59], v71 offset:31232
    s_waitcnt lgkmcnt(10)
    v_mfma_f32_32x32x16_bf16 v[136:151], v[36:39], a[148:151], v[136:151]
    v_mfma_f32_32x32x16_bf16 v[152:167], v[40:43], a[148:151], v[152:167]
    s_waitcnt lgkmcnt(5)
    v_mfma_f32_32x32x16_bf16 v[136:151], v[44:47], a[152:155], v[136:151]
    v_mfma_f32_32x32x16_bf16 v[152:167], v[48:51], a[152:155], v[152:167]
    s_waitcnt lgkmcnt(0)
    v_mfma_f32_32x32x16_bf16 v[136:151], v[52:55], a[156:159], v[136:151]
    v_mfma_f32_32x32x16_bf16 v[152:167], v[56:59], a[156:159], v[152:167]
    s_waitcnt vmcnt(6)
    s_mov_b32 s65, 0
M_tagchk:
    v_readfirstlane_b32 s64, v69
    v_readfirstlane_b32 s69, v68
    s_cmp_eq_u32 s64, 1
    s_cbranch_scc1 M_tagok
    s_sleep 2
    buffer_load_dwordx2 v[68:69], v83, s[44:47], 0 offen sc1
    s_waitcnt vmcnt(0)
    s_add_u32 s65, s65, 1
    s_cmp_lt_u32 s65, 262144
    s_cbranch_scc1 M_tagchk
M_tagok:
    s_nop 7
    s_cmp_eq_u32 s66, 1
    s_cbranch_scc1 M_tailB
    s_cmp_eq_u32 s66, 2
    s_cbranch_scc1 M_tailC
    s_cmp_eq_u32 s66, 3
    s_cbranch_scc1 M_tail_done
    s_mul_i32 s63, s62, 40960
    s_lshl_b32 s64, s54, 11
    s_add_u32 s63, s63, s64
    v_pk_mul_f32 v[136:137], v[136:137], v[66:67]
    v_pk_mul_f32 v[138:139], v[138:139], v[66:67]
    v_pk_mul_f32 v[140:141], v[140:141], v[66:67]
    v_pk_mul_f32 v[142:143], v[142:143], v[66:67]
    v_pk_mul_f32 v[144:145], v[144:145], v[66:67]
    v_pk_mul_f32 v[146:147], v[146:147], v[66:67]
    v_pk_mul_f32 v[148:149], v[148:149], v[66:67]
    v_pk_mul_f32 v[150:151], v[150:151], v[66:67]
    v_cvt_pk_bf16_f32 v200, v136, v137
    v_cvt_pk_bf16_f32 v201, v138, v139
    v_cvt_pk_bf16_f32 v202, v140, v141
    v_cvt_pk_bf16_f32 v203, v142, v143
    v_cvt_pk_bf16_f32 v204, v144, v145
    v_cvt_pk_bf16_f32 v205, v146, v147
    v_cvt_pk_bf16_f32 v206, v148, v149
    v_cvt_pk_bf16_f32 v207, v150, v151
    buffer_store_dwordx2 v[200:201], v5, s[40:43], s63 offen offset:0 sc1
    buffer_store_dwordx2 v[202:203], v5, s[40:43], s63 offen offset:512 sc1
    buffer_store_dwordx2 v[204:205], v5, s[40:43], s63 offen offset:1024 sc1
    buffer_store_dwordx2 v[206:207], v5, s[40:43], s63 offen offset:1536 sc1
    v_pk_mul_f32 v[152:153], v[152:153], v[66:67]
    v_pk_mul_f32 v[154:155], v[154:155], v[66:67]
    v_pk_mul_f32 v[156:157], v[156:157], v[66:67]
    v_pk_mul_f32 v[158:159], v[158:159], v[66:67]
    v_pk_mul_f32 v[160:161], v[160:161], v[66:67]
    v_pk_mul_f32 v[162:163], v[162:163], v[66:67]
    v_pk_mul_f32 v[164:165], v[164:165], v[66:67]
    v_pk_mul_f32 v[166:167], v[166:167], v[66:67]
    v_cvt_pk_bf16_f32 v208, v152, v153
    v_cvt_pk_bf16_f32 v209, v154, v155
    v_cvt_pk_bf16_f32 v210, v156, v157
    v_cvt_pk_bf16_f32 v211, v158, v159
    v_cvt_pk_bf16_f32 v212, v160, v161
    v_cvt_pk_bf16_f32 v213, v162, v163
    v_cvt_pk_bf16_f32 v214, v164, v165
    v_cvt_pk_bf16_f32 v215, v166, v167
    buffer_store_dwordx2 v[208:209], v5, s[40:43], s63 offen offset:2048 sc1
    buffer_store_dwordx2 v[210:211], v5, s[40:43], s63 offen offset:2560 sc1
    buffer_store_dwordx2 v[212:213], v5, s[40:43], s63 offen offset:3072 sc1
    buffer_store_dwordx2 v[214:215], v5, s[40:43], s63 offen offset:3584 sc1
    s_branch M_tail_done
M_tailC:
    v_pk_mul_f32 v[168:169], v[136:137], v[136:137]
    v_pk_mul_f32 v[170:171], v[138:139], v[138:139]
    v_pk_mul_f32 v[172:173], v[140:141], v[140:141]
    v_pk_mul_f32 v[174:175], v[142:143], v[142:143]
    v_pk_mul_f32 v[176:177], v[144:145], v[144:145]
    v_pk_mul_f32 v[178:179], v[146:147], v[146:147]
    v_pk_mul_f32 v[180:181], v[148:149], v[148:149]
    v_pk_mul_f32 v[182:183], v[150:151], v[150:151]
    v_pk_fma_f32 v[168:169], v[168:169], v[62:63], v[60:61]
    v_pk_fma_f32 v[170:171], v[170:171], v[62:63], v[60:61]
    v_pk_fma_f32 v[172:173], v[172:173], v[62:63], v[60:61]
    v_pk_fma_f32 v[174:175], v[174:175], v[62:63], v[60:61]
    v_pk_fma_f32 v[176:177], v[176:177], v[62:63], v[60:61]
    v_pk_fma_f32 v[178:179], v[178:179], v[62:63], v[60:61]
    v_pk_fma_f32 v[180:181], v[180:181], v[62:63], v[60:61]
    v_pk_fma_f32 v[182:183], v[182:183], v[62:63], v[60:61]
    v_pk_mul_f32 v[168:169], v[168:169], v[136:137]
    v_pk_mul_f32 v[170:171], v[170:171], v[138:139]
    v_pk_mul_f32 v[172:173], v[172:173], v[140:141]
    v_pk_mul_f32 v[174:175], v[174:175], v[142:143]
    v_pk_mul_f32 v[176:177], v[176:177], v[144:145]
    v_pk_mul_f32 v[178:179], v[178:179], v[146:147]
    v_pk_mul_f32 v[180:181], v[180:181], v[148:149]
    v_pk_mul_f32 v[182:183], v[182:183], v[150:151]
    v_exp_f32 v168, v168
    v_exp_f32 v169, v169
    v_exp_f32 v170, v170
    v_exp_f32 v171, v171
    v_exp_f32 v172, v172
    v_exp_f32 v173, v173
    v_exp_f32 v174, v174
    v_exp_f32 v175, v175
    v_exp_f32 v176, v176
    v_exp_f32 v177, v177
    v_exp_f32 v178, v178
    v_exp_f32 v179, v179
    v_exp_f32 v180, v180
    v_exp_f32 v181, v181
    v_exp_f32 v182, v182
    v_exp_f32 v183, v183
    v_pk_add_f32 v[168:169], v[168:169], v[64:65]
    v_pk_add_f32 v[170:171], v[170:171], v[64:65]
    v_pk_add_f32 v[172:173], v[172:173], v[64:65]
    v_pk_add_f32 v[174:175], v[174:175], v[64:65]
    v_pk_add_f32 v[176:177], v[176:177], v[64:65]
    v_pk_add_f32 v[178:179], v[178:179], v[64:65]
    v_pk_add_f32 v[180:181], v[180:181], v[64:65]
    v_pk_add_f32 v[182:183], v[182:183], v[64:65]
    v_rcp_f32 v168, v168
    v_rcp_f32 v169, v169
    v_rcp_f32 v170, v170
    v_rcp_f32 v171, v171
    v_rcp_f32 v172, v172
    v_rcp_f32 v173, v173
    v_rcp_f32 v174, v174
    v_rcp_f32 v175, v175
    v_rcp_f32 v176, v176
    v_rcp_f32 v177, v177
    v_rcp_f32 v178, v178
    v_rcp_f32 v179, v179
    v_rcp_f32 v180, v180
    v_rcp_f32 v181, v181
    v_rcp_f32 v182, v182
    v_rcp_f32 v183, v183
    v_pk_mul_f32 v[136:137], v[136:137], v[168:169]
    v_pk_mul_f32 v[138:139], v[138:139], v[170:171]
    v_pk_mul_f32 v[140:141], v[140:141], v[172:173]
    v_pk_mul_f32 v[142:143], v[142:143], v[174:175]
    v_pk_mul_f32 v[144:145], v[144:145], v[176:177]
    v_pk_mul_f32 v[146:147], v[146:147], v[178:179]
    v_pk_mul_f32 v[148:149], v[148:149], v[180:181]
    v_pk_mul_f32 v[150:151], v[150:151], v[182:183]
    v_cvt_pk_bf16_f32 v200, v136, v137
    v_cvt_pk_bf16_f32 v201, v138, v139
    v_cvt_pk_bf16_f32 v202, v140, v141
    v_cvt_pk_bf16_f32 v203, v142, v143
    v_cvt_pk_bf16_f32 v204, v144, v145
    v_cvt_pk_bf16_f32 v205, v146, v147
    v_cvt_pk_bf16_f32 v206, v148, v149
    v_cvt_pk_bf16_f32 v207, v150, v151
    s_mul_i32 s63, s62, 55296
    s_lshl_b32 s64, s54, 11
    s_add_u32 s63, s63, s64
    s_add_u32 s63, s63, 7077888
    buffer_store_dwordx4 v[200:203], v4, s[40:43], s63 offen sc1
    buffer_store_dwordx4 v[204:207], v4, s[40:43], s63 offen offset:1024 sc1
    v_pk_mul_f32 v[168:169], v[152:153], v[152:153]
    v_pk_mul_f32 v[170:171], v[154:155], v[154:155]
    v_pk_mul_f32 v[172:173], v[156:157], v[156:157]
    v_pk_mul_f32 v[174:175], v[158:159], v[158:159]
    v_pk_mul_f32 v[176:177], v[160:161], v[160:161]
    v_pk_mul_f32 v[178:179], v[162:163], v[162:163]
    v_pk_mul_f32 v[180:181], v[164:165], v[164:165]
    v_pk_mul_f32 v[182:183], v[166:167], v[166:167]
    v_pk_fma_f32 v[168:169], v[168:169], v[62:63], v[60:61]
    v_pk_fma_f32 v[170:171], v[170:171], v[62:63], v[60:61]
    v_pk_fma_f32 v[172:173], v[172:173], v[62:63], v[60:61]
    v_pk_fma_f32 v[174:175], v[174:175], v[62:63], v[60:61]
    v_pk_fma_f32 v[176:177], v[176:177], v[62:63], v[60:61]
    v_pk_fma_f32 v[178:179], v[178:179], v[62:63], v[60:61]
    v_pk_fma_f32 v[180:181], v[180:181], v[62:63], v[60:61]
    v_pk_fma_f32 v[182:183], v[182:183], v[62:63], v[60:61]
    v_pk_mul_f32 v[168:169], v[168:169], v[152:153]
    v_pk_mul_f32 v[170:171], v[170:171], v[154:155]
    v_pk_mul_f32 v[172:173], v[172:173], v[156:157]
    v_pk_mul_f32 v[174:175], v[174:175], v[158:159]
    v_pk_mul_f32 v[176:177], v[176:177], v[160:161]
    v_pk_mul_f32 v[178:179], v[178:179], v[162:163]
    v_pk_mul_f32 v[180:181], v[180:181], v[164:165]
    v_pk_mul_f32 v[182:183], v[182:183], v[166:167]
    v_exp_f32 v168, v168
    v_exp_f32 v169, v169
    v_exp_f32 v170, v170
    v_exp_f32 v171, v171
    v_exp_f32 v172, v172
    v_exp_f32 v173, v173
    v_exp_f32 v174, v174
    v_exp_f32 v175, v175
    v_exp_f32 v176, v176
    v_exp_f32 v177, v177
    v_exp_f32 v178, v178
    v_exp_f32 v179, v179
    v_exp_f32 v180, v180
    v_exp_f32 v181, v181
    v_exp_f32 v182, v182
    v_exp_f32 v183, v183
    v_pk_add_f32 v[168:169], v[168:169], v[64:65]
    v_pk_add_f32 v[170:171], v[170:171], v[64:65]
    v_pk_add_f32 v[172:173], v[172:173], v[64:65]
    v_pk_add_f32 v[174:175], v[174:175], v[64:65]
    v_pk_add_f32 v[176:177], v[176:177], v[64:65]
    v_pk_add_f32 v[178:179], v[178:179], v[64:65]
    v_pk_add_f32 v[180:181], v[180:181], v[64:65]
    v_pk_add_f32 v[182:183], v[182:183], v[64:65]
    v_rcp_f32 v168, v168
    v_rcp_f32 v169, v169
    v_rcp_f32 v170, v170
    v_rcp_f32 v171, v171
    v_rcp_f32 v172, v172
    v_rcp_f32 v173, v173
    v_rcp_f32 v174, v174
    v_rcp_f32 v175, v175
    v_rcp_f32 v176, v176
    v_rcp_f32 v177, v177
    v_rcp_f32 v178, v178
    v_rcp_f32 v179, v179
    v_rcp_f32 v180, v180
    v_rcp_f32 v181, v181
    v_rcp_f32 v182, v182
    v_rcp_f32 v183, v183
    v_pk_mul_f32 v[152:153], v[152:153], v[168:169]
    v_pk_mul_f32 v[154:155], v[154:155], v[170:171]
    v_pk_mul_f32 v[156:157], v[156:157], v[172:173]
    v_pk_mul_f32 v[158:159], v[158:159], v[174:175]
    v_pk_mul_f32 v[160:161], v[160:161], v[176:177]
    v_pk_mul_f32 v[162:163], v[162:163], v[178:179]
    v_pk_mul_f32 v[164:165], v[164:165], v[180:181]
    v_pk_mul_f32 v[166:167], v[166:167], v[182:183]
    v_cvt_pk_bf16_f32 v208, v152, v153
    v_cvt_pk_bf16_f32 v209, v154, v155
    v_cvt_pk_bf16_f32 v210, v156, v157
    v_cvt_pk_bf16_f32 v211, v158, v159
    v_cvt_pk_bf16_f32 v212, v160, v161
    v_cvt_pk_bf16_f32 v213, v162, v163
    v_cvt_pk_bf16_f32 v214, v164, v165
    v_cvt_pk_bf16_f32 v215, v166, v167
    s_mul_i32 s63, s62, 55296
    s_lshl_b32 s64, s54, 11
    s_add_u32 s63, s63, s64
    s_add_u32 s63, s63, 7079936
    buffer_store_dwordx4 v[208:211], v4, s[40:43], s63 offen sc1
    buffer_store_dwordx4 v[212:215], v4, s[40:43], s63 offen offset:1024 sc1
    s_branch M_tail_done
M_tailB:
    v_cvt_pk_bf16_f32 v200, v136, v137
    v_cvt_pk_bf16_f32 v201, v138, v139
    v_cvt_pk_bf16_f32 v202, v140, v141
    v_cvt_pk_bf16_f32 v203, v142, v143
    v_cvt_pk_bf16_f32 v204, v144, v145
    v_cvt_pk_bf16_f32 v205, v146, v147
    v_mul_f32 v19, v136, v136
    v_fma_f32 v19, v137, v137, v19
    v_fma_f32 v19, v138, v138, v19
    v_fma_f32 v19, v139, v139, v19
    v_fma_f32 v19, v140, v140, v19
    v_fma_f32 v19, v141, v141, v19
    v_fma_f32 v19, v142, v142, v19
    v_fma_f32 v19, v143, v143, v19
    v_mul_f32 v20, v144, v144
    v_fma_f32 v20, v145, v145, v20
    v_fma_f32 v20, v146, v146, v20
    v_fma_f32 v20, v147, v147, v20
    s_mov_b32 exec_lo, 0
    v_mov_b32 v20, 0
    v_mov_b32 v204, 0x3f803f80
    v_mov_b32 v205, 0x00003f80
    s_mov_b64 exec, -1
    v_add_f32 v19, v19, v20
    v_mov_b32 v20, v19
    s_nop 1
    v_permlane32_swap_b32 v19, v20
    v_add_f32 v19, v19, v20
    s_nop 1
    v_max_f32_dpp v19, v19, v19 row_shr:1 row_mask:0xf bank_mask:0xf bound_ctrl:0
    s_nop 1
    v_max_f32_dpp v19, v19, v19 row_shr:2 row_mask:0xf bank_mask:0xf bound_ctrl:0
    s_nop 1
    v_max_f32_dpp v19, v19, v19 row_shr:4 row_mask:0xf bank_mask:0xf bound_ctrl:0
    s_nop 1
    v_max_f32_dpp v19, v19, v19 row_shr:8 row_mask:0xf bank_mask:0xf bound_ctrl:0
    s_nop 1
    v_max_f32_dpp v19, v19, v19 row_bcast:15 row_mask:0xa bank_mask:0xf
    s_sub_u32 s63, s62, 1
    s_and_b32 s63, s63, 63
    s_mul_i32 s63, s63, 3072
    s_add_u32 s63, s63, 2621440
    buffer_store_dwordx4 v[200:203], v4, s[40:43], s63 offen sc1
    buffer_store_dwordx2 v[204:205], v5, s[40:43], s63 offen offset:1024 sc1
    s_lshl_b32 s64, s62, 2
    s_add_u32 s64, s64, 2826240
    s_mov_b32 exec_lo, 0x80000000
    s_mov_b32 exec_hi, 0
    buffer_store_dword v19, v83, s[40:43], s64 offen sc1
    s_mov_b64 exec, -1
    v_cvt_pk_bf16_f32 v208, v152, v153
    v_cvt_pk_bf16_f32 v209, v154, v155
    v_cvt_pk_bf16_f32 v210, v156, v157
    v_cvt_pk_bf16_f32 v211, v158, v159
    v_cvt_pk_bf16_f32 v212, v160, v161
    v_cvt_pk_bf16_f32 v213, v162, v163
    v_mul_u32_u24 v21, 72, v3
    v_lshl_add_u32 v21, v2, 3, v21
    v_add_u32 v21, s58, v21
    ds_write_b64 v21, v[208:209] offset:16384
    ds_write_b64 v21, v[210:211] offset:16400
    ds_write_b64 v21, v[212:213] offset:16416
    v_lshlrev_b32 v22, 2, v2
    v_bfe_u32 v23, v1, 2, 2
    v_add_u32 v22, v22, v23
    v_mul_u32_u24 v22, 72, v22
    v_bfe_u32 v23, v1, 4, 1
    v_lshl_add_u32 v22, v23, 5, v22
    v_and_b32 v23, 3, v1
    v_lshl_add_u32 v22, v23, 3, v22
    v_add_u32 v22, s58, v22
    s_waitcnt lgkmcnt(0)
    ds_read_b64_tr_b16 v[168:169], v22 offset:16384
    ds_read_b64_tr_b16 v[170:171], v22 offset:16960
    ds_read_b64_tr_b16 v[172:173], v22 offset:17536
    ds_read_b64_tr_b16 v[174:175], v22 offset:18112
    v_min_u32 v23, 21, v3
    v_lshlrev_b32 v23, 4, v23
    v_mul_u32_u24 v24, 352, v2
    v_add_u32 v23, v23, v24
    s_mul_i32 s63, s62, 3072
    s_add_u32 s63, s63, 2621440
    s_waitcnt lgkmcnt(0)
    s_mov_b32 exec_lo, 0x00100000
    s_mov_b32 exec_hi, 0x00100000
    v_mov_b32 v168, 0x3f803f80
    v_mov_b32 v169, 0x3f803f80
    v_mov_b32 v170, 0x3f803f80
    v_mov_b32 v171, 0x3f803f80
    v_mov_b32 v172, 0x3f803f80
    v_mov_b32 v173, 0x3f803f80
    v_mov_b32 v174, 0x3f803f80
    v_mov_b32 v175, 0x3f803f80
    s_mov_b32 exec_lo, 0x00200000
    s_mov_b32 exec_hi, 0x00200000
    v_mov_b32 v168, 0
    v_mov_b32 v169, 0
    v_mov_b32 v170, 0
    v_mov_b32 v171, 0
    v_mov_b32 v172, 0
    v_mov_b32 v173, 0
    v_mov_b32 v174, 0
    v_mov_b32 v175, 0
    s_mov_b32 exec_lo, 4194303
    s_mov_b32 exec_hi, 4194303
    buffer_store_dwordx4 v[168:171], v23, s[40:43], s63 offen offset:1536 sc1
    buffer_store_dwordx4 v[172:175], v23, s[40:43], s63 offen offset:2240 sc1
    s_mov_b64 exec, -1
M_tail_done:
    v_mov_b32 v20, v81
    v_mov_b32 v21, s69
    s_mov_b32 s63, 2850816
    s_mov_b32 exec_lo, 0x80000000
    s_mov_b32 exec_hi, 0x80000000
    buffer_store_dwordx2 v[20:21], v82, s[40:43], s63 offen sc1
    s_mov_b64 exec, -1
    s_barrier
    ds_read_b64_tr_b16 v[32:33], v72 offset:32768
    ds_read_b64_tr_b16 v[34:35], v72 offset:33280
    ds_read_b64_tr_b16 v[36:37], v73 offset:32768
    ds_read_b64_tr_b16 v[38:39], v73 offset:33280
    ds_read_b64_tr_b16 v[40:41], v72 offset:34816
    ds_read_b64_tr_b16 v[42:43], v72 offset:35328
    ds_read_b64_tr_b16 v[44:45], v73 offset:34816
    ds_read_b64_tr_b16 v[46:47], v73 offset:35328
    ds_read_b64_tr_b16 v[48:49], v72 offset:36864
    ds_read_b64_tr_b16 v[50:51], v72 offset:37376
    ds_read_b64_tr_b16 v[52:53], v73 offset:36864
    ds_read_b64_tr_b16 v[54:55], v73 offset:37376
    s_waitcnt lgkmcnt(8)
    v_mfma_f32_32x32x16_bf16 v[104:119], v[32:35], a[64:67], v[104:119]
    s_add_u32 m0, s58, 0
    s_mul_i32 s67, s12, 1728
    ds_read_b64_tr_b16 v[56:57], v72 offset:38912
    ds_read_b64_tr_b16 v[58:59], v72 offset:39424
    buffer_load_dwordx4 v238, s[28:31], s67 offen lds
    v_mfma_f32_32x32x16_bf16 v[120:135], v[36:39], a[64:67], v[120:135]
    s_add_u32 m0, s58, 1024
    s_mul_i32 s67, s13, 1728
    ds_read_b64_tr_b16 v[32:33], v73 offset:38912
    ds_read_b64_tr_b16 v[34:35], v73 offset:39424
    buffer_load_dwordx4 v238, s[28:31], s67 offen lds
    s_waitcnt lgkmcnt(8)
    v_mfma_f32_32x32x16_bf16 v[104:119], v[40:43], a[68:71], v[104:119]
    s_add_u32 m0, s58, 2048
    s_mul_i32 s67, s14, 1728
    ds_read_b64_tr_b16 v[36:37], v72 offset:40960
    ds_read_b64_tr_b16 v[38:39], v72 offset:41472
    buffer_load_dwordx4 v238, s[28:31], s67 offen lds
    v_mfma_f32_32x32x16_bf16 v[120:135], v[44:47], a[68:71], v[120:135]
    s_add_u32 m0, s58, 3072
    s_mul_i32 s67, s15, 1728
    ds_read_b64_tr_b16 v[40:41], v73 offset:40960
    ds_read_b64_tr_b16 v[42:43], v73 offset:41472
    buffer_load_dwordx4 v238, s[28:31], s67 offen lds
    s_waitcnt lgkmcnt(8)
    v_mfma_f32_32x32x16_bf16 v[104:119], v[48:51], a[72:75], v[104:119]
    s_add_u32 m0, s59, 0
    s_mul_i32 s67, s16, 1728
    ds_read_b64_tr_b16 v[44:45], v72 offset:43008
    ds_read_b64_tr_b16 v[46:47], v72 offset:43520
    buffer_load_dwordx4 v238, s[28:31], s67 offen lds
    v_mfma_f32_32x32x16_bf16 v[120:135], v[52:55], a[72:75], v[120:135]
    s_add_u32 m0, s59, 4096
    s_mul_i32 s67, s17, 1728
    ds_read_b64_tr_b16 v[48:49], v73 offset:43008
    ds_read_b64_tr_b16 v[50:51], v73 offset:43520
    buffer_load_dwordx4 v238, s[28:31], s67 offen lds
    s_waitcnt lgkmcnt(8)
    v_mfma_f32_32x32x16_bf16 v[104:119], v[56:59], a[76:79], v[104:119]
    ds_read_b64_tr_b16 v[52:53], v72 offset:45056
    ds_read_b64_tr_b16 v[54:55], v72 offset:45568
    v_mfma_f32_32x32x16_bf16 v[120:135], v[32:35], a[76:79], v[120:135]
    ds_read_b64_tr_b16 v[56:57], v73 offset:45056
    ds_read_b64_tr_b16 v[58:59], v73 offset:45568
    s_waitcnt lgkmcnt(8)
    v_mfma_f32_32x32x16_bf16 v[104:119], v[36:39], a[80:83], v[104:119]
    ds_read_b64_tr_b16 v[32:33], v72 offset:47104
    ds_read_b64_tr_b16 v[34:35], v72 offset:47616
    v_mfma_f32_32x32x16_bf16 v[120:135], v[40:43], a[80:83], v[120:135]
    ds_read_b64_tr_b16 v[36:37], v73 offset:47104
    ds_read_b64_tr_b16 v[38:39], v73 offset:47616
    s_waitcnt lgkmcnt(8)
    v_mfma_f32_32x32x16_bf16 v[104:119], v[44:47], a[84:87], v[104:119]
    s_waitcnt vmcnt(11)
    s_barrier
    ds_read_b64_tr_b16 v[40:41], v76 offset:0
    ds_read_b64_tr_b16 v[42:43], v76 offset:512
    v_mfma_f32_32x32x16_bf16 v[120:135], v[48:51], a[84:87], v[120:135]
    ds_read_b64_tr_b16 v[44:45], v77 offset:0
    ds_read_b64_tr_b16 v[46:47], v77 offset:512
    s_waitcnt lgkmcnt(8)
    v_mfma_f32_32x32x16_bf16 v[104:119], v[52:55], a[88:91], v[104:119]
    ds_read_b64_tr_b16 v[48:49], v76 offset:4096
    ds_read_b64_tr_b16 v[50:51], v76 offset:4608
    v_mfma_f32_32x32x16_bf16 v[120:135], v[56:59], a[88:91], v[120:135]
    ds_read_b64_tr_b16 v[52:53], v77 offset:4096
    ds_read_b64_tr_b16 v[54:55], v77 offset:4608
    s_waitcnt lgkmcnt(8)
    v_mfma_f32_32x32x16_bf16 v[104:119], v[32:35], a[92:95], v[104:119]
    ds_read_b64_tr_b16 v[56:57], v76 offset:8192
    ds_read_b64_tr_b16 v[58:59], v76 offset:8704
    v_mfma_f32_32x32x16_bf16 v[120:135], v[36:39], a[92:95], v[120:135]
    ds_read_b64_tr_b16 v[32:33], v77 offset:8192
    ds_read_b64_tr_b16 v[34:35], v77 offset:8704
    s_waitcnt lgkmcnt(8)
    v_mfma_f32_32x32x16_bf16 v[104:119], v[40:43], a[96:99], v[104:119]
    ds_read_b64_tr_b16 v[36:37], v76 offset:12288
    ds_read_b64_tr_b16 v[38:39], v76 offset:12800
    v_mfma_f32_32x32x16_bf16 v[120:135], v[44:47], a[96:99], v[120:135]
    ds_read_b64_tr_b16 v[40:41], v77 offset:12288
    ds_read_b64_tr_b16 v[42:43], v77 offset:12800
    s_waitcnt lgkmcnt(8)
    v_mfma_f32_32x32x16_bf16 v[104:119], v[48:51], a[100:103], v[104:119]
    ds_read_b64_tr_b16 v[44:45], v76 offset:2048
    ds_read_b64_tr_b16 v[46:47], v76 offset:2560
    v_mfma_f32_32x32x16_bf16 v[120:135], v[52:55], a[100:103], v[120:135]
    ds_read_b64_tr_b16 v[48:49], v77 offset:2048
    ds_read_b64_tr_b16 v[50:51], v77 offset:2560
    s_waitcnt lgkmcnt(8)
    v_mfma_f32_32x32x16_bf16 v[104:119], v[56:59], a[104:107], v[104:119]
    ds_read_b64_tr_b16 v[52:53], v76 offset:6144
    ds_read_b64_tr_b16 v[54:55], v76 offset:6656
    s_and_b32 s63, s2, 7
    s_lshl_b32 s63, s63, 20
    s_lshr_b32 s64, s2, 3
    s_lshl_b32 s64, s64, 15
    s_add_u32 s63, s63, s64
    s_lshl_b32 s64, s3, 13
    s_add_u32 s63, s63, s64
    v_bfe_u32 v252, v1, 2, 3
    v_lshlrev_b32 v252, 7, v252
    v_lshl_add_u32 v252, v2, 12, v252
    v_add_u32 v252, s63, v252
    global_load_dword v253, v252, s[72:73]
    v_mfma_f32_32x32x16_bf16 v[120:135], v[32:35], a[104:107], v[120:135]
    ds_read_b64_tr_b16 v[56:57], v77 offset:6144
    ds_read_b64_tr_b16 v[58:59], v77 offset:6656
    s_waitcnt lgkmcnt(8)
    v_mfma_f32_32x32x16_bf16 v[104:119], v[36:39], a[108:111], v[104:119]
    ds_read_b64_tr_b16 v[32:33], v76 offset:10240
    ds_read_b64_tr_b16 v[34:35], v76 offset:10752
    v_mfma_f32_32x32x16_bf16 v[120:135], v[40:43], a[108:111], v[120:135]
    ds_read_b64_tr_b16 v[36:37], v77 offset:10240
    ds_read_b64_tr_b16 v[38:39], v77 offset:10752
    s_waitcnt lgkmcnt(8)
    v_mfma_f32_32x32x16_bf16 v[104:119], v[44:47], a[112:115], v[104:119]
    ds_read_b64_tr_b16 v[40:41], v76 offset:14336
    ds_read_b64_tr_b16 v[42:43], v76 offset:14848
    v_mfma_f32_32x32x16_bf16 v[120:135], v[48:51], a[112:115], v[120:135]
    ds_read_b64_tr_b16 v[44:45], v77 offset:14336
    ds_read_b64_tr_b16 v[46:47], v77 offset:14848
    s_waitcnt lgkmcnt(8)
    v_mfma_f32_32x32x16_bf16 v[104:119], v[52:55], a[116:119], v[104:119]
    s_waitcnt vmcnt(8)
    s_barrier
    ds_read_b64_tr_b16 v[48:49], v76 offset:16384
    ds_read_b64_tr_b16 v[50:51], v76 offset:16896
    v_mfma_f32_32x32x16_bf16 v[120:135], v[56:59], a[116:119], v[120:135]
    ds_read_b64_tr_b16 v[52:53], v77 offset:16384
    ds_read_b64_tr_b16 v[54:55], v77 offset:16896
    s_waitcnt lgkmcnt(8)
    v_mfma_f32_32x32x16_bf16 v[104:119], v[32:35], a[120:123], v[104:119]
    ds_read_b64_tr_b16 v[56:57], v76 offset:20480
    ds_read_b64_tr_b16 v[58:59], v76 offset:20992
    v_mfma_f32_32x32x16_bf16 v[120:135], v[36:39], a[120:123], v[120:135]
    ds_read_b64_tr_b16 v[32:33], v77 offset:20480
    ds_read_b64_tr_b16 v[34:35], v77 offset:20992
    s_waitcnt lgkmcnt(8)
    v_mfma_f32_32x32x16_bf16 v[104:119], v[40:43], a[124:127], v[104:119]
    ds_read_b64_tr_b16 v[36:37], v76 offset:24576
    ds_read_b64_tr_b16 v[38:39], v76 offset:25088
    v_mfma_f32_32x32x16_bf16 v[120:135], v[44:47], a[124:127], v[120:135]
    ds_read_b64_tr_b16 v[40:41], v77 offset:24576
    ds_read_b64_tr_b16 v[42:43], v77 offset:25088
    s_waitcnt lgkmcnt(8)
    v_mfma_f32_32x32x16_bf16 v[104:119], v[48:51], a[128:131], v[104:119]
    ds_read_b64_tr_b16 v[44:45], v76 offset:28672
    ds_read_b64_tr_b16 v[46:47], v76 offset:29184
    v_mfma_f32_32x32x16_bf16 v[120:135], v[52:55], a[128:131], v[120:135]
    ds_read_b64_tr_b16 v[48:49], v77 offset:28672
    ds_read_b64_tr_b16 v[50:51], v77 offset:29184
    s_waitcnt lgkmcnt(8)
    v_mfma_f32_32x32x16_bf16 v[104:119], v[56:59], a[132:135], v[104:119]
    ds_read_b64_tr_b16 v[52:53], v76 offset:18432
    ds_read_b64_tr_b16 v[54:55], v76 offset:18944
    v_mfma_f32_32x32x16_bf16 v[120:135], v[32:35], a[132:135], v[120:135]
    ds_read_b64_tr_b16 v[56:57], v77 offset:18432
    ds_read_b64_tr_b16 v[58:59], v77 offset:18944
    s_waitcnt lgkmcnt(8)
    v_mfma_f32_32x32x16_bf16 v[104:119], v[36:39], a[136:139], v[104:119]
    ds_read_b64_tr_b16 v[32:33], v76 offset:22528
    ds_read_b64_tr_b16 v[34:35], v76 offset:23040
    v_mfma_f32_32x32x16_bf16 v[120:135], v[40:43], a[136:139], v[120:135]
    ds_read_b64_tr_b16 v[36:37], v77 offset:22528
    ds_read_b64_tr_b16 v[38:39], v77 offset:23040
    s_waitcnt lgkmcnt(8)
    v_mfma_f32_32x32x16_bf16 v[104:119], v[44:47], a[140:143], v[104:119]
    ds_read_b64_tr_b16 v[40:41], v76 offset:26624
    ds_read_b64_tr_b16 v[42:43], v76 offset:27136
    v_mfma_f32_32x32x16_bf16 v[120:135], v[48:51], a[140:143], v[120:135]
    ds_read_b64_tr_b16 v[44:45], v77 offset:26624
    ds_read_b64_tr_b16 v[46:47], v77 offset:27136
    s_waitcnt lgkmcnt(8)
    v_mfma_f32_32x32x16_bf16 v[104:119], v[52:55], a[144:147], v[104:119]
    ds_read_b64_tr_b16 v[48:49], v76 offset:30720
    ds_read_b64_tr_b16 v[50:51], v76 offset:31232
    v_mfma_f32_32x32x16_bf16 v[120:135], v[56:59], a[144:147], v[120:135]
    ds_read_b64_tr_b16 v[52:53], v77 offset:30720
    ds_read_b64_tr_b16 v[54:55], v77 offset:31232
    s_waitcnt lgkmcnt(8)
    v_mfma_f32_32x32x16_bf16 v[104:119], v[32:35], a[148:151], v[104:119]
    v_mfma_f32_32x32x16_bf16 v[120:135], v[36:39], a[148:151], v[120:135]
    s_waitcnt lgkmcnt(4)
    v_mfma_f32_32x32x16_bf16 v[104:119], v[40:43], a[152:155], v[104:119]
    s_waitcnt vmcnt(7)
    s_lshl_b32 s63, s5, 8
    s_lshl_b32 s64, s62, 2
    s_add_u32 s63, s63, s64
    s_add_u32 s63, s63, 2834432
    v_mov_b32 v20, s69
    v_mov_b32 v21, 0
    s_mov_b64 exec, 1
    buffer_store_dword v20, v21, s[40:43], s63 offen sc1
    s_mov_b64 exec, -1
    v_mfma_f32_32x32x16_bf16 v[120:135], v[44:47], a[152:155], v[120:135]
    s_waitcnt lgkmcnt(0)
    v_mfma_f32_32x32x16_bf16 v[104:119], v[48:51], a[156:159], v[104:119]
    v_mfma_f32_32x32x16_bf16 v[120:135], v[52:55], a[156:159], v[120:135]
    s_nop 10
    v_pk_mul_f32 v[168:169], v[104:105], v[104:105]
    v_pk_mul_f32 v[170:171], v[106:107], v[106:107]
    v_pk_mul_f32 v[172:173], v[108:109], v[108:109]
    v_pk_mul_f32 v[174:175], v[110:111], v[110:111]
    v_pk_mul_f32 v[176:177], v[112:113], v[112:113]
    v_pk_mul_f32 v[178:179], v[114:115], v[114:115]
    v_pk_mul_f32 v[180:181], v[116:117], v[116:117]
    v_pk_mul_f32 v[182:183], v[118:119], v[118:119]
    v_pk_fma_f32 v[168:169], v[168:169], v[62:63], v[60:61]
    v_pk_fma_f32 v[170:171], v[170:171], v[62:63], v[60:61]
    v_pk_fma_f32 v[172:173], v[172:173], v[62:63], v[60:61]
    v_pk_fma_f32 v[174:175], v[174:175], v[62:63], v[60:61]
    v_pk_fma_f32 v[176:177], v[176:177], v[62:63], v[60:61]
    v_pk_fma_f32 v[178:179], v[178:179], v[62:63], v[60:61]
    v_pk_fma_f32 v[180:181], v[180:181], v[62:63], v[60:61]
    v_pk_fma_f32 v[182:183], v[182:183], v[62:63], v[60:61]
    v_pk_mul_f32 v[168:169], v[168:169], v[104:105]
    v_pk_mul_f32 v[170:171], v[170:171], v[106:107]
    v_pk_mul_f32 v[172:173], v[172:173], v[108:109]
    v_pk_mul_f32 v[174:175], v[174:175], v[110:111]
    v_pk_mul_f32 v[176:177], v[176:177], v[112:113]
    v_pk_mul_f32 v[178:179], v[178:179], v[114:115]
    v_pk_mul_f32 v[180:181], v[180:181], v[116:117]
    v_pk_mul_f32 v[182:183], v[182:183], v[118:119]
    v_exp_f32 v168, v168
    v_exp_f32 v169, v169
    v_exp_f32 v170, v170
    v_exp_f32 v171, v171
    v_exp_f32 v172, v172
    v_exp_f32 v173, v173
    v_exp_f32 v174, v174
    v_exp_f32 v175, v175
    v_exp_f32 v176, v176
    v_exp_f32 v177, v177
    v_exp_f32 v178, v178
    v_exp_f32 v179, v179
    v_exp_f32 v180, v180
    v_exp_f32 v181, v181
    v_exp_f32 v182, v182
    v_exp_f32 v183, v183
    v_pk_add_f32 v[168:169], v[168:169], v[64:65]
    v_pk_add_f32 v[170:171], v[170:171], v[64:65]
    v_pk_add_f32 v[172:173], v[172:173], v[64:65]
    v_pk_add_f32 v[174:175], v[174:175], v[64:65]
    v_pk_add_f32 v[176:177], v[176:177], v[64:65]
    v_pk_add_f32 v[178:179], v[178:179], v[64:65]
    v_pk_add_f32 v[180:181], v[180:181], v[64:65]
    v_pk_add_f32 v[182:183], v[182:183], v[64:65]
    v_rcp_f32 v168, v168
    v_rcp_f32 v169, v169
    v_rcp_f32 v170, v170
    v_rcp_f32 v171, v171
    v_rcp_f32 v172, v172
    v_rcp_f32 v173, v173
    v_rcp_f32 v174, v174
    v_rcp_f32 v175, v175
    v_rcp_f32 v176, v176
    v_rcp_f32 v177, v177
    v_rcp_f32 v178, v178
    v_rcp_f32 v179, v179
    v_rcp_f32 v180, v180
    v_rcp_f32 v181, v181
    v_rcp_f32 v182, v182
    v_rcp_f32 v183, v183
    v_pk_mul_f32 v[104:105], v[104:105], v[168:169]
    v_pk_mul_f32 v[106:107], v[106:107], v[170:171]
    v_pk_mul_f32 v[108:109], v[108:109], v[172:173]
    v_pk_mul_f32 v[110:111], v[110:111], v[174:175]
    v_pk_mul_f32 v[112:113], v[112:113], v[176:177]
    v_pk_mul_f32 v[114:115], v[114:115], v[178:179]
    v_pk_mul_f32 v[116:117], v[116:117], v[180:181]
    v_pk_mul_f32 v[118:119], v[118:119], v[182:183]
    v_pk_add_f32 v[20:21], v[104:105], v[106:107]
    v_pk_mul_f32 v[22:23], v[104:105], v[104:105]
    v_pk_fma_f32 v[22:23], v[106:107], v[106:107], v[22:23]
    v_pk_add_f32 v[20:21], v[20:21], v[108:109]
    v_pk_fma_f32 v[22:23], v[108:109], v[108:109], v[22:23]
    v_pk_add_f32 v[20:21], v[20:21], v[110:111]
    v_pk_fma_f32 v[22:23], v[110:111], v[110:111], v[22:23]
    v_pk_add_f32 v[20:21], v[20:21], v[112:113]
    v_pk_fma_f32 v[22:23], v[112:113], v[112:113], v[22:23]
    v_pk_add_f32 v[20:21], v[20:21], v[114:115]
    v_pk_fma_f32 v[22:23], v[114:115], v[114:115], v[22:23]
    v_pk_add_f32 v[20:21], v[20:21], v[116:117]
    v_pk_fma_f32 v[22:23], v[116:117], v[116:117], v[22:23]
    v_pk_add_f32 v[20:21], v[20:21], v[118:119]
    v_pk_fma_f32 v[22:23], v[118:119], v[118:119], v[22:23]
    v_add_f32 v20, v20, v21
    v_add_f32 v22, v22, v23
    v_pk_mul_f32 v[168:169], v[120:121], v[120:121]
    v_pk_mul_f32 v[170:171], v[122:123], v[122:123]
    v_pk_mul_f32 v[172:173], v[124:125], v[124:125]
    v_pk_mul_f32 v[174:175], v[126:127], v[126:127]
    v_pk_mul_f32 v[176:177], v[128:129], v[128:129]
    v_pk_mul_f32 v[178:179], v[130:131], v[130:131]
    v_pk_mul_f32 v[180:181], v[132:133], v[132:133]
    v_pk_mul_f32 v[182:183], v[134:135], v[134:135]
    v_pk_fma_f32 v[168:169], v[168:169], v[62:63], v[60:61]
    v_pk_fma_f32 v[170:171], v[170:171], v[62:63], v[60:61]
    v_pk_fma_f32 v[172:173], v[172:173], v[62:63], v[60:61]
    v_pk_fma_f32 v[174:175], v[174:175], v[62:63], v[60:61]
    v_pk_fma_f32 v[176:177], v[176:177], v[62:63], v[60:61]
    v_pk_fma_f32 v[178:179], v[178:179], v[62:63], v[60:61]
    v_pk_fma_f32 v[180:181], v[180:181], v[62:63], v[60:61]
    v_pk_fma_f32 v[182:183], v[182:183], v[62:63], v[60:61]
    v_pk_mul_f32 v[168:169], v[168:169], v[120:121]
    v_pk_mul_f32 v[170:171], v[170:171], v[122:123]
    v_pk_mul_f32 v[172:173], v[172:173], v[124:125]
    v_pk_mul_f32 v[174:175], v[174:175], v[126:127]
    v_pk_mul_f32 v[176:177], v[176:177], v[128:129]
    v_pk_mul_f32 v[178:179], v[178:179], v[130:131]
    v_pk_mul_f32 v[180:181], v[180:181], v[132:133]
    v_pk_mul_f32 v[182:183], v[182:183], v[134:135]
    v_exp_f32 v168, v168
    v_exp_f32 v169, v169
    v_exp_f32 v170, v170
    v_exp_f32 v171, v171
    v_exp_f32 v172, v172
    v_exp_f32 v173, v173
    v_exp_f32 v174, v174
    v_exp_f32 v175, v175
    v_exp_f32 v176, v176
    v_exp_f32 v177, v177
    v_exp_f32 v178, v178
    v_exp_f32 v179, v179
    v_exp_f32 v180, v180
    v_exp_f32 v181, v181
    v_exp_f32 v182, v182
    v_exp_f32 v183, v183
    v_pk_add_f32 v[168:169], v[168:169], v[64:65]
    v_pk_add_f32 v[170:171], v[170:171], v[64:65]
    v_pk_add_f32 v[172:173], v[172:173], v[64:65]
    v_pk_add_f32 v[174:175], v[174:175], v[64:65]
    v_pk_add_f32 v[176:177], v[176:177], v[64:65]
    v_pk_add_f32 v[178:179], v[178:179], v[64:65]
    v_pk_add_f32 v[180:181], v[180:181], v[64:65]
    v_pk_add_f32 v[182:183], v[182:183], v[64:65]
    v_rcp_f32 v168, v168
    v_rcp_f32 v169, v169
    v_rcp_f32 v170, v170
    v_rcp_f32 v171, v171
    v_rcp_f32 v172, v172
    v_rcp_f32 v173, v173
    v_rcp_f32 v174, v174
    v_rcp_f32 v175, v175
    v_rcp_f32 v176, v176
    v_rcp_f32 v177, v177
    v_rcp_f32 v178, v178
    v_rcp_f32 v179, v179
    v_rcp_f32 v180, v180
    v_rcp_f32 v181, v181
    v_rcp_f32 v182, v182
    v_rcp_f32 v183, v183
    v_pk_mul_f32 v[120:121], v[120:121], v[168:169]
    v_pk_mul_f32 v[122:123], v[122:123], v[170:171]
    v_pk_mul_f32 v[124:125], v[124:125], v[172:173]
    v_pk_mul_f32 v[126:127], v[126:127], v[174:175]
    v_pk_mul_f32 v[128:129], v[128:129], v[176:177]
    v_pk_mul_f32 v[130:131], v[130:131], v[178:179]
    v_pk_mul_f32 v[132:133], v[132:133], v[180:181]
    v_pk_mul_f32 v[134:135], v[134:135], v[182:183]
    s_waitcnt vmcnt(2)
    s_barrier
    ds_read_b64_tr_b16 v[56:57], v79 offset:16384
    ds_read_b64_tr_b16 v[58:59], v79 offset:16896
    ds_read_b64_tr_b16 v[32:33], v79 offset:17408
    ds_read_b64_tr_b16 v[34:35], v79 offset:17920
    ds_read_b64_tr_b16 v[36:37], v79 offset:18432
    ds_read_b64_tr_b16 v[38:39], v79 offset:18944
    ds_read_b64_tr_b16 v[40:41], v79 offset:19456
    ds_read_b64_tr_b16 v[42:43], v79 offset:19968
    ds_read_b64_tr_b16 v[44:45], v79 offset:20480
    ds_read_b64_tr_b16 v[46:47], v79 offset:20992
    ds_read_b64_tr_b16 v[48:49], v79 offset:21504
    ds_read_b64_tr_b16 v[50:51], v79 offset:22016
    v_pk_add_f32 v[24:25], v[120:121], v[122:123]
    v_pk_mul_f32 v[26:27], v[120:121], v[120:121]
    v_pk_fma_f32 v[26:27], v[122:123], v[122:123], v[26:27]
    v_pk_add_f32 v[24:25], v[24:25], v[124:125]
    v_pk_fma_f32 v[26:27], v[124:125], v[124:125], v[26:27]
    v_pk_add_f32 v[24:25], v[24:25], v[126:127]
    v_pk_fma_f32 v[26:27], v[126:127], v[126:127], v[26:27]
    v_pk_add_f32 v[24:25], v[24:25], v[128:129]
    v_pk_fma_f32 v[26:27], v[128:129], v[128:129], v[26:27]
    v_pk_add_f32 v[24:25], v[24:25], v[130:131]
    v_pk_fma_f32 v[26:27], v[130:131], v[130:131], v[26:27]
    v_pk_add_f32 v[24:25], v[24:25], v[132:133]
    v_pk_fma_f32 v[26:27], v[132:133], v[132:133], v[26:27]
    v_pk_add_f32 v[24:25], v[24:25], v[134:135]
    v_pk_fma_f32 v[26:27], v[134:135], v[134:135], v[26:27]
    v_add_f32 v24, v24, v25
    v_add_f32 v26, v26, v27
    v_mul_f32 v28, s55, v20
    v_mul_f32 v30, s55, v22
    v_fma_f32 v28, s56, v24, v28
    v_fma_f32 v30, s56, v26, v30
    v_mov_b32 v20, v28
    v_mov_b32 v21, v30
    v_mov_b32 v29, s69
    v_permlane32_swap_b32 v28, v20
    v_permlane32_swap_b32 v30, v21
    v_add_f32 v28, v28, v20
    v_add_f32 v30, v30, v21
    v_mov_b32 v31, s69
    s_lshl_b32 s63, s62, 13
    s_add_u32 s63, s63, 2883584
    s_lshl_b32 s64, s5, 9
    s_add_u32 s63, s63, s64
    s_mov_b32 exec_hi, 0
    buffer_store_dwordx4 v[28:31], v4, s[40:43], s63 offen sc1
    s_mov_b64 exec, -1
    s_waitcnt lgkmcnt(8)
    v_mfma_f32_32x32x16_bf16 v[84:99], v[56:59], a[0:3], 0
    ds_read_b64_tr_b16 v[52:53], v79 offset:22528
    ds_read_b64_tr_b16 v[54:55], v79 offset:23040
    s_lshr_b32 s8, s2, 2
    s_and_b32 s9, s2, 3
    s_lshl_b32 s9, s9, 3
    v_mfma_f32_32x32x16_bf16 v[84:99], v[32:35], a[4:7], v[84:99]
    ds_read_b64_tr_b16 v[56:57], v79 offset:23552
    ds_read_b64_tr_b16 v[58:59], v79 offset:24064
    s_lshl_b32 s63, s3, 1
    s_add_u32 s9, s9, s63
    v_lshlrev_b32 v218, 2, v1
    s_waitcnt lgkmcnt(8)
    v_mfma_f32_32x32x16_bf16 v[84:99], v[36:39], a[8:11], v[84:99]
    ds_read_b64_tr_b16 v[32:33], v79 offset:24576
    ds_read_b64_tr_b16 v[34:35], v79 offset:25088
    v_add_u32 v218, 2837248, v218
    v_and_b32 v16, 1, v1
    v_mul_u32_u24 v16, 39, v16
    v_mfma_f32_32x32x16_bf16 v[84:99], v[40:43], a[12:15], v[84:99]
    ds_read_b64_tr_b16 v[36:37], v79 offset:25600
    ds_read_b64_tr_b16 v[38:39], v79 offset:26112
    s_mul_i32 s63, s9, 20
    v_add_u32 v16, s63, v16
    v_lshrrev_b32 v16, 6, v16
    s_waitcnt lgkmcnt(8)
    v_mfma_f32_32x32x16_bf16 v[84:99], v[44:47], a[16:19], v[84:99]
    ds_read_b64_tr_b16 v[40:41], v79 offset:26624
    ds_read_b64_tr_b16 v[42:43], v79 offset:27136
    v_lshlrev_b32 v16, 8, v16
    s_lshl_b32 s63, s8, 2
    s_add_u32 s63, s63, 2834688
    v_mfma_f32_32x32x16_bf16 v[84:99], v[48:51], a[20:23], v[84:99]
    ds_read_b64_tr_b16 v[44:45], v79 offset:27648
    ds_read_b64_tr_b16 v[46:47], v79 offset:28160
    v_add_u32 v219, s63, v16
    s_lshr_b32 s63, s2, 3
    s_mul_i32 s64, s63, 37
    s_waitcnt lgkmcnt(8)
    v_mfma_f32_32x32x16_bf16 v[84:99], v[52:55], a[24:27], v[84:99]
    ds_read_b64_tr_b16 v[48:49], v79 offset:28672
    ds_read_b64_tr_b16 v[50:51], v79 offset:29184
    s_lshr_b32 s64, s64, 8
    s_mul_i32 s65, s64, 7
    s_sub_u32 s65, s63, s65
    v_mfma_f32_32x32x16_bf16 v[84:99], v[56:59], a[28:31], v[84:99]
    ds_read_b64_tr_b16 v[52:53], v79 offset:29696
    ds_read_b64_tr_b16 v[54:55], v79 offset:30208
    s_and_b32 s64, s64, 3
    s_and_b32 s10, s2, 7
    s_lshl_b32 s10, s10, 2
    s_waitcnt lgkmcnt(8)
    v_mfma_f32_32x32x16_bf16 v[84:99], v[32:35], a[32:35], v[84:99]
    ds_read_b64_tr_b16 v[56:57], v79 offset:30720
    ds_read_b64_tr_b16 v[58:59], v79 offset:31232
    s_add_u32 s10, s10, s64
    s_lshl_b32 s11, s65, 2
    s_add_u32 s11, s11, s3
    v_mfma_f32_32x32x16_bf16 v[84:99], v[36:39], a[36:39], v[84:99]
    ds_read_b64_tr_b16 v[32:33], v79 offset:31744
    ds_read_b64_tr_b16 v[34:35], v79 offset:32256
    s_mov_b32 s22, 0x40000000
    s_cmp_lt_u32 s63, 28
    s_cselect_b32 s12, 1, 0
    s_cselect_b32 s16, 0, s22
    s_cmp_lt_u32 s11, 27
    s_cselect_b32 s12, s12, 0
    s_waitcnt lgkmcnt(8)
    v_mfma_f32_32x32x16_bf16 v[84:99], v[40:43], a[40:43], v[84:99]
    ds_read_b64_tr_b16 v[36:37], v79 offset:32768
    ds_read_b64_tr_b16 v[38:39], v79 offset:33280
    s_lshl_b32 s63, s10, 6
    s_lshl_b32 s64, s3, 4
    s_add_u32 s63, s63, s64
    v_mfma_f32_32x32x16_bf16 v[84:99], v[44:47], a[44:47], v[84:99]
    ds_read_b64_tr_b16 v[40:41], v79 offset:36864
    ds_read_b64_tr_b16 v[42:43], v79 offset:37376
    v_lshrrev_b32 v16, 3, v1
    v_add_u32 v16, s63, v16
    v_lshlrev_b32 v16, 12, v16
    s_waitcnt lgkmcnt(8)
    v_mfma_f32_32x32x16_bf16 v[84:99], v[48:51], a[48:51], v[84:99]
    ds_read_b64_tr_b16 v[44:45], v79 offset:40960
    ds_read_b64_tr_b16 v[46:47], v79 offset:41472
    v_and_b32 v17, 7, v1
    v_lshrrev_b32 v18, 4, v1
    v_xor_b32 v17, v17, v18
    v_mfma_f32_32x32x16_bf16 v[84:99], v[52:55], a[52:55], v[84:99]
    ds_read_b64_tr_b16 v[48:49], v79 offset:45056
    ds_read_b64_tr_b16 v[50:51], v79 offset:45568
    v_lshlrev_b32 v17, 4, v17
    v_add_u32 v13, v16, v17
    v_xor_b32 v17, 64, v17
    s_waitcnt lgkmcnt(8)
    v_mfma_f32_32x32x16_bf16 v[84:99], v[56:59], a[56:59], v[84:99]
    ds_read_b64_tr_b16 v[52:53], v79 offset:33792
    ds_read_b64_tr_b16 v[54:55], v79 offset:34304
    v_add_u32 v14, v16, v17
    v_add_u32 v14, 32768, v14
    s_mul_i32 s63, s3, 3072
    v_mfma_f32_32x32x16_bf16 v[84:99], v[32:35], a[60:63], v[84:99]
    ds_read_b64_tr_b16 v[56:57], v79 offset:37888
    ds_read_b64_tr_b16 v[58:59], v79 offset:38400
    v_add_u32 v15, s63, v4
    s_add_u32 s14, s63, 65536
    s_add_u32 s15, s14, 32768
    s_waitcnt lgkmcnt(8)
    v_mfma_f32_32x32x16_bf16 v[84:99], v[36:39], a[64:67], v[84:99]
    ds_read_b64_tr_b16 v[32:33], v79 offset:41984
    ds_read_b64_tr_b16 v[34:35], v79 offset:42496
    s_lshl_b32 s13, s3, 11
    s_lshl_b32 s18, s11, 17
    s_add_u32 s18, s18, 3407872
    v_mfma_f32_32x32x16_bf16 v[84:99], v[40:43], a[68:71], v[84:99]
    ds_read_b64_tr_b16 v[36:37], v79 offset:46080
    ds_read_b64_tr_b16 v[38:39], v79 offset:46592
    s_add_u32 s21, s18, 131072
    s_cmp_eq_u32 s12, 0
    s_cselect_b32 s18, s22, s18
    s_mov_b32 s17, 0
    s_waitcnt lgkmcnt(8)
    v_mfma_f32_32x32x16_bf16 v[84:99], v[44:47], a[72:75], v[84:99]
    ds_read_b64_tr_b16 v[40:41], v79 offset:34816
    ds_read_b64_tr_b16 v[42:43], v79 offset:35328
    v_mov_b32 v144, 0
    v_mov_b32 v145, 0
    v_mov_b32 v146, 0
    v_mfma_f32_32x32x16_bf16 v[84:99], v[48:51], a[76:79], v[84:99]
    ds_read_b64_tr_b16 v[44:45], v79 offset:38912
    ds_read_b64_tr_b16 v[46:47], v79 offset:39424
    v_mov_b32 v147, 0
    s_mov_b32 s24, s72
    s_mov_b32 s25, s73
    s_waitcnt lgkmcnt(8)
    v_mfma_f32_32x32x16_bf16 v[84:99], v[52:55], a[80:83], v[84:99]
    ds_read_b64_tr_b16 v[48:49], v79 offset:43008
    ds_read_b64_tr_b16 v[50:51], v79 offset:43520
    s_mov_b32 s26, 8388608
    s_add_u32 s28, s40, 2621440
    s_addc_u32 s29, s41, 0
    s_mov_b32 s30, 196608
    v_mfma_f32_32x32x16_bf16 v[84:99], v[56:59], a[84:87], v[84:99]
    ds_read_b64_tr_b16 v[52:53], v79 offset:47104
    ds_read_b64_tr_b16 v[54:55], v79 offset:47616
    s_mov_b32 s32, s74
    s_mov_b32 s33, s75
    s_mov_b32 s34, 4096
    s_waitcnt lgkmcnt(8)
    v_mfma_f32_32x32x16_bf16 v[84:99], v[32:35], a[88:91], v[84:99]
    ds_read_b64_tr_b16 v[56:57], v79 offset:35840
    ds_read_b64_tr_b16 v[58:59], v79 offset:36352
    v_add_u32 v6, 65536, v4
    v_add_u32 v7, 65536, v5
    v_min_u32 v8, 21, v3
    v_mfma_f32_32x32x16_bf16 v[84:99], v[36:39], a[92:95], v[84:99]
    ds_read_b64_tr_b16 v[32:33], v79 offset:39936
    ds_read_b64_tr_b16 v[34:35], v79 offset:40448
    v_lshlrev_b32 v8, 4, v8
    v_mul_u32_u24 v17, 352, v2
    v_add_u32 v8, v8, v17
    s_waitcnt lgkmcnt(8)
    v_mfma_f32_32x32x16_bf16 v[84:99], v[40:43], a[96:99], v[84:99]
    ds_read_b64_tr_b16 v[36:37], v79 offset:44032
    ds_read_b64_tr_b16 v[38:39], v79 offset:44544
    v_add_u32 v8, 65536, v8
    v_lshrrev_b32 v17, 1, v3
    v_and_b32 v17, 7, v17
    v_mfma_f32_32x32x16_bf16 v[84:99], v[44:47], a[100:103], v[84:99]
    ds_read_b64_tr_b16 v[40:41], v79 offset:48128
    ds_read_b64_tr_b16 v[42:43], v79 offset:48640
    v_lshlrev_b32 v18, 7, v3
    v_add_u32 v19, 0, v2
    v_xor_b32 v19, v19, v17
    s_waitcnt lgkmcnt(8)
    v_mfma_f32_32x32x16_bf16 v[84:99], v[48:51], a[104:107], v[84:99]
    ds_read_b64_tr_b16 v[44:45], v78 offset:0
    ds_read_b64_tr_b16 v[46:47], v78 offset:512
    v_lshl_add_u32 v9, v19, 4, v18
    v_add_u32 v19, 2, v2
    v_xor_b32 v19, v19, v17
    v_mfma_f32_32x32x16_bf16 v[84:99], v[52:55], a[108:111], v[84:99]
    ds_read_b64_tr_b16 v[48:49], v78 offset:1024
    ds_read_b64_tr_b16 v[50:51], v78 offset:1536
    v_lshl_add_u32 v10, v19, 4, v18
    v_add_u32 v19, 4, v2
    v_xor_b32 v19, v19, v17
    s_waitcnt lgkmcnt(8)
    v_mfma_f32_32x32x16_bf16 v[84:99], v[56:59], a[112:115], v[84:99]
    ds_read_b64_tr_b16 v[52:53], v78 offset:2048
    ds_read_b64_tr_b16 v[54:55], v78 offset:2560
    v_lshl_add_u32 v11, v19, 4, v18
    v_add_u32 v19, 6, v2
    v_xor_b32 v19, v19, v17
    v_mfma_f32_32x32x16_bf16 v[84:99], v[32:35], a[116:119], v[84:99]
    ds_read_b64_tr_b16 v[56:57], v78 offset:3072
    ds_read_b64_tr_b16 v[58:59], v78 offset:3584
    v_lshl_add_u32 v12, v19, 4, v18
    s_waitcnt lgkmcnt(8)
    v_mfma_f32_32x32x16_bf16 v[84:99], v[36:39], a[120:123], v[84:99]
    ds_read_b64_tr_b16 v[32:33], v78 offset:4096
    ds_read_b64_tr_b16 v[34:35], v78 offset:4608
    v_mfma_f32_32x32x16_bf16 v[84:99], v[40:43], a[124:127], v[84:99]
    ds_read_b64_tr_b16 v[36:37], v78 offset:5120
    ds_read_b64_tr_b16 v[38:39], v78 offset:5632
    s_waitcnt lgkmcnt(8)
    v_mfma_f32_32x32x16_bf16 v[84:99], v[44:47], a[128:131], v[84:99]
    ds_read_b64_tr_b16 v[40:41], v78 offset:6144
    ds_read_b64_tr_b16 v[42:43], v78 offset:6656
    buffer_load_dword v216, v218, s[40:43], 0 offen sc1
    buffer_load_dword v217, v219, s[40:43], 0 offen sc1
    v_mfma_f32_32x32x16_bf16 v[84:99], v[48:51], a[132:135], v[84:99]
    ds_read_b64_tr_b16 v[44:45], v78 offset:7168
    ds_read_b64_tr_b16 v[46:47], v78 offset:7680
    s_waitcnt lgkmcnt(8)
    v_mfma_f32_32x32x16_bf16 v[84:99], v[52:55], a[136:139], v[84:99]
    v_mfma_f32_32x32x16_bf16 v[84:99], v[56:59], a[140:143], v[84:99]
    s_waitcnt lgkmcnt(4)
    v_mfma_f32_32x32x16_bf16 v[84:99], v[32:35], a[144:147], v[84:99]
    v_mfma_f32_32x32x16_bf16 v[84:99], v[36:39], a[148:151], v[84:99]
    s_waitcnt lgkmcnt(0)
    v_mfma_f32_32x32x16_bf16 v[84:99], v[40:43], a[152:155], v[84:99]
    v_mfma_f32_32x32x16_bf16 v[84:99], v[44:47], a[156:159], v[84:99]
    s_waitcnt vmcnt(0)
    s_barrier
    s_mov_b32 s65, 0
M_fe_chk:
    v_cmp_ne_u32 vcc, s69, v216
    v_cmp_ne_u32 s[6:7], s69, v217
    s_nop 0
    s_or_b64 vcc, vcc, s[6:7]
    s_cbranch_vccz M_fe_ok
    s_sleep 1
    buffer_load_dword v216, v218, s[40:43], 0 offen sc1
    buffer_load_dword v217, v219, s[40:43], 0 offen sc1
    s_waitcnt vmcnt(0)
    s_add_u32 s65, s65, 1
    s_cmp_lt_u32 s65, 262144
    s_cbranch_scc1 M_fe_chk
M_fe_ok:
    s_mul_i32 s63, s8, 40960
    s_mul_i32 s64, s9, 1280
    s_add_u32 s63, s63, s64
    v_add_u32 v218, -11008, v218
    buffer_load_dword v254, v218, s[40:43], 0 offen sc1
    buffer_load_dwordx2 v[136:137], v5, s[40:43], s63 offen sc1
    buffer_load_dwordx2 v[138:139], v5, s[40:43], s63 offen offset:512 sc1
    buffer_load_dwordx2 v[140:141], v5, s[40:43], s63 offen offset:1280 sc1
    buffer_load_dwordx2 v[142:143], v5, s[40:43], s63 offen offset:1792 sc1
    s_mov_b32 exec_hi, 0
    buffer_load_dwordx2 v[144:145], v5, s[40:43], s63 offen offset:1024 sc1
    buffer_load_dwordx2 v[146:147], v5, s[40:43], s63 offen offset:2304 sc1
    s_mov_b64 exec, -1
    s_mov_b32 s64, 193536
    buffer_load_dwordx4 v[148:151], v4, s[28:31], s64 offen sc1
    buffer_load_dwordx2 v[152:153], v5, s[28:31], s64 offen offset:1024 sc1
    s_add_u32 m0, s14, 0
    s_nop 0
    buffer_load_dwordx4 v15, s[28:31], s17 offen offset:0 sc1 lds
    buffer_load_dwordx4 v15, s[28:31], s17 offen offset:1024 sc1 lds
    buffer_load_dwordx4 v15, s[28:31], s17 offen offset:2048 sc1 lds
    s_add_u32 s17, s17, 12288
    v_pk_mul_f32 v[168:169], v[84:85], v[84:85]
    v_pk_mul_f32 v[170:171], v[86:87], v[86:87]
    v_pk_mul_f32 v[172:173], v[88:89], v[88:89]
    v_pk_mul_f32 v[174:175], v[90:91], v[90:91]
    v_pk_mul_f32 v[176:177], v[92:93], v[92:93]
    v_pk_mul_f32 v[178:179], v[94:95], v[94:95]
    v_pk_mul_f32 v[180:181], v[96:97], v[96:97]
    v_pk_mul_f32 v[182:183], v[98:99], v[98:99]
    v_pk_fma_f32 v[168:169], v[168:169], v[62:63], v[60:61]
    v_pk_fma_f32 v[170:171], v[170:171], v[62:63], v[60:61]
    v_pk_fma_f32 v[172:173], v[172:173], v[62:63], v[60:61]
    s_add_u32 m0, s14, 12288
    s_nop 0
    buffer_load_dwordx4 v15, s[28:31], s17 offen offset:0 sc1 lds
    v_pk_fma_f32 v[174:175], v[174:175], v[62:63], v[60:61]
    v_pk_fma_f32 v[176:177], v[176:177], v[62:63], v[60:61]
    v_pk_fma_f32 v[178:179], v[178:179], v[62:63], v[60:61]
    v_pk_fma_f32 v[180:181], v[180:181], v[62:63], v[60:61]
    v_pk_fma_f32 v[182:183], v[182:183], v[62:63], v[60:61]
    v_pk_mul_f32 v[168:169], v[168:169], v[84:85]
    v_pk_mul_f32 v[170:171], v[170:171], v[86:87]
    v_pk_mul_f32 v[172:173], v[172:173], v[88:89]
    v_pk_mul_f32 v[174:175], v[174:175], v[90:91]
    v_pk_mul_f32 v[176:177], v[176:177], v[92:93]
    v_pk_mul_f32 v[178:179], v[178:179], v[94:95]
    buffer_load_dwordx4 v15, s[28:31], s17 offen offset:1024 sc1 lds
    v_pk_mul_f32 v[180:181], v[180:181], v[96:97]
    v_pk_mul_f32 v[182:183], v[182:183], v[98:99]
    v_exp_f32 v168, v168
    v_exp_f32 v169, v169
    v_exp_f32 v170, v170
    v_exp_f32 v171, v171
    v_exp_f32 v172, v172
    v_exp_f32 v173, v173
    v_exp_f32 v174, v174
    v_exp_f32 v175, v175
    v_exp_f32 v176, v176
    buffer_load_dwordx4 v15, s[28:31], s17 offen offset:2048 sc1 lds
    s_add_u32 s17, s17, 12288
    v_exp_f32 v177, v177
    v_exp_f32 v178, v178
    v_exp_f32 v179, v179
    v_exp_f32 v180, v180
    v_exp_f32 v181, v181
    v_exp_f32 v182, v182
    v_exp_f32 v183, v183
    v_pk_add_f32 v[168:169], v[168:169], v[64:65]
    v_pk_add_f32 v[170:171], v[170:171], v[64:65]
    v_pk_add_f32 v[172:173], v[172:173], v[64:65]
    v_pk_add_f32 v[174:175], v[174:175], v[64:65]
    s_add_u32 m0, s15, 0
    s_nop 0
    buffer_load_dwordx4 v15, s[28:31], s17 offen offset:0 sc1 lds
    v_pk_add_f32 v[176:177], v[176:177], v[64:65]
    v_pk_add_f32 v[178:179], v[178:179], v[64:65]
    v_pk_add_f32 v[180:181], v[180:181], v[64:65]
    v_pk_add_f32 v[182:183], v[182:183], v[64:65]
    v_rcp_f32 v168, v168
    v_rcp_f32 v169, v169
    v_rcp_f32 v170, v170
    v_rcp_f32 v171, v171
    v_rcp_f32 v172, v172
    v_rcp_f32 v173, v173
    v_rcp_f32 v174, v174
    buffer_load_dwordx4 v15, s[28:31], s17 offen offset:1024 sc1 lds
    v_rcp_f32 v175, v175
    v_rcp_f32 v176, v176
    v_rcp_f32 v177, v177
    v_rcp_f32 v178, v178
    v_rcp_f32 v179, v179
    v_rcp_f32 v180, v180
    v_rcp_f32 v181, v181
    v_rcp_f32 v182, v182
    v_rcp_f32 v183, v183
    v_pk_mul_f32 v[84:85], v[84:85], v[168:169]
    v_pk_mul_f32 v[86:87], v[86:87], v[170:171]
    buffer_load_dwordx4 v15, s[28:31], s17 offen offset:2048 sc1 lds
    s_add_u32 s17, s17, 12288
    v_pk_mul_f32 v[88:89], v[88:89], v[172:173]
    v_pk_mul_f32 v[90:91], v[90:91], v[174:175]
    v_pk_mul_f32 v[92:93], v[92:93], v[176:177]
    v_pk_mul_f32 v[94:95], v[94:95], v[178:179]
    v_pk_mul_f32 v[96:97], v[96:97], v[180:181]
    v_pk_mul_f32 v[98:99], v[98:99], v[182:183]
    v_cvt_pk_bf16_f32 v200, v84, v85
    v_cvt_pk_bf16_f32 v201, v86, v87
    v_cvt_pk_bf16_f32 v202, v88, v89
    v_cvt_pk_bf16_f32 v203, v90, v91
    v_cvt_pk_bf16_f32 v204, v92, v93
    v_cvt_pk_bf16_f32 v205, v94, v95
    v_cvt_pk_bf16_f32 v206, v96, v97
    v_cvt_pk_bf16_f32 v207, v98, v99
    s_mul_i32 s63, s62, 55296
    s_lshl_b32 s64, s53, 11
    s_add_u32 s63, s63, s64
    s_add_u32 s63, s63, 7077888
    buffer_store_dwordx4 v[200:203], v4, s[40:43], s63 offen sc1
    buffer_store_dwordx4 v[204:207], v4, s[40:43], s63 offen offset:1024 sc1
    s_cmp_lg_u32 s55, 0
    s_cbranch_scc1 M_b0z2
    v_cvt_pk_bf16_f32 v168, v104, v105
    v_cvt_pk_bf16_f32 v169, v106, v107
    v_cvt_pk_bf16_f32 v170, v108, v109
    v_cvt_pk_bf16_f32 v171, v110, v111
    v_cvt_pk_bf16_f32 v172, v112, v113
    v_cvt_pk_bf16_f32 v173, v114, v115
    v_cvt_pk_bf16_f32 v174, v116, v117
    v_cvt_pk_bf16_f32 v175, v118, v119
    s_mul_i32 s63, s62, 55296
    s_lshl_b32 s64, s52, 11
    s_add_u32 s63, s63, s64
    s_add_u32 s63, s63, 7077888
    buffer_store_dwordx4 v[168:171], v4, s[40:43], s63 offen sc1
    buffer_store_dwordx4 v[172:175], v4, s[40:43], s63 offen offset:1024 sc1
    s_cmp_lg_u32 s56, 0
    s_cbranch_scc1 M_b0z2
    v_cvt_pk_bf16_f32 v176, v120, v121
    v_cvt_pk_bf16_f32 v177, v122, v123
    v_cvt_pk_bf16_f32 v178, v124, v125
    v_cvt_pk_bf16_f32 v179, v126, v127
    v_cvt_pk_bf16_f32 v180, v128, v129
    v_cvt_pk_bf16_f32 v181, v130, v131
    v_cvt_pk_bf16_f32 v182, v132, v133
    v_cvt_pk_bf16_f32 v183, v134, v135
    s_mul_i32 s63, s62, 55296
    s_lshl_b32 s64, s52, 11
    s_add_u32 s63, s63, s64
    s_add_u32 s63, s63, 7079936
    buffer_store_dwordx4 v[176:179], v4, s[40:43], s63 offen sc1
    buffer_store_dwordx4 v[180:183], v4, s[40:43], s63 offen offset:1024 sc1
M_b0z2:
    v_mul_u32_u24 v216, 72, v3
    v_lshl_add_u32 v216, v2, 3, v216
    v_add_u32 v216, s58, v216
    v_lshlrev_b32 v217, 3, v2
    v_bfe_u32 v218, v1, 2, 2
    v_add_u32 v217, v217, v218
    v_mul_u32_u24 v217, 72, v217
    v_bfe_u32 v218, v1, 4, 1
    v_lshl_add_u32 v217, v218, 5, v217
    v_and_b32 v218, 3, v1
    v_lshl_add_u32 v217, v218, 3, v217
    v_add_u32 v217, s58, v217
    s_sub_u32 s54, s52, 27
    s_lshl_b32 s54, s54, 17
    s_lshl_b32 s64, s62, 11
    s_add_u32 s54, s54, s64
    s_add_u32 s54, s54, 3407872
    s_add_u32 s57, s54, 131072
    s_cmp_eq_u32 s55, 0
    s_cselect_b32 s54, s22, s54
    s_cmp_eq_u32 s56, 0
    s_cselect_b32 s57, s22, s57
    v_mov_b32 v192, -1
    v_mov_b32 v193, -1
    v_mov_b32 v194, -1
    v_mov_b32 v195, -1
    s_mul_i32 s59, s10, 192512
    s_lshl_b32 s66, s11, 11
    s_add_u32 s59, s59, s66
    s_add_u32 s59, s59, 10788864
    s_cmp_eq_u32 s12, 0
    s_cselect_b32 s59, s22, s59
    s_add_u32 s66, s59, 96256
    s_mul_i32 s53, s8, 96256
    s_add_u32 s53, s53, 10747904
    s_lshl_b32 s52, s9, 10
    s_add_u32 s52, s52, s53
    s_lshl_b32 s63, s9, 8
    s_add_u32 s53, s53, s63
    s_add_u32 s53, s53, 32768
    s_lshl_b32 s55, s62, 13
    s_add_u32 s55, s55, 2883584
    s_add_u32 s56, s55, 4096
    s_add_u32 s63, s11, 1
    s_lshr_b32 s63, s63, 1
    s_min_u32 s63, s63, 13
    s_lshl_b32 s63, s63, 8
    s_add_u32 s63, s63, 2838528
    v_lshlrev_b32 v196, 2, v1
    v_add_u32 v196, s63, v196
    s_sub_u32 s63, s11, 4
    s_lshr_b32 s64, s11, 1
    s_add_u32 s65, s64, 14
    s_cmp_lt_u32 s11, 4
    s_cselect_b32 s63, s65, s63
    s_add_u32 s65, s64, 4
    s_cmp_ge_u32 s11, 20
    s_cselect_b32 s63, s65, s63
    s_cmp_ge_u32 s11, 24
    s_cselect_b32 s63, 0, s63
    s_lshl_b32 s63, s63, 8
    s_lshl_b32 s64, s10, 3
    s_add_u32 s63, s63, s64
    s_add_u32 s63, s63, 2838528
    v_and_b32 v197, 1, v1
    v_lshlrev_b32 v197, 2, v197
    v_add_u32 v197, s63, v197
    v_lshlrev_b32 v23, 3, v3
    v_lshlrev_b32 v198, 1, v3
    s_lshl_b32 s23, s8, 8
    s_add_u32 s23, s23, 2850816
    s_lshl_b32 s4, s10, 9
    s_add_u32 s4, s4, 2850816
    s_waitcnt vmcnt(11)
    v_max_f32_dpp v254, v254, v254 row_shr:1 row_mask:0xf bank_mask:0xf bound_ctrl:0
    s_nop 1
    v_max_f32_dpp v254, v254, v254 row_shr:2 row_mask:0xf bank_mask:0xf bound_ctrl:0
    s_nop 1
    v_max_f32_dpp v254, v254, v254 row_shr:4 row_mask:0xf bank_mask:0xf bound_ctrl:0
    s_nop 1
    v_max_f32_dpp v254, v254, v254 row_shr:8 row_mask:0xf bank_mask:0xf bound_ctrl:0
    s_nop 1
    v_max_f32_dpp v254, v254, v254 row_bcast:15 row_mask:0xa bank_mask:0xf
    s_nop 1
    v_max_f32_dpp v254, v254, v254 row_bcast:31 row_mask:0xc bank_mask:0xf
    s_nop 0
    v_readlane_b32 s20, v254, 63
    v_mov_b32 v17, 0
    v_dot2_f32_bf16 v17, v136, v136, v17
    v_dot2_f32_bf16 v17, v137, v137, v17
    v_dot2_f32_bf16 v17, v138, v138, v17
    v_dot2_f32_bf16 v17, v139, v139, v17
    v_dot2_f32_bf16 v17, v144, v144, v17
    v_dot2_f32_bf16 v17, v145, v145, v17
    v_mov_b32 v18, 0
    v_dot2_f32_bf16 v18, v140, v140, v18
    v_dot2_f32_bf16 v18, v141, v141, v18
    v_dot2_f32_bf16 v18, v142, v142, v18
    v_dot2_f32_bf16 v18, v143, v143, v18
    v_dot2_f32_bf16 v18, v146, v146, v18
    v_dot2_f32_bf16 v18, v147, v147, v18
    s_nop 2
    v_mov_b32 v19, v17
    s_nop 1
    v_permlane32_swap_b32 v17, v19
    v_add_f32 v17, v17, v19
    v_mul_f32 v17, s20, v17
    v_sqrt_f32 v17, v17
    s_nop 0
    v_mul_f32 v17, 0x3f8147ae, v17
    v_add_f32 v17, 0xc2200000, v17
    v_sub_f32 v20, 0, v17
    v_and_b32 v21, 0xffff0000, v20
    v_sub_f32 v20, v20, v21
    v_and_b32 v22, 0xffff0000, v20
    v_sub_f32 v20, v20, v22
    v_lshrrev_b32 v21, 16, v21
    s_mov_b32 exec_lo, 0
    v_or_b32 v144, v21, v22
    v_lshrrev_b32 v145, 16, v20
    s_mov_b64 exec, -1
    v_mov_b32 v19, v18
    s_nop 1
    v_permlane32_swap_b32 v18, v19
    v_add_f32 v18, v18, v19
    v_mul_f32 v18, s20, v18
    v_sqrt_f32 v18, v18
    s_nop 0
    v_mul_f32 v18, 0x3f8147ae, v18
    v_add_f32 v18, 0xc2200000, v18
    v_sub_f32 v20, 0, v18
    v_and_b32 v21, 0xffff0000, v20
    v_sub_f32 v20, v20, v21
    v_and_b32 v22, 0xffff0000, v20
    v_sub_f32 v20, v20, v22
    v_lshrrev_b32 v21, 16, v21
    s_mov_b32 exec_lo, 0
    v_or_b32 v146, v21, v22
    v_lshrrev_b32 v147, 16, v20
    s_mov_b64 exec, -1
    v_mfma_f32_32x32x16_bf16 v[24:39], v[148:151], v[136:139], 0
    v_mfma_f32_32x32x8_bf16 v[24:39], v[152:153], v[144:145], v[24:39]
    v_mfma_f32_32x32x16_bf16 v[40:55], v[148:151], v[140:143], 0
    v_mfma_f32_32x32x8_bf16 v[40:55], v[152:153], v[146:147], v[40:55]
    s_mov_b32 s60, 2048
    buffer_load_dwordx4 v[220:223], v4, s[40:43], s55 offen offset:0 sc1
    buffer_load_dwordx4 v[224:227], v4, s[40:43], s55 offen offset:1024 sc1
    buffer_load_dwordx4 v[228:231], v4, s[40:43], s55 offen offset:2048 sc1
    buffer_load_dwordx4 v[232:235], v4, s[40:43], s55 offen offset:3072 sc1
    s_waitcnt vmcnt(12)
    s_barrier
    ds_read_b128 v[172:175], v8 offset:1536
    ds_read_b128 v[156:159], v6 offset:0
    ds_read_b64 v[160:161], v7 offset:1024
    ds_read_b128 v[176:179], v8 offset:2240
    v_exp_f32 v24, v24
    v_exp_f32 v25, v25
    v_exp_f32 v26, v26
    v_exp_f32 v27, v27
    v_exp_f32 v28, v28
    v_exp_f32 v29, v29
    v_exp_f32 v30, v30
    v_exp_f32 v31, v31
    v_exp_f32 v32, v32
    v_exp_f32 v33, v33
    v_exp_f32 v34, v34
    v_exp_f32 v35, v35
    v_exp_f32 v36, v36
    v_exp_f32 v37, v37
    v_exp_f32 v38, v38
    v_exp_f32 v39, v39
    v_cvt_pk_bf16_f32 v56, v24, v25
    v_cvt_pk_bf16_f32 v57, v26, v27
    v_cvt_pk_bf16_f32 v58, v28, v29
    v_cvt_pk_bf16_f32 v59, v30, v31
    v_cvt_pk_bf16_f32 v60, v32, v33
    v_cvt_pk_bf16_f32 v61, v34, v35
    s_waitcnt lgkmcnt(2)
    v_mfma_f32_32x32x16_bf16 v[72:87], v[172:175], v[56:59], 0
    s_add_u32 m0, s15, 12288
    s_nop 0
    buffer_load_dwordx4 v15, s[28:31], s17 offen offset:0 sc1 lds
    v_exp_f32 v40, v40
    v_exp_f32 v41, v41
    v_exp_f32 v42, v42
    v_exp_f32 v43, v43
    v_cvt_pk_bf16_f32 v62, v36, v37
    v_cvt_pk_bf16_f32 v63, v38, v39
    v_mfma_f32_32x32x16_bf16 v[24:39], v[156:159], v[136:139], 0
    s_waitcnt lgkmcnt(0)
    buffer_load_dwordx4 v[236:239], v4, s[40:43], s56 offen offset:0 sc1
    v_exp_f32 v44, v44
    v_exp_f32 v45, v45
    v_exp_f32 v46, v46
    v_exp_f32 v47, v47
    v_cvt_pk_bf16_f32 v64, v40, v41
    v_cvt_pk_bf16_f32 v65, v42, v43
    v_mfma_f32_32x32x8_bf16 v[24:39], v[160:161], v[144:145], v[24:39]
    buffer_load_dwordx4 v[240:243], v4, s[40:43], s56 offen offset:1024 sc1
    v_exp_f32 v48, v48
    v_exp_f32 v49, v49
    v_exp_f32 v50, v50
    v_exp_f32 v51, v51
    v_cvt_pk_bf16_f32 v66, v44, v45
    v_cvt_pk_bf16_f32 v67, v46, v47
    v_mfma_f32_32x32x16_bf16 v[72:87], v[176:179], v[60:63], v[72:87]
    buffer_load_dwordx4 v[244:247], v4, s[40:43], s56 offen offset:2048 sc1
    v_exp_f32 v52, v52
    v_exp_f32 v53, v53
    v_exp_f32 v54, v54
    v_exp_f32 v55, v55
    v_cvt_pk_bf16_f32 v68, v48, v49
    v_cvt_pk_bf16_f32 v69, v50, v51
    v_mfma_f32_32x32x16_bf16 v[88:103], v[172:175], v[64:67], 0
    ds_read_b128 v[164:167], v8 offset:4608
    buffer_load_dwordx4 v[248:251], v4, s[40:43], s56 offen offset:3072 sc1
    v_exp_f32 v24, v24
    v_exp_f32 v25, v25
    v_exp_f32 v26, v26
    v_exp_f32 v27, v27
    v_cvt_pk_bf16_f32 v70, v52, v53
    v_cvt_pk_bf16_f32 v71, v54, v55
    v_mfma_f32_32x32x16_bf16 v[40:55], v[156:159], v[140:143], 0
    ds_read_b128 v[148:151], v6 offset:3072
    v_exp_f32 v28, v28
    v_exp_f32 v29, v29
    v_exp_f32 v30, v30
    v_exp_f32 v31, v31
    v_cvt_pk_bf16_f32 v56, v24, v25
    v_cvt_pk_bf16_f32 v57, v26, v27
    v_mfma_f32_32x32x8_bf16 v[40:55], v[160:161], v[146:147], v[40:55]
    ds_read_b64 v[152:153], v7 offset:4096
    v_exp_f32 v32, v32
    v_exp_f32 v33, v33
    v_exp_f32 v34, v34
    v_exp_f32 v35, v35
    v_cvt_pk_bf16_f32 v58, v28, v29
    v_cvt_pk_bf16_f32 v59, v30, v31
    v_mfma_f32_32x32x16_bf16 v[88:103], v[176:179], v[68:71], v[88:103]
    s_waitcnt lgkmcnt(1)
    ds_read_b128 v[168:171], v8 offset:5312
    v_exp_f32 v36, v36
    v_exp_f32 v37, v37
    v_exp_f32 v38, v38
    v_exp_f32 v39, v39
    v_cvt_pk_bf16_f32 v60, v32, v33
    v_cvt_pk_bf16_f32 v61, v34, v35
    v_mfma_f32_32x32x16_bf16 v[72:87], v[164:167], v[56:59], v[72:87]
    s_add_u32 m0, s15, 12288
    s_nop 0
    buffer_load_dwordx4 v15, s[28:31], s17 offen offset:1024 sc1 lds
    v_exp_f32 v40, v40
    v_exp_f32 v41, v41
    v_exp_f32 v42, v42
    v_exp_f32 v43, v43
    v_cvt_pk_bf16_f32 v62, v36, v37
    v_cvt_pk_bf16_f32 v63, v38, v39
    v_mfma_f32_32x32x16_bf16 v[24:39], v[148:151], v[136:139], 0
    s_waitcnt lgkmcnt(0)
    v_exp_f32 v44, v44
    v_exp_f32 v45, v45
    v_exp_f32 v46, v46
    v_exp_f32 v47, v47
    v_cvt_pk_bf16_f32 v64, v40, v41
    v_cvt_pk_bf16_f32 v65, v42, v43
    v_mfma_f32_32x32x8_bf16 v[24:39], v[152:153], v[144:145], v[24:39]
    v_exp_f32 v48, v48
    v_exp_f32 v49, v49
    v_exp_f32 v50, v50
    v_exp_f32 v51, v51
    v_cvt_pk_bf16_f32 v66, v44, v45
    v_cvt_pk_bf16_f32 v67, v46, v47
    v_mfma_f32_32x32x16_bf16 v[72:87], v[168:171], v[60:63], v[72:87]
    v_exp_f32 v52, v52
    v_exp_f32 v53, v53
    v_exp_f32 v54, v54
    v_exp_f32 v55, v55
    v_cvt_pk_bf16_f32 v68, v48, v49
    v_cvt_pk_bf16_f32 v69, v50, v51
    v_mfma_f32_32x32x16_bf16 v[88:103], v[164:167], v[64:67], v[88:103]
    ds_read_b128 v[172:175], v8 offset:7680
    v_exp_f32 v24, v24
    v_exp_f32 v25, v25
    v_exp_f32 v26, v26
    v_exp_f32 v27, v27
    v_cvt_pk_bf16_f32 v70, v52, v53
    v_cvt_pk_bf16_f32 v71, v54, v55
    v_mfma_f32_32x32x16_bf16 v[40:55], v[148:151], v[140:143], 0
    ds_read_b128 v[156:159], v6 offset:6144
    v_exp_f32 v28, v28
    v_exp_f32 v29, v29
    v_exp_f32 v30, v30
    v_exp_f32 v31, v31
    v_cvt_pk_bf16_f32 v56, v24, v25
    v_cvt_pk_bf16_f32 v57, v26, v27
    v_mfma_f32_32x32x8_bf16 v[40:55], v[152:153], v[146:147], v[40:55]
    ds_read_b64 v[160:161], v7 offset:7168
    v_exp_f32 v32, v32
    v_exp_f32 v33, v33
    v_exp_f32 v34, v34
    v_exp_f32 v35, v35
    v_cvt_pk_bf16_f32 v58, v28, v29
    v_cvt_pk_bf16_f32 v59, v30, v31
    v_mfma_f32_32x32x16_bf16 v[88:103], v[168:171], v[68:71], v[88:103]
    s_waitcnt lgkmcnt(1)
    ds_read_b128 v[176:179], v8 offset:8384
    v_exp_f32 v36, v36
    v_exp_f32 v37, v37
    v_exp_f32 v38, v38
    v_exp_f32 v39, v39
    v_cvt_pk_bf16_f32 v60, v32, v33
    v_cvt_pk_bf16_f32 v61, v34, v35
    v_mfma_f32_32x32x16_bf16 v[72:87], v[172:175], v[56:59], v[72:87]
    s_add_u32 m0, s15, 12288
    s_nop 0
    buffer_load_dwordx4 v15, s[28:31], s17 offen offset:2048 sc1 lds
    s_add_u32 s17, s17, 12288
    v_exp_f32 v40, v40
    v_exp_f32 v41, v41
    v_exp_f32 v42, v42
    v_exp_f32 v43, v43
    v_cvt_pk_bf16_f32 v62, v36, v37
    v_cvt_pk_bf16_f32 v63, v38, v39
    v_mfma_f32_32x32x16_bf16 v[24:39], v[156:159], v[136:139], 0
    s_waitcnt lgkmcnt(0)
    v_exp_f32 v44, v44
    v_exp_f32 v45, v45
    v_exp_f32 v46, v46
    v_exp_f32 v47, v47
    v_cvt_pk_bf16_f32 v64, v40, v41
    v_cvt_pk_bf16_f32 v65, v42, v43
    v_mfma_f32_32x32x8_bf16 v[24:39], v[160:161], v[144:145], v[24:39]
    v_exp_f32 v48, v48
    v_exp_f32 v49, v49
    v_exp_f32 v50, v50
    v_exp_f32 v51, v51
    v_cvt_pk_bf16_f32 v66, v44, v45
    v_cvt_pk_bf16_f32 v67, v46, v47
    v_mfma_f32_32x32x16_bf16 v[72:87], v[176:179], v[60:63], v[72:87]
    v_exp_f32 v52, v52
    v_exp_f32 v53, v53
    v_exp_f32 v54, v54
    v_exp_f32 v55, v55
    v_cvt_pk_bf16_f32 v68, v48, v49
    v_cvt_pk_bf16_f32 v69, v50, v51
    s_waitcnt vmcnt(2)
    s_mov_b32 s65, 0
M_stchk:
    v_min_u32 v208, v221, v223
    v_max_u32 v209, v221, v223
    v_min3_u32 v208, v225, v227, v208
    v_max3_u32 v209, v225, v227, v209
    v_min3_u32 v208, v229, v231, v208
    v_max3_u32 v209, v229, v231, v209
    v_min3_u32 v208, v233, v235, v208
    v_max3_u32 v209, v233, v235, v209
    v_min3_u32 v208, v237, v239, v208
    v_max3_u32 v209, v237, v239, v209
    v_min3_u32 v208, v241, v243, v208
    v_max3_u32 v209, v241, v243, v209
    v_min3_u32 v208, v245, v247, v208
    v_max3_u32 v209, v245, v247, v209
    v_min3_u32 v208, v249, v251, v208
    v_max3_u32 v209, v249, v251, v209
    v_cmp_ne_u32 vcc, s69, v208
    v_cmp_ne_u32 s[6:7], v208, v209
    s_nop 0
    s_or_b64 vcc, vcc, s[6:7]
    s_cbranch_vccz M_stok
    s_sleep 1
    buffer_load_dwordx4 v[220:223], v4, s[40:43], s55 offen offset:0 sc1
    buffer_load_dwordx4 v[224:227], v4, s[40:43], s55 offen offset:1024 sc1
    buffer_load_dwordx4 v[228:231], v4, s[40:43], s55 offen offset:2048 sc1
    buffer_load_dwordx4 v[232:235], v4, s[40:43], s55 offen offset:3072 sc1
    buffer_load_dwordx4 v[236:239], v4, s[40:43], s56 offen offset:0 sc1
    buffer_load_dwordx4 v[240:243], v4, s[40:43], s56 offen offset:1024 sc1
    buffer_load_dwordx4 v[244:247], v4, s[40:43], s56 offen offset:2048 sc1
    buffer_load_dwordx4 v[248:251], v4, s[40:43], s56 offen offset:3072 sc1
    s_waitcnt vmcnt(0)
    s_add_u32 s65, s65, 1
    s_cmp_lt_u32 s65, 262144
    s_cbranch_scc1 M_stchk
M_stok:
    v_add_f32 v220, v220, v236
    v_add_f32 v222, v222, v238
    v_add_f32 v224, v224, v240
    v_add_f32 v226, v226, v242
    v_add_f32 v228, v228, v244
    v_add_f32 v230, v230, v246
    v_add_f32 v232, v232, v248
    v_add_f32 v234, v234, v250
    v_add_f32 v220, v220, v228
    v_add_f32 v222, v222, v230
    v_add_f32 v224, v224, v232
    v_add_f32 v226, v226, v234
    v_add_f32 v220, v220, v224
    v_add_f32 v222, v222, v226
    v_mov_b32 v208, v220
    v_mov_b32 v209, v222
    s_nop 0
    v_permlane32_swap_b32 v220, v208
    v_permlane32_swap_b32 v222, v209
    v_add_f32 v208, v208, v220
    v_add_f32 v209, v209, v222
    v_mul_f32 v208, 0x3a97b426, v208
    v_mul_f32 v209, 0x3a97b426, v209
    v_fma_f32 v209, -v208, v208, v209
    v_max_f32 v209, 0, v209
    v_add_f32 v209, 0x3727c5ac, v209
    v_rsq_f32 v212, v209
    s_nop 0
    v_mul_f32 v214, -v208, v212
    v_mov_b32 v213, v212
    v_mov_b32 v215, v214
    v_pk_fma_f32 v[104:105], v[104:105], v[212:213], v[214:215]
    v_pk_fma_f32 v[106:107], v[106:107], v[212:213], v[214:215]
    v_pk_fma_f32 v[108:109], v[108:109], v[212:213], v[214:215]
    v_pk_fma_f32 v[110:111], v[110:111], v[212:213], v[214:215]
    v_pk_fma_f32 v[112:113], v[112:113], v[212:213], v[214:215]
    v_pk_fma_f32 v[114:115], v[114:115], v[212:213], v[214:215]
    v_pk_fma_f32 v[116:117], v[116:117], v[212:213], v[214:215]
    v_pk_fma_f32 v[118:119], v[118:119], v[212:213], v[214:215]
    v_cvt_pk_bf16_f32 v220, v104, v105
    v_cvt_pk_bf16_f32 v221, v106, v107
    v_cvt_pk_bf16_f32 v222, v108, v109
    v_cvt_pk_bf16_f32 v223, v110, v111
    v_cvt_pk_bf16_f32 v224, v112, v113
    v_cvt_pk_bf16_f32 v225, v114, v115
    v_cvt_pk_bf16_f32 v226, v116, v117
    v_cvt_pk_bf16_f32 v227, v118, v119
    v_pk_fma_f32 v[120:121], v[120:121], v[212:213], v[214:215]
    v_pk_fma_f32 v[122:123], v[122:123], v[212:213], v[214:215]
    v_pk_fma_f32 v[124:125], v[124:125], v[212:213], v[214:215]
    v_pk_fma_f32 v[126:127], v[126:127], v[212:213], v[214:215]
    v_pk_fma_f32 v[128:129], v[128:129], v[212:213], v[214:215]
    v_pk_fma_f32 v[130:131], v[130:131], v[212:213], v[214:215]
    v_pk_fma_f32 v[132:133], v[132:133], v[212:213], v[214:215]
    v_pk_fma_f32 v[134:135], v[134:135], v[212:213], v[214:215]
    v_cvt_pk_bf16_f32 v228, v120, v121
    v_cvt_pk_bf16_f32 v229, v122, v123
    v_cvt_pk_bf16_f32 v230, v124, v125
    v_cvt_pk_bf16_f32 v231, v126, v127
    v_cvt_pk_bf16_f32 v232, v128, v129
    v_cvt_pk_bf16_f32 v233, v130, v131
    v_cvt_pk_bf16_f32 v234, v132, v133
    v_cvt_pk_bf16_f32 v235, v134, v135
    ds_write_b64 v216, v[220:221] offset:32768
    ds_write_b64 v216, v[222:223] offset:32784
    ds_write_b64 v216, v[224:225] offset:32800
    ds_write_b64 v216, v[226:227] offset:32816
    ds_write_b64 v216, v[228:229] offset:49152
    ds_write_b64 v216, v[230:231] offset:49168
    ds_write_b64 v216, v[232:233] offset:49184
    ds_write_b64 v216, v[234:235] offset:49200
    v_mov_b64 v[104:105], 0
    v_mov_b64 v[106:107], 0
    v_mov_b64 v[108:109], 0
    v_mov_b64 v[110:111], 0
    v_mov_b64 v[112:113], 0
    v_mov_b64 v[114:115], 0
    v_mov_b64 v[116:117], 0
    v_mov_b64 v[118:119], 0
    v_mov_b64 v[120:121], 0
    v_mov_b64 v[122:123], 0
    v_mov_b64 v[124:125], 0
    v_mov_b64 v[126:127], 0
    v_mov_b64 v[128:129], 0
    v_mov_b64 v[130:131], 0
    v_mov_b64 v[132:133], 0
    v_mov_b64 v[134:135], 0
    v_mfma_f32_32x32x16_bf16 v[88:103], v[172:175], v[64:67], v[88:103]
    ds_read_b128 v[164:167], v8 offset:10752
    v_exp_f32 v24, v24
    v_exp_f32 v25, v25
    v_exp_f32 v26, v26
    v_exp_f32 v27, v27
    v_cvt_pk_bf16_f32 v70, v52, v53
    v_cvt_pk_bf16_f32 v71, v54, v55
    v_mfma_f32_32x32x16_bf16 v[40:55], v[156:159], v[140:143], 0
    ds_read_b128 v[148:151], v6 offset:9216
    v_exp_f32 v28, v28
    v_exp_f32 v29, v29
    v_exp_f32 v30, v30
    v_exp_f32 v31, v31
    v_cvt_pk_bf16_f32 v56, v24, v25
    v_cvt_pk_bf16_f32 v57, v26, v27
    s_waitcnt lgkmcnt(2)
    ds_read_b64_tr_b16 v[236:237], v217 offset:32768
    ds_read_b64_tr_b16 v[238:239], v217 offset:33056
    ds_read_b64_tr_b16 v[240:241], v217 offset:33920
    ds_read_b64_tr_b16 v[242:243], v217 offset:34208
    ds_read_b64_tr_b16 v[244:245], v217 offset:49152
    ds_read_b64_tr_b16 v[246:247], v217 offset:49440
    ds_read_b64_tr_b16 v[248:249], v217 offset:50304
    ds_read_b64_tr_b16 v[250:251], v217 offset:50592
    v_mfma_f32_32x32x8_bf16 v[40:55], v[160:161], v[146:147], v[40:55]
    ds_read_b64 v[152:153], v7 offset:10240
    v_exp_f32 v32, v32
    v_exp_f32 v33, v33
    v_exp_f32 v34, v34
    v_exp_f32 v35, v35
    v_cvt_pk_bf16_f32 v58, v28, v29
    v_cvt_pk_bf16_f32 v59, v30, v31
    v_mfma_f32_32x32x16_bf16 v[88:103], v[176:179], v[68:71], v[88:103]
    s_waitcnt lgkmcnt(9)
    ds_read_b128 v[168:171], v8 offset:11456
    v_exp_f32 v36, v36
    v_exp_f32 v37, v37
    v_exp_f32 v38, v38
    v_exp_f32 v39, v39
    v_cvt_pk_bf16_f32 v60, v32, v33
    v_cvt_pk_bf16_f32 v61, v34, v35
    v_mfma_f32_32x32x16_bf16 v[72:87], v[164:167], v[56:59], v[72:87]
    s_waitcnt lgkmcnt(2)
    buffer_store_dwordx4 v[236:239], v4, s[40:43], s54 offen offset:0 sc1
    v_exp_f32 v40, v40
    v_exp_f32 v41, v41
    v_exp_f32 v42, v42
    v_exp_f32 v43, v43
    v_cvt_pk_bf16_f32 v62, v36, v37
    v_cvt_pk_bf16_f32 v63, v38, v39
    v_mfma_f32_32x32x16_bf16 v[24:39], v[148:151], v[136:139], 0
    s_waitcnt lgkmcnt(0)
    buffer_store_dwordx4 v[240:243], v4, s[40:43], s54 offen offset:1024 sc1
    v_exp_f32 v44, v44
    v_exp_f32 v45, v45
    v_exp_f32 v46, v46
    v_exp_f32 v47, v47
    v_cvt_pk_bf16_f32 v64, v40, v41
    v_cvt_pk_bf16_f32 v65, v42, v43
    v_mfma_f32_32x32x8_bf16 v[24:39], v[152:153], v[144:145], v[24:39]
    buffer_store_dwordx4 v[244:247], v4, s[40:43], s57 offen offset:0 sc1
    v_exp_f32 v48, v48
    v_exp_f32 v49, v49
    v_exp_f32 v50, v50
    v_exp_f32 v51, v51
    v_cvt_pk_bf16_f32 v66, v44, v45
    v_cvt_pk_bf16_f32 v67, v46, v47
    v_mfma_f32_32x32x16_bf16 v[72:87], v[168:171], v[60:63], v[72:87]
    buffer_store_dwordx4 v[248:251], v4, s[40:43], s57 offen offset:1024 sc1
    v_exp_f32 v52, v52
    v_exp_f32 v53, v53
    v_exp_f32 v54, v54
    v_exp_f32 v55, v55
    v_cvt_pk_bf16_f32 v68, v48, v49
    v_cvt_pk_bf16_f32 v69, v50, v51
    v_mfma_f32_32x32x16_bf16 v[88:103], v[164:167], v[64:67], v[88:103]
    s_barrier
    ds_read_b128 v[172:175], v8 offset:13824
    v_exp_f32 v24, v24
    v_exp_f32 v25, v25
    v_exp_f32 v26, v26
    v_exp_f32 v27, v27
    v_cvt_pk_bf16_f32 v70, v52, v53
    v_cvt_pk_bf16_f32 v71, v54, v55
    v_mfma_f32_32x32x16_bf16 v[40:55], v[148:151], v[140:143], 0
    ds_read_b128 v[156:159], v6 offset:12288
    v_exp_f32 v28, v28
    v_exp_f32 v29, v29
    v_exp_f32 v30, v30
    v_exp_f32 v31, v31
    v_cvt_pk_bf16_f32 v56, v24, v25
    v_cvt_pk_bf16_f32 v57, v26, v27
    v_mfma_f32_32x32x8_bf16 v[40:55], v[152:153], v[146:147], v[40:55]
    ds_read_b64 v[160:161], v7 offset:13312
    v_exp_f32 v32, v32
    v_exp_f32 v33, v33
    v_exp_f32 v34, v34
    v_exp_f32 v35, v35
    v_cvt_pk_bf16_f32 v58, v28, v29
    v_cvt_pk_bf16_f32 v59, v30, v31
    v_mfma_f32_32x32x16_bf16 v[88:103], v[168:171], v[68:71], v[88:103]
    s_waitcnt lgkmcnt(1)
    ds_read_b128 v[176:179], v8 offset:14528
    v_exp_f32 v36, v36
    v_exp_f32 v37, v37
    v_exp_f32 v38, v38
    v_exp_f32 v39, v39
    v_cvt_pk_bf16_f32 v60, v32, v33
    v_cvt_pk_bf16_f32 v61, v34, v35
    v_mfma_f32_32x32x16_bf16 v[72:87], v[172:175], v[56:59], v[72:87]
    s_add_u32 m0, s14, 0
    s_nop 0
    buffer_load_dwordx4 v15, s[28:31], s17 offen offset:0 sc1 lds
    v_exp_f32 v40, v40
    v_exp_f32 v41, v41
    v_exp_f32 v42, v42
    v_exp_f32 v43, v43
    v_cvt_pk_bf16_f32 v62, v36, v37
    v_cvt_pk_bf16_f32 v63, v38, v39
    v_mfma_f32_32x32x16_bf16 v[24:39], v[156:159], v[136:139], 0
    s_waitcnt lgkmcnt(0)
    s_mul_i32 s68, s3, 5120
    v_accvgpr_read_b32 v16, a160
    s_add_u32 m0, s68, 122880
    s_nop 0
    buffer_load_dwordx4 v16, s[48:51], s100 offen lds
    v_exp_f32 v44, v44
    v_exp_f32 v45, v45
    v_exp_f32 v46, v46
    v_exp_f32 v47, v47
    v_cvt_pk_bf16_f32 v64, v40, v41
    v_cvt_pk_bf16_f32 v65, v42, v43
    v_mfma_f32_32x32x8_bf16 v[24:39], v[160:161], v[144:145], v[24:39]
    v_accvgpr_read_b32 v17, a161
    s_add_u32 m0, s68, 123904
    s_nop 0
    buffer_load_dwordx4 v17, s[48:51], s100 offen lds
    v_exp_f32 v48, v48
    v_exp_f32 v49, v49
    v_exp_f32 v50, v50
    v_exp_f32 v51, v51
    v_cvt_pk_bf16_f32 v66, v44, v45
    v_cvt_pk_bf16_f32 v67, v46, v47
    v_mfma_f32_32x32x16_bf16 v[72:87], v[176:179], v[60:63], v[72:87]
    v_accvgpr_read_b32 v18, a162
    s_add_u32 m0, s68, 124928
    s_nop 0
    buffer_load_dwordx4 v18, s[48:51], s100 offen lds
    v_exp_f32 v52, v52
    v_exp_f32 v53, v53
    v_exp_f32 v54, v54
    v_exp_f32 v55, v55
    v_cvt_pk_bf16_f32 v68, v48, v49
    v_cvt_pk_bf16_f32 v69, v50, v51
    v_mfma_f32_32x32x16_bf16 v[88:103], v[172:175], v[64:67], v[88:103]
    v_accvgpr_read_b32 v19, a163
    s_add_u32 m0, s68, 125952
    ds_read_b128 v[164:167], v8 offset:16896
    buffer_load_dwordx4 v19, s[48:51], s100 offen lds
    v_exp_f32 v24, v24
    v_exp_f32 v25, v25
    v_exp_f32 v26, v26
    v_exp_f32 v27, v27
    v_cvt_pk_bf16_f32 v70, v52, v53
    v_cvt_pk_bf16_f32 v71, v54, v55
    v_mfma_f32_32x32x16_bf16 v[40:55], v[156:159], v[140:143], 0
    v_accvgpr_read_b32 v20, a164
    s_add_u32 m0, s68, 126976
    ds_read_b128 v[148:151], v6 offset:15360
    buffer_load_dwordx4 v20, s[48:51], s100 offen lds
    v_exp_f32 v28, v28
    v_exp_f32 v29, v29
    v_exp_f32 v30, v30
    v_exp_f32 v31, v31
    v_cvt_pk_bf16_f32 v56, v24, v25
    v_cvt_pk_bf16_f32 v57, v26, v27
    v_mfma_f32_32x32x8_bf16 v[40:55], v[160:161], v[146:147], v[40:55]
    ds_read_b64 v[152:153], v7 offset:16384
    v_exp_f32 v32, v32
    v_exp_f32 v33, v33
    v_exp_f32 v34, v34
    v_exp_f32 v35, v35
    v_cvt_pk_bf16_f32 v58, v28, v29
    v_cvt_pk_bf16_f32 v59, v30, v31
    v_mfma_f32_32x32x16_bf16 v[88:103], v[176:179], v[68:71], v[88:103]
    s_waitcnt lgkmcnt(1)
    ds_read_b128 v[168:171], v8 offset:17600
    v_exp_f32 v36, v36
    v_exp_f32 v37, v37
    v_exp_f32 v38, v38
    v_exp_f32 v39, v39
    v_cvt_pk_bf16_f32 v60, v32, v33
    v_cvt_pk_bf16_f32 v61, v34, v35
    v_mfma_f32_32x32x16_bf16 v[72:87], v[164:167], v[56:59], v[72:87]
    s_add_u32 m0, s14, 0
    s_nop 0
    buffer_load_dwordx4 v15, s[28:31], s17 offen offset:1024 sc1 lds
    v_exp_f32 v40, v40
    v_exp_f32 v41, v41
    v_exp_f32 v42, v42
    v_exp_f32 v43, v43
    v_cvt_pk_bf16_f32 v62, v36, v37
    v_cvt_pk_bf16_f32 v63, v38, v39
    v_mfma_f32_32x32x16_bf16 v[24:39], v[148:151], v[136:139], 0
    s_waitcnt lgkmcnt(0)
    s_add_u32 m0, s13, 0
    s_nop 0
    buffer_load_dwordx4 v13, s[24:27], s16 offen offset:0 lds
    v_exp_f32 v44, v44
    v_exp_f32 v45, v45
    v_exp_f32 v46, v46
    v_exp_f32 v47, v47
    v_cvt_pk_bf16_f32 v64, v40, v41
    v_cvt_pk_bf16_f32 v65, v42, v43
    v_mfma_f32_32x32x8_bf16 v[24:39], v[152:153], v[144:145], v[24:39]
    s_add_u32 m0, s13, 1024
    s_nop 0
    buffer_load_dwordx4 v14, s[24:27], s16 offen offset:0 lds
    v_exp_f32 v48, v48
    v_exp_f32 v49, v49
    v_exp_f32 v50, v50
    v_exp_f32 v51, v51
    v_cvt_pk_bf16_f32 v66, v44, v45
    v_cvt_pk_bf16_f32 v67, v46, v47
    v_mfma_f32_32x32x16_bf16 v[72:87], v[168:171], v[60:63], v[72:87]
    v_exp_f32 v52, v52
    v_exp_f32 v53, v53
    v_exp_f32 v54, v54
    v_exp_f32 v55, v55
    v_cvt_pk_bf16_f32 v68, v48, v49
    v_cvt_pk_bf16_f32 v69, v50, v51
    v_mfma_f32_32x32x16_bf16 v[88:103], v[164:167], v[64:67], v[88:103]
    ds_read_b128 v[172:175], v8 offset:19968
    v_exp_f32 v24, v24
    v_exp_f32 v25, v25
    v_exp_f32 v26, v26
    v_exp_f32 v27, v27
    v_cvt_pk_bf16_f32 v70, v52, v53
    v_cvt_pk_bf16_f32 v71, v54, v55
    v_mfma_f32_32x32x16_bf16 v[40:55], v[148:151], v[140:143], 0
    ds_read_b128 v[156:159], v6 offset:18432
    v_exp_f32 v28, v28
    v_exp_f32 v29, v29
    v_exp_f32 v30, v30
    v_exp_f32 v31, v31
    v_cvt_pk_bf16_f32 v56, v24, v25
    v_cvt_pk_bf16_f32 v57, v26, v27
    v_mfma_f32_32x32x8_bf16 v[40:55], v[152:153], v[146:147], v[40:55]
    ds_read_b64 v[160:161], v7 offset:19456
    v_exp_f32 v32, v32
    v_exp_f32 v33, v33
    v_exp_f32 v34, v34
    v_exp_f32 v35, v35
    v_cvt_pk_bf16_f32 v58, v28, v29
    v_cvt_pk_bf16_f32 v59, v30, v31
    v_mfma_f32_32x32x16_bf16 v[88:103], v[168:171], v[68:71], v[88:103]
    s_waitcnt lgkmcnt(1)
    ds_read_b128 v[176:179], v8 offset:20672
    v_exp_f32 v36, v36
    v_exp_f32 v37, v37
    v_exp_f32 v38, v38
    v_exp_f32 v39, v39
    v_cvt_pk_bf16_f32 v60, v32, v33
    v_cvt_pk_bf16_f32 v61, v34, v35
    v_mfma_f32_32x32x16_bf16 v[72:87], v[172:175], v[56:59], v[72:87]
    s_add_u32 m0, s14, 0
    s_nop 0
    buffer_load_dwordx4 v15, s[28:31], s17 offen offset:2048 sc1 lds
    s_add_u32 s17, s17, 12288
    v_exp_f32 v40, v40
    v_exp_f32 v41, v41
    v_exp_f32 v42, v42
    v_exp_f32 v43, v43
    v_cvt_pk_bf16_f32 v62, v36, v37
    v_cvt_pk_bf16_f32 v63, v38, v39
    v_mfma_f32_32x32x16_bf16 v[24:39], v[156:159], v[136:139], 0
    s_waitcnt lgkmcnt(0)
    s_add_u32 m0, s13, 8064
    s_nop 0
    buffer_load_dwordx4 v13, s[24:27], s16 offen offset:128 lds
    v_exp_f32 v44, v44
    v_exp_f32 v45, v45
    v_exp_f32 v46, v46
    v_exp_f32 v47, v47
    v_cvt_pk_bf16_f32 v64, v40, v41
    v_cvt_pk_bf16_f32 v65, v42, v43
    v_mfma_f32_32x32x8_bf16 v[24:39], v[160:161], v[144:145], v[24:39]
    s_add_u32 m0, s13, 9088
    s_nop 0
    buffer_load_dwordx4 v14, s[24:27], s16 offen offset:128 lds
    s_add_u32 s16, s16, 256
    v_exp_f32 v48, v48
    v_exp_f32 v49, v49
    v_exp_f32 v50, v50
    v_exp_f32 v51, v51
    v_cvt_pk_bf16_f32 v66, v44, v45
    v_cvt_pk_bf16_f32 v67, v46, v47
    v_mfma_f32_32x32x16_bf16 v[72:87], v[176:179], v[60:63], v[72:87]
    v_exp_f32 v52, v52
    v_exp_f32 v53, v53
    v_exp_f32 v54, v54
    v_exp_f32 v55, v55
    v_cvt_pk_bf16_f32 v68, v48, v49
    v_cvt_pk_bf16_f32 v69, v50, v51
    v_mfma_f32_32x32x16_bf16 v[88:103], v[172:175], v[64:67], v[88:103]
    ds_read_b128 v[164:167], v8 offset:23040
    v_exp_f32 v24, v24
    v_exp_f32 v25, v25
    v_exp_f32 v26, v26
    v_exp_f32 v27, v27
    v_cvt_pk_bf16_f32 v70, v52, v53
    v_cvt_pk_bf16_f32 v71, v54, v55
    v_mfma_f32_32x32x16_bf16 v[40:55], v[156:159], v[140:143], 0
    ds_read_b128 v[148:151], v6 offset:21504
    v_exp_f32 v28, v28
    v_exp_f32 v29, v29
    v_exp_f32 v30, v30
    v_exp_f32 v31, v31
    v_cvt_pk_bf16_f32 v56, v24, v25
    v_cvt_pk_bf16_f32 v57, v26, v27
    v_mfma_f32_32x32x8_bf16 v[40:55], v[160:161], v[146:147], v[40:55]
    ds_read_b64 v[152:153], v7 offset:22528
    v_exp_f32 v32, v32
    v_exp_f32 v33, v33
    v_exp_f32 v34, v34
    v_exp_f32 v35, v35
    v_cvt_pk_bf16_f32 v58, v28, v29
    v_cvt_pk_bf16_f32 v59, v30, v31
    v_mfma_f32_32x32x16_bf16 v[88:103], v[176:179], v[68:71], v[88:103]
    s_waitcnt lgkmcnt(1)
    ds_read_b128 v[168:171], v8 offset:23744
    v_exp_f32 v36, v36
    v_exp_f32 v37, v37
    v_exp_f32 v38, v38
    v_exp_f32 v39, v39
    v_cvt_pk_bf16_f32 v60, v32, v33
    v_cvt_pk_bf16_f32 v61, v34, v35
    v_mfma_f32_32x32x16_bf16 v[72:87], v[164:167], v[56:59], v[72:87]
    s_add_u32 m0, s13, 16384
    s_nop 0
    buffer_load_dwordx4 v13, s[24:27], s16 offen offset:0 lds
    v_exp_f32 v40, v40
    v_exp_f32 v41, v41
    v_exp_f32 v42, v42
    v_exp_f32 v43, v43
    v_cvt_pk_bf16_f32 v62, v36, v37
    v_cvt_pk_bf16_f32 v63, v38, v39
    v_mfma_f32_32x32x16_bf16 v[24:39], v[148:151], v[136:139], 0
    s_waitcnt lgkmcnt(0)
    s_add_u32 m0, s13, 17408
    s_nop 0
    buffer_load_dwordx4 v14, s[24:27], s16 offen offset:0 lds
    v_exp_f32 v44, v44
    v_exp_f32 v45, v45
    v_exp_f32 v46, v46
    v_exp_f32 v47, v47
    v_cvt_pk_bf16_f32 v64, v40, v41
    v_cvt_pk_bf16_f32 v65, v42, v43
    v_mfma_f32_32x32x8_bf16 v[24:39], v[152:153], v[144:145], v[24:39]
    v_exp_f32 v48, v48
    v_exp_f32 v49, v49
    v_exp_f32 v50, v50
    v_exp_f32 v51, v51
    v_cvt_pk_bf16_f32 v66, v44, v45
    v_cvt_pk_bf16_f32 v67, v46, v47
    v_mfma_f32_32x32x16_bf16 v[72:87], v[168:171], v[60:63], v[72:87]
    v_xor_b32 v6, 0x8000, v6
    v_xor_b32 v7, 0x8000, v7
    v_xor_b32 v8, 0x8000, v8
    s_xor_b32 s14, s14, 0x8000
    s_xor_b32 s15, s15, 0x8000
    v_exp_f32 v52, v52
    v_exp_f32 v53, v53
    v_exp_f32 v54, v54
    v_exp_f32 v55, v55
    v_cvt_pk_bf16_f32 v68, v48, v49
    v_cvt_pk_bf16_f32 v69, v50, v51
    v_mfma_f32_32x32x16_bf16 v[88:103], v[164:167], v[64:67], v[88:103]
    s_barrier
    ds_read_b128 v[172:175], v8 offset:1536
    v_exp_f32 v24, v24
    v_exp_f32 v25, v25
    v_exp_f32 v26, v26
    v_exp_f32 v27, v27
    v_cvt_pk_bf16_f32 v70, v52, v53
    v_cvt_pk_bf16_f32 v71, v54, v55
    v_mfma_f32_32x32x16_bf16 v[40:55], v[148:151], v[140:143], 0
    ds_read_b128 v[156:159], v6 offset:0
    v_exp_f32 v28, v28
    v_exp_f32 v29, v29
    v_exp_f32 v30, v30
    v_exp_f32 v31, v31
    v_cvt_pk_bf16_f32 v56, v24, v25
    v_cvt_pk_bf16_f32 v57, v26, v27
    v_mfma_f32_32x32x8_bf16 v[40:55], v[152:153], v[146:147], v[40:55]
    ds_read_b64 v[160:161], v7 offset:1024
    v_exp_f32 v32, v32
    v_exp_f32 v33, v33
    v_exp_f32 v34, v34
    v_exp_f32 v35, v35
    v_cvt_pk_bf16_f32 v58, v28, v29
    v_cvt_pk_bf16_f32 v59, v30, v31
    v_mfma_f32_32x32x16_bf16 v[88:103], v[168:171], v[68:71], v[88:103]
    s_waitcnt lgkmcnt(1)
    ds_read_b128 v[176:179], v8 offset:2240
    v_exp_f32 v36, v36
    v_exp_f32 v37, v37
    v_exp_f32 v38, v38
    v_exp_f32 v39, v39
    v_cvt_pk_bf16_f32 v60, v32, v33
    v_cvt_pk_bf16_f32 v61, v34, v35
    s_lshl_b32 s67, s5, 8
    s_lshl_b32 s64, s62, 2
    s_add_u32 s67, s67, s64
    s_add_u32 s67, s67, 2838528
    s_waitcnt vmcnt(14)
    v_mov_b32 v16, s69
    v_mov_b32 v17, 0
    s_mov_b64 exec, 1
    buffer_store_dword v16, v17, s[40:43], s67 offen sc1
    s_mov_b64 exec, -1
    v_mfma_f32_32x32x16_bf16 v[72:87], v[172:175], v[56:59], v[72:87]
    s_add_u32 m0, s15, 12288
    s_nop 0
    buffer_load_dwordx4 v15, s[28:31], s17 offen offset:0 sc1 lds
    v_exp_f32 v40, v40
    v_exp_f32 v41, v41
    v_exp_f32 v42, v42
    v_exp_f32 v43, v43
    v_cvt_pk_bf16_f32 v62, v36, v37
    v_cvt_pk_bf16_f32 v63, v38, v39
    v_mfma_f32_32x32x16_bf16 v[24:39], v[156:159], v[136:139], 0
    s_waitcnt lgkmcnt(0)
    s_add_u32 m0, s13, 24448
    s_nop 0
    buffer_load_dwordx4 v13, s[24:27], s16 offen offset:128 lds
    v_exp_f32 v44, v44
    v_exp_f32 v45, v45
    v_exp_f32 v46, v46
    v_exp_f32 v47, v47
    v_cvt_pk_bf16_f32 v64, v40, v41
    v_cvt_pk_bf16_f32 v65, v42, v43
    v_mfma_f32_32x32x8_bf16 v[24:39], v[160:161], v[144:145], v[24:39]
    s_add_u32 m0, s13, 25472
    s_nop 0
    buffer_load_dwordx4 v14, s[24:27], s16 offen offset:128 lds
    s_add_u32 s16, s16, 256
    v_exp_f32 v48, v48
    v_exp_f32 v49, v49
    v_exp_f32 v50, v50
    v_exp_f32 v51, v51
    v_cvt_pk_bf16_f32 v66, v44, v45
    v_cvt_pk_bf16_f32 v67, v46, v47
    v_mfma_f32_32x32x16_bf16 v[72:87], v[176:179], v[60:63], v[72:87]
    buffer_store_dwordx4 v[192:195], v4, s[40:43], s52 offen offset:0 sc1
    v_exp_f32 v52, v52
    v_exp_f32 v53, v53
    v_exp_f32 v54, v54
    v_exp_f32 v55, v55
    v_cvt_pk_bf16_f32 v68, v48, v49
    v_cvt_pk_bf16_f32 v69, v50, v51
    v_mfma_f32_32x32x16_bf16 v[88:103], v[172:175], v[64:67], v[88:103]
    ds_read_b128 v[164:167], v8 offset:4608
    v_exp_f32 v24, v24
    v_exp_f32 v25, v25
    v_exp_f32 v26, v26
    v_exp_f32 v27, v27
    v_cvt_pk_bf16_f32 v70, v52, v53
    v_cvt_pk_bf16_f32 v71, v54, v55
    v_mfma_f32_32x32x16_bf16 v[40:55], v[156:159], v[140:143], 0
    ds_read_b128 v[148:151], v6 offset:3072
    v_exp_f32 v28, v28
    v_exp_f32 v29, v29
    v_exp_f32 v30, v30
    v_exp_f32 v31, v31
    v_cvt_pk_bf16_f32 v56, v24, v25
    v_cvt_pk_bf16_f32 v57, v26, v27
    v_mfma_f32_32x32x8_bf16 v[40:55], v[160:161], v[146:147], v[40:55]
    ds_read_b64 v[152:153], v7 offset:4096
    v_exp_f32 v32, v32
    v_exp_f32 v33, v33
    v_exp_f32 v34, v34
    v_exp_f32 v35, v35
    v_cvt_pk_bf16_f32 v58, v28, v29
    v_cvt_pk_bf16_f32 v59, v30, v31
    v_mfma_f32_32x32x16_bf16 v[88:103], v[176:179], v[68:71], v[88:103]
    s_waitcnt lgkmcnt(1)
    ds_read_b128 v[168:171], v8 offset:5312
    v_exp_f32 v36, v36
    v_exp_f32 v37, v37
    v_exp_f32 v38, v38
    v_exp_f32 v39, v39
    v_cvt_pk_bf16_f32 v60, v32, v33
    v_cvt_pk_bf16_f32 v61, v34, v35
    v_mfma_f32_32x32x16_bf16 v[72:87], v[164:167], v[56:59], v[72:87]
    s_add_u32 m0, s15, 12288
    s_nop 0
    buffer_load_dwordx4 v15, s[28:31], s17 offen offset:1024 sc1 lds
    v_exp_f32 v40, v40
    v_exp_f32 v41, v41
    v_exp_f32 v42, v42
    v_exp_f32 v43, v43
    v_cvt_pk_bf16_f32 v62, v36, v37
    v_cvt_pk_bf16_f32 v63, v38, v39
    v_mfma_f32_32x32x16_bf16 v[24:39], v[148:151], v[136:139], 0
    s_waitcnt lgkmcnt(0)
    s_add_u32 m0, s13, 32768
    s_nop 0
    buffer_load_dwordx4 v13, s[24:27], s16 offen offset:0 lds
    v_exp_f32 v44, v44
    v_exp_f32 v45, v45
    v_exp_f32 v46, v46
    v_exp_f32 v47, v47
    v_cvt_pk_bf16_f32 v64, v40, v41
    v_cvt_pk_bf16_f32 v65, v42, v43
    v_mfma_f32_32x32x8_bf16 v[24:39], v[152:153], v[144:145], v[24:39]
    s_add_u32 m0, s13, 33792
    s_nop 0
    buffer_load_dwordx4 v14, s[24:27], s16 offen offset:0 lds
    v_exp_f32 v48, v48
    v_exp_f32 v49, v49
    v_exp_f32 v50, v50
    v_exp_f32 v51, v51
    v_cvt_pk_bf16_f32 v66, v44, v45
    v_cvt_pk_bf16_f32 v67, v46, v47
    v_mfma_f32_32x32x16_bf16 v[72:87], v[168:171], v[60:63], v[72:87]
    buffer_store_dwordx4 v[192:195], v4, s[40:43], s52 offen offset:1024 sc1
    v_exp_f32 v52, v52
    v_exp_f32 v53, v53
    v_exp_f32 v54, v54
    v_exp_f32 v55, v55
    v_cvt_pk_bf16_f32 v68, v48, v49
    v_cvt_pk_bf16_f32 v69, v50, v51
    v_mfma_f32_32x32x16_bf16 v[88:103], v[164:167], v[64:67], v[88:103]
    ds_read_b128 v[172:175], v8 offset:7680
    v_exp_f32 v24, v24
    v_exp_f32 v25, v25
    v_exp_f32 v26, v26
    v_exp_f32 v27, v27
    v_cvt_pk_bf16_f32 v70, v52, v53
    v_cvt_pk_bf16_f32 v71, v54, v55
    v_mfma_f32_32x32x16_bf16 v[40:55], v[148:151], v[140:143], 0
    ds_read_b128 v[156:159], v6 offset:6144
    v_exp_f32 v28, v28
    v_exp_f32 v29, v29
    v_exp_f32 v30, v30
    v_exp_f32 v31, v31
    v_cvt_pk_bf16_f32 v56, v24, v25
    v_cvt_pk_bf16_f32 v57, v26, v27
    v_mfma_f32_32x32x8_bf16 v[40:55], v[152:153], v[146:147], v[40:55]
    ds_read_b64 v[160:161], v7 offset:7168
    v_exp_f32 v32, v32
    v_exp_f32 v33, v33
    v_exp_f32 v34, v34
    v_exp_f32 v35, v35
    v_cvt_pk_bf16_f32 v58, v28, v29
    v_cvt_pk_bf16_f32 v59, v30, v31
    v_mfma_f32_32x32x16_bf16 v[88:103], v[168:171], v[68:71], v[88:103]
    s_waitcnt lgkmcnt(1)
    ds_read_b128 v[176:179], v8 offset:8384
    v_exp_f32 v36, v36
    v_exp_f32 v37, v37
    v_exp_f32 v38, v38
    v_exp_f32 v39, v39
    v_cvt_pk_bf16_f32 v60, v32, v33
    v_cvt_pk_bf16_f32 v61, v34, v35
    v_mfma_f32_32x32x16_bf16 v[72:87], v[172:175], v[56:59], v[72:87]
    s_add_u32 m0, s15, 12288
    s_nop 0
    buffer_load_dwordx4 v15, s[28:31], s17 offen offset:2048 sc1 lds
    s_add_u32 s17, s17, 12288
    v_exp_f32 v40, v40
    v_exp_f32 v41, v41
    v_exp_f32 v42, v42
    v_exp_f32 v43, v43
    v_cvt_pk_bf16_f32 v62, v36, v37
    v_cvt_pk_bf16_f32 v63, v38, v39
    v_mfma_f32_32x32x16_bf16 v[24:39], v[156:159], v[136:139], 0
    s_waitcnt lgkmcnt(0)
    s_add_u32 m0, s13, 40832
    s_nop 0
    buffer_load_dwordx4 v13, s[24:27], s16 offen offset:128 lds
    v_exp_f32 v44, v44
    v_exp_f32 v45, v45
    v_exp_f32 v46, v46
    v_exp_f32 v47, v47
    v_cvt_pk_bf16_f32 v64, v40, v41
    v_cvt_pk_bf16_f32 v65, v42, v43
    v_mfma_f32_32x32x8_bf16 v[24:39], v[160:161], v[144:145], v[24:39]
    s_add_u32 m0, s13, 41856
    s_nop 0
    buffer_load_dwordx4 v14, s[24:27], s16 offen offset:128 lds
    s_add_u32 s16, s16, 256
    v_exp_f32 v48, v48
    v_exp_f32 v49, v49
    v_exp_f32 v50, v50
    v_exp_f32 v51, v51
    v_cvt_pk_bf16_f32 v66, v44, v45
    v_cvt_pk_bf16_f32 v67, v46, v47
    v_mfma_f32_32x32x16_bf16 v[72:87], v[176:179], v[60:63], v[72:87]
    buffer_store_dwordx4 v[192:195], v4, s[40:43], s59 offen offset:0 sc1
    v_exp_f32 v52, v52
    v_exp_f32 v53, v53
    v_exp_f32 v54, v54
    v_exp_f32 v55, v55
    v_cvt_pk_bf16_f32 v68, v48, v49
    v_cvt_pk_bf16_f32 v69, v50, v51
    v_mfma_f32_32x32x16_bf16 v[88:103], v[172:175], v[64:67], v[88:103]
    ds_read_b128 v[164:167], v8 offset:10752
    v_exp_f32 v24, v24
    v_exp_f32 v25, v25
    v_exp_f32 v26, v26
    v_exp_f32 v27, v27
    v_cvt_pk_bf16_f32 v70, v52, v53
    v_cvt_pk_bf16_f32 v71, v54, v55
    v_mfma_f32_32x32x16_bf16 v[40:55], v[156:159], v[140:143], 0
    ds_read_b128 v[148:151], v6 offset:9216
    v_exp_f32 v28, v28
    v_exp_f32 v29, v29
    v_exp_f32 v30, v30
    v_exp_f32 v31, v31
    v_cvt_pk_bf16_f32 v56, v24, v25
    v_cvt_pk_bf16_f32 v57, v26, v27
    v_mfma_f32_32x32x8_bf16 v[40:55], v[160:161], v[146:147], v[40:55]
    ds_read_b64 v[152:153], v7 offset:10240
    v_exp_f32 v32, v32
    v_exp_f32 v33, v33
    v_exp_f32 v34, v34
    v_exp_f32 v35, v35
    v_cvt_pk_bf16_f32 v58, v28, v29
    v_cvt_pk_bf16_f32 v59, v30, v31
    v_mfma_f32_32x32x16_bf16 v[88:103], v[176:179], v[68:71], v[88:103]
    s_waitcnt lgkmcnt(1)
    ds_read_b128 v[168:171], v8 offset:11456
    v_exp_f32 v36, v36
    v_exp_f32 v37, v37
    v_exp_f32 v38, v38
    v_exp_f32 v39, v39
    v_cvt_pk_bf16_f32 v60, v32, v33
    v_cvt_pk_bf16_f32 v61, v34, v35
    v_mfma_f32_32x32x16_bf16 v[72:87], v[164:167], v[56:59], v[72:87]
    buffer_store_dwordx4 v[192:195], v4, s[40:43], s59 offen offset:1024 sc1
    v_exp_f32 v40, v40
    v_exp_f32 v41, v41
    v_exp_f32 v42, v42
    v_exp_f32 v43, v43
    v_cvt_pk_bf16_f32 v62, v36, v37
    v_cvt_pk_bf16_f32 v63, v38, v39
    v_mfma_f32_32x32x16_bf16 v[24:39], v[148:151], v[136:139], 0
    s_waitcnt lgkmcnt(0)
    v_exp_f32 v44, v44
    v_exp_f32 v45, v45
    v_exp_f32 v46, v46
    v_exp_f32 v47, v47
    v_cvt_pk_bf16_f32 v64, v40, v41
    v_cvt_pk_bf16_f32 v65, v42, v43
    v_mfma_f32_32x32x8_bf16 v[24:39], v[152:153], v[144:145], v[24:39]
    v_exp_f32 v48, v48
    v_exp_f32 v49, v49
    v_exp_f32 v50, v50
    v_exp_f32 v51, v51
    v_cvt_pk_bf16_f32 v66, v44, v45
    v_cvt_pk_bf16_f32 v67, v46, v47
    v_mfma_f32_32x32x16_bf16 v[72:87], v[168:171], v[60:63], v[72:87]
    v_exp_f32 v52, v52
    v_exp_f32 v53, v53
    v_exp_f32 v54, v54
    v_exp_f32 v55, v55
    v_cvt_pk_bf16_f32 v68, v48, v49
    v_cvt_pk_bf16_f32 v69, v50, v51
    v_accvgpr_read_b32 v16, a165
    s_waitcnt vmcnt(22)
    ds_read_b64_tr_b16 a[128:129], v16 offset:0
    ds_read_b64_tr_b16 a[130:131], v16 offset:2560
    ds_read_b64_tr_b16 a[132:133], v16 offset:32
    ds_read_b64_tr_b16 a[134:135], v16 offset:2592
    ds_read_b64_tr_b16 a[136:137], v16 offset:64
    ds_read_b64_tr_b16 a[138:139], v16 offset:2624
    ds_read_b64_tr_b16 a[140:141], v16 offset:96
    ds_read_b64_tr_b16 a[142:143], v16 offset:2656
    ds_read_b64_tr_b16 a[144:145], v16 offset:128
    ds_read_b64_tr_b16 a[146:147], v16 offset:2688
    v_mfma_f32_32x32x16_bf16 v[88:103], v[164:167], v[64:67], v[88:103]
    s_barrier
    ds_read_b128 v[172:175], v8 offset:13824
    v_exp_f32 v24, v24
    v_exp_f32 v25, v25
    v_exp_f32 v26, v26
    v_exp_f32 v27, v27
    v_cvt_pk_bf16_f32 v70, v52, v53
    v_cvt_pk_bf16_f32 v71, v54, v55
    v_mfma_f32_32x32x16_bf16 v[40:55], v[148:151], v[140:143], 0
    ds_read_b128 v[156:159], v6 offset:12288
    v_exp_f32 v28, v28
    v_exp_f32 v29, v29
    v_exp_f32 v30, v30
    v_exp_f32 v31, v31
    v_cvt_pk_bf16_f32 v56, v24, v25
    v_cvt_pk_bf16_f32 v57, v26, v27
    v_mfma_f32_32x32x8_bf16 v[40:55], v[152:153], v[146:147], v[40:55]
    ds_read_b64 v[160:161], v7 offset:13312
    v_exp_f32 v32, v32
    v_exp_f32 v33, v33
    v_exp_f32 v34, v34
    v_exp_f32 v35, v35
    v_cvt_pk_bf16_f32 v58, v28, v29
    v_cvt_pk_bf16_f32 v59, v30, v31
    v_mfma_f32_32x32x16_bf16 v[88:103], v[168:171], v[68:71], v[88:103]
    s_waitcnt lgkmcnt(1)
    ds_read_b128 v[176:179], v8 offset:14528
    v_exp_f32 v36, v36
    v_exp_f32 v37, v37
    v_exp_f32 v38, v38
    v_exp_f32 v39, v39
    v_cvt_pk_bf16_f32 v60, v32, v33
    v_cvt_pk_bf16_f32 v61, v34, v35
    v_mfma_f32_32x32x16_bf16 v[72:87], v[172:175], v[56:59], v[72:87]
    s_add_u32 m0, s14, 0
    s_nop 0
    buffer_load_dwordx4 v15, s[28:31], s17 offen offset:0 sc1 lds
    v_exp_f32 v40, v40
    v_exp_f32 v41, v41
    v_exp_f32 v42, v42
    v_exp_f32 v43, v43
    v_cvt_pk_bf16_f32 v62, v36, v37
    v_cvt_pk_bf16_f32 v63, v38, v39
    v_mfma_f32_32x32x16_bf16 v[24:39], v[156:159], v[136:139], 0
    s_waitcnt lgkmcnt(0)
    buffer_store_dwordx4 a[128:131], v4, s[40:43], s101 offen offset:0 sc1
    v_exp_f32 v44, v44
    v_exp_f32 v45, v45
    v_exp_f32 v46, v46
    v_exp_f32 v47, v47
    v_cvt_pk_bf16_f32 v64, v40, v41
    v_cvt_pk_bf16_f32 v65, v42, v43
    v_mfma_f32_32x32x8_bf16 v[24:39], v[160:161], v[144:145], v[24:39]
    buffer_store_dwordx4 a[132:135], v4, s[40:43], s101 offen offset:1024 sc1
    v_exp_f32 v48, v48
    v_exp_f32 v49, v49
    v_exp_f32 v50, v50
    v_exp_f32 v51, v51
    v_cvt_pk_bf16_f32 v66, v44, v45
    v_cvt_pk_bf16_f32 v67, v46, v47
    v_mfma_f32_32x32x16_bf16 v[72:87], v[176:179], v[60:63], v[72:87]
    buffer_store_dwordx4 a[136:139], v4, s[40:43], s101 offen offset:2048 sc1
    v_exp_f32 v52, v52
    v_exp_f32 v53, v53
    v_exp_f32 v54, v54
    v_exp_f32 v55, v55
    v_cvt_pk_bf16_f32 v68, v48, v49
    v_cvt_pk_bf16_f32 v69, v50, v51
    v_mfma_f32_32x32x16_bf16 v[88:103], v[172:175], v[64:67], v[88:103]
    ds_read_b128 v[164:167], v8 offset:16896
    buffer_store_dwordx4 a[140:143], v4, s[40:43], s101 offen offset:3072 sc1
    v_exp_f32 v24, v24
    v_exp_f32 v25, v25
    v_exp_f32 v26, v26
    v_exp_f32 v27, v27
    v_cvt_pk_bf16_f32 v70, v52, v53
    v_cvt_pk_bf16_f32 v71, v54, v55
    v_mfma_f32_32x32x16_bf16 v[40:55], v[156:159], v[140:143], 0
    s_add_u32 s101, s101, 4096
    ds_read_b128 v[148:151], v6 offset:15360
    buffer_store_dwordx4 a[144:147], v4, s[40:43], s101 offen offset:0 sc1
    v_exp_f32 v28, v28
    v_exp_f32 v29, v29
    v_exp_f32 v30, v30
    v_exp_f32 v31, v31
    v_cvt_pk_bf16_f32 v56, v24, v25
    v_cvt_pk_bf16_f32 v57, v26, v27
    v_mfma_f32_32x32x8_bf16 v[40:55], v[160:161], v[146:147], v[40:55]
    ds_read_b64 v[152:153], v7 offset:16384
    buffer_store_dwordx4 v[192:195], v4, s[40:43], s66 offen offset:0 sc1
    v_exp_f32 v32, v32
    v_exp_f32 v33, v33
    v_exp_f32 v34, v34
    v_exp_f32 v35, v35
    v_cvt_pk_bf16_f32 v58, v28, v29
    v_cvt_pk_bf16_f32 v59, v30, v31
    v_mfma_f32_32x32x16_bf16 v[88:103], v[176:179], v[68:71], v[88:103]
    s_waitcnt lgkmcnt(1)
    ds_read_b128 v[168:171], v8 offset:17600
    v_exp_f32 v36, v36
    v_exp_f32 v37, v37
    v_exp_f32 v38, v38
    v_exp_f32 v39, v39
    v_cvt_pk_bf16_f32 v60, v32, v33
    v_cvt_pk_bf16_f32 v61, v34, v35
    v_mfma_f32_32x32x16_bf16 v[72:87], v[164:167], v[56:59], v[72:87]
    s_add_u32 m0, s14, 0
    s_nop 0
    buffer_load_dwordx4 v15, s[28:31], s17 offen offset:1024 sc1 lds
    v_exp_f32 v40, v40
    v_exp_f32 v41, v41
    v_exp_f32 v42, v42
    v_exp_f32 v43, v43
    v_cvt_pk_bf16_f32 v62, v36, v37
    v_cvt_pk_bf16_f32 v63, v38, v39
    v_mfma_f32_32x32x16_bf16 v[24:39], v[148:151], v[136:139], 0
    s_waitcnt lgkmcnt(0)
    buffer_store_dwordx4 v[192:195], v4, s[40:43], s66 offen offset:1024 sc1
    v_exp_f32 v44, v44
    v_exp_f32 v45, v45
    v_exp_f32 v46, v46
    v_exp_f32 v47, v47
    v_cvt_pk_bf16_f32 v64, v40, v41
    v_cvt_pk_bf16_f32 v65, v42, v43
    v_mfma_f32_32x32x8_bf16 v[24:39], v[152:153], v[144:145], v[24:39]
    buffer_load_dword v236, v196, s[40:43], 0 offen sc1
    v_exp_f32 v48, v48
    v_exp_f32 v49, v49
    v_exp_f32 v50, v50
    v_exp_f32 v51, v51
    v_cvt_pk_bf16_f32 v66, v44, v45
    v_cvt_pk_bf16_f32 v67, v46, v47
    v_mfma_f32_32x32x16_bf16 v[72:87], v[168:171], v[60:63], v[72:87]
    buffer_load_dword v237, v197, s[40:43], 0 offen sc1
    v_exp_f32 v52, v52
    v_exp_f32 v53, v53
    v_exp_f32 v54, v54
    v_exp_f32 v55, v55
    v_cvt_pk_bf16_f32 v68, v48, v49
    v_cvt_pk_bf16_f32 v69, v50, v51
    v_mfma_f32_32x32x16_bf16 v[88:103], v[164:167], v[64:67], v[88:103]
    ds_read_b128 v[172:175], v8 offset:19968
    v_exp_f32 v24, v24
    v_exp_f32 v25, v25
    v_exp_f32 v26, v26
    v_exp_f32 v27, v27
    v_cvt_pk_bf16_f32 v70, v52, v53
    v_cvt_pk_bf16_f32 v71, v54, v55
    v_mfma_f32_32x32x16_bf16 v[40:55], v[148:151], v[140:143], 0
    ds_read_b128 v[156:159], v6 offset:18432
    v_exp_f32 v28, v28
    v_exp_f32 v29, v29
    v_exp_f32 v30, v30
    v_exp_f32 v31, v31
    v_cvt_pk_bf16_f32 v56, v24, v25
    v_cvt_pk_bf16_f32 v57, v26, v27
    v_mfma_f32_32x32x8_bf16 v[40:55], v[152:153], v[146:147], v[40:55]
    ds_read_b64 v[160:161], v7 offset:19456
    v_exp_f32 v32, v32
    v_exp_f32 v33, v33
    v_exp_f32 v34, v34
    v_exp_f32 v35, v35
    v_cvt_pk_bf16_f32 v58, v28, v29
    v_cvt_pk_bf16_f32 v59, v30, v31
    v_mfma_f32_32x32x16_bf16 v[88:103], v[168:171], v[68:71], v[88:103]
    s_waitcnt lgkmcnt(1)
    ds_read_b128 v[176:179], v8 offset:20672
    v_exp_f32 v36, v36
    v_exp_f32 v37, v37
    v_exp_f32 v38, v38
    v_exp_f32 v39, v39
    v_cvt_pk_bf16_f32 v60, v32, v33
    v_cvt_pk_bf16_f32 v61, v34, v35
    v_mfma_f32_32x32x16_bf16 v[72:87], v[172:175], v[56:59], v[72:87]
    s_add_u32 m0, s14, 0
    s_nop 0
    buffer_load_dwordx4 v15, s[28:31], s17 offen offset:2048 sc1 lds
    s_add_u32 s17, s17, 12288
    v_exp_f32 v40, v40
    v_exp_f32 v41, v41
    v_exp_f32 v42, v42
    v_exp_f32 v43, v43
    v_cvt_pk_bf16_f32 v62, v36, v37
    v_cvt_pk_bf16_f32 v63, v38, v39
    v_mfma_f32_32x32x16_bf16 v[24:39], v[156:159], v[136:139], 0
    s_waitcnt lgkmcnt(0)
    buffer_store_dwordx2 v[192:193], v5, s[40:43], s53 offen sc1
    v_exp_f32 v44, v44
    v_exp_f32 v45, v45
    v_exp_f32 v46, v46
    v_exp_f32 v47, v47
    v_cvt_pk_bf16_f32 v64, v40, v41
    v_cvt_pk_bf16_f32 v65, v42, v43
    v_mfma_f32_32x32x8_bf16 v[24:39], v[160:161], v[144:145], v[24:39]
    buffer_load_dwordx2 v[228:229], v23, s[40:43], s23 offen sc1
    v_exp_f32 v48, v48
    v_exp_f32 v49, v49
    v_exp_f32 v50, v50
    v_exp_f32 v51, v51
    v_cvt_pk_bf16_f32 v66, v44, v45
    v_cvt_pk_bf16_f32 v67, v46, v47
    v_mfma_f32_32x32x16_bf16 v[72:87], v[176:179], v[60:63], v[72:87]
    buffer_load_dwordx2 v[230:231], v23, s[40:43], s4 offen sc1
    v_exp_f32 v52, v52
    v_exp_f32 v53, v53
    v_exp_f32 v54, v54
    v_exp_f32 v55, v55
    v_cvt_pk_bf16_f32 v68, v48, v49
    v_cvt_pk_bf16_f32 v69, v50, v51
    v_mfma_f32_32x32x16_bf16 v[88:103], v[172:175], v[64:67], v[88:103]
    ds_read_b128 v[164:167], v8 offset:23040
    buffer_load_dwordx2 v[232:233], v23, s[40:43], s4 offen offset:256 sc1
    v_exp_f32 v24, v24
    v_exp_f32 v25, v25
    v_exp_f32 v26, v26
    v_exp_f32 v27, v27
    v_cvt_pk_bf16_f32 v70, v52, v53
    v_cvt_pk_bf16_f32 v71, v54, v55
    v_mfma_f32_32x32x16_bf16 v[40:55], v[156:159], v[140:143], 0
    s_lshl_b32 s63, s10, 7
    ds_read_b128 v[148:151], v6 offset:21504
    buffer_load_ushort v234, v198, s[32:35], s63 offen
    v_exp_f32 v28, v28
    v_exp_f32 v29, v29
    v_exp_f32 v30, v30
    v_exp_f32 v31, v31
    v_cvt_pk_bf16_f32 v56, v24, v25
    v_cvt_pk_bf16_f32 v57, v26, v27
    v_mfma_f32_32x32x8_bf16 v[40:55], v[160:161], v[146:147], v[40:55]
    ds_read_b64 v[152:153], v7 offset:22528
    buffer_load_ushort v235, v198, s[32:35], s63 offen offset:64
    v_exp_f32 v32, v32
    v_exp_f32 v33, v33
    v_exp_f32 v34, v34
    v_exp_f32 v35, v35
    v_cvt_pk_bf16_f32 v58, v28, v29
    v_cvt_pk_bf16_f32 v59, v30, v31
    v_mfma_f32_32x32x16_bf16 v[88:103], v[176:179], v[68:71], v[88:103]
    s_waitcnt lgkmcnt(1)
    ds_read_b128 v[168:171], v8 offset:23744
    buffer_load_dword v253, v252, s[24:27], 0 offen offset:1024
    v_exp_f32 v36, v36
    v_exp_f32 v37, v37
    v_exp_f32 v38, v38
    v_exp_f32 v39, v39
    v_cvt_pk_bf16_f32 v60, v32, v33
    v_cvt_pk_bf16_f32 v61, v34, v35
    v_mfma_f32_32x32x16_bf16 v[72:87], v[164:167], v[56:59], v[72:87]
    v_exp_f32 v40, v40
    v_exp_f32 v41, v41
    v_exp_f32 v42, v42
    v_exp_f32 v43, v43
    v_cvt_pk_bf16_f32 v62, v36, v37
    v_cvt_pk_bf16_f32 v63, v38, v39
    v_mfma_f32_32x32x16_bf16 v[24:39], v[148:151], v[136:139], 0
    s_waitcnt lgkmcnt(0)
    v_exp_f32 v44, v44
    v_exp_f32 v45, v45
    v_exp_f32 v46, v46
    v_exp_f32 v47, v47
    v_cvt_pk_bf16_f32 v64, v40, v41
    v_cvt_pk_bf16_f32 v65, v42, v43
    v_mfma_f32_32x32x8_bf16 v[24:39], v[152:153], v[144:145], v[24:39]
    v_exp_f32 v48, v48
    v_exp_f32 v49, v49
    v_exp_f32 v50, v50
    v_exp_f32 v51, v51
    v_cvt_pk_bf16_f32 v66, v44, v45
    v_cvt_pk_bf16_f32 v67, v46, v47
    v_mfma_f32_32x32x16_bf16 v[72:87], v[168:171], v[60:63], v[72:87]
    v_xor_b32 v6, 0x8000, v6
    v_xor_b32 v7, 0x8000, v7
    v_xor_b32 v8, 0x8000, v8
    s_xor_b32 s14, s14, 0x8000
    s_xor_b32 s15, s15, 0x8000
    v_exp_f32 v52, v52
    v_exp_f32 v53, v53
    v_exp_f32 v54, v54
    v_exp_f32 v55, v55
    v_cvt_pk_bf16_f32 v68, v48, v49
    v_cvt_pk_bf16_f32 v69, v50, v51
    v_mfma_f32_32x32x16_bf16 v[88:103], v[164:167], v[64:67], v[88:103]
    s_waitcnt vmcnt(37)
    s_barrier
    ds_read_b128 v[172:175], v8 offset:1536
    v_exp_f32 v24, v24
    v_exp_f32 v25, v25
    v_exp_f32 v26, v26
    v_exp_f32 v27, v27
    v_cvt_pk_bf16_f32 v70, v52, v53
    v_cvt_pk_bf16_f32 v71, v54, v55
    v_mfma_f32_32x32x16_bf16 v[40:55], v[148:151], v[140:143], 0
    ds_read_b128 v[156:159], v6 offset:0
    v_exp_f32 v28, v28
    v_exp_f32 v29, v29
    v_exp_f32 v30, v30
    v_exp_f32 v31, v31
    v_cvt_pk_bf16_f32 v56, v24, v25
    v_cvt_pk_bf16_f32 v57, v26, v27
    v_mfma_f32_32x32x8_bf16 v[40:55], v[152:153], v[146:147], v[40:55]
    ds_read_b64 v[160:161], v7 offset:1024
    v_exp_f32 v32, v32
    v_exp_f32 v33, v33
    v_exp_f32 v34, v34
    v_exp_f32 v35, v35
    v_cvt_pk_bf16_f32 v58, v28, v29
    v_cvt_pk_bf16_f32 v59, v30, v31
    v_mfma_f32_32x32x16_bf16 v[88:103], v[168:171], v[68:71], v[88:103]
    s_waitcnt lgkmcnt(1)
    ds_read_b128 v[176:179], v8 offset:2240
    v_exp_f32 v36, v36
    v_exp_f32 v37, v37
    v_exp_f32 v38, v38
    v_exp_f32 v39, v39
    v_cvt_pk_bf16_f32 v60, v32, v33
    v_cvt_pk_bf16_f32 v61, v34, v35
    s_waitcnt vmcnt(8)
    s_mov_b32 s65, 0
M_fend_chk:
    v_cmp_ne_u32 vcc, s69, v236
    v_cmp_ne_u32 s[6:7], s69, v237
    s_nop 0
    s_or_b64 vcc, vcc, s[6:7]
    s_cbranch_vccz M_fend_ok
    s_sleep 1
    buffer_load_dword v236, v196, s[40:43], 0 offen sc1
    buffer_load_dword v237, v197, s[40:43], 0 offen sc1
    s_waitcnt vmcnt(0)
    s_add_u32 s65, s65, 1
    s_cmp_lt_u32 s65, 262144
    s_cbranch_scc1 M_fend_chk
M_fend_ok:
    v_mfma_f32_32x32x16_bf16 v[72:87], v[172:175], v[56:59], v[72:87]
    s_add_u32 m0, s15, 12288
    s_nop 0
    buffer_load_dwordx4 v15, s[28:31], s17 offen offset:0 sc1 lds
    v_exp_f32 v40, v40
    v_exp_f32 v41, v41
    v_exp_f32 v42, v42
    v_exp_f32 v43, v43
    v_cvt_pk_bf16_f32 v62, v36, v37
    v_cvt_pk_bf16_f32 v63, v38, v39
    v_mfma_f32_32x32x16_bf16 v[24:39], v[156:159], v[136:139], 0
    s_waitcnt lgkmcnt(0)
    buffer_load_dwordx4 a[0:3], v4, s[40:43], s18 offen offset:0 sc1
    v_exp_f32 v44, v44
    v_exp_f32 v45, v45
    v_exp_f32 v46, v46
    v_exp_f32 v47, v47
    v_cvt_pk_bf16_f32 v64, v40, v41
    v_cvt_pk_bf16_f32 v65, v42, v43
    v_mfma_f32_32x32x8_bf16 v[24:39], v[160:161], v[144:145], v[24:39]
    buffer_load_dwordx4 a[4:7], v4, s[40:43], s18 offen offset:1024 sc1
    v_exp_f32 v48, v48
    v_exp_f32 v49, v49
    v_exp_f32 v50, v50
    v_exp_f32 v51, v51
    v_cvt_pk_bf16_f32 v66, v44, v45
    v_cvt_pk_bf16_f32 v67, v46, v47
    v_mfma_f32_32x32x16_bf16 v[72:87], v[176:179], v[60:63], v[72:87]
    buffer_load_dwordx4 a[8:11], v4, s[40:43], s18 offen offset:2048 sc1
    v_exp_f32 v52, v52
    v_exp_f32 v53, v53
    v_exp_f32 v54, v54
    v_exp_f32 v55, v55
    v_cvt_pk_bf16_f32 v68, v48, v49
    v_cvt_pk_bf16_f32 v69, v50, v51
    v_mfma_f32_32x32x16_bf16 v[88:103], v[172:175], v[64:67], v[88:103]
    ds_read_b128 v[164:167], v8 offset:4608
    buffer_load_dwordx4 a[12:15], v4, s[40:43], s18 offen offset:3072 sc1
    s_add_u32 s18, s18, 4096
    v_exp_f32 v24, v24
    v_exp_f32 v25, v25
    v_exp_f32 v26, v26
    v_exp_f32 v27, v27
    v_cvt_pk_bf16_f32 v70, v52, v53
    v_cvt_pk_bf16_f32 v71, v54, v55
    v_mfma_f32_32x32x16_bf16 v[40:55], v[156:159], v[140:143], 0
    ds_read_b128 v[148:151], v6 offset:3072
    buffer_load_dwordx4 a[16:19], v4, s[40:43], s18 offen offset:0 sc1
    v_exp_f32 v28, v28
    v_exp_f32 v29, v29
    v_exp_f32 v30, v30
    v_exp_f32 v31, v31
    v_cvt_pk_bf16_f32 v56, v24, v25
    v_cvt_pk_bf16_f32 v57, v26, v27
    v_mfma_f32_32x32x8_bf16 v[40:55], v[160:161], v[146:147], v[40:55]
    ds_read_b64 v[152:153], v7 offset:4096
    v_exp_f32 v32, v32
    v_exp_f32 v33, v33
    v_exp_f32 v34, v34
    v_exp_f32 v35, v35
    v_cvt_pk_bf16_f32 v58, v28, v29
    v_cvt_pk_bf16_f32 v59, v30, v31
    v_mfma_f32_32x32x16_bf16 v[88:103], v[176:179], v[68:71], v[88:103]
    s_waitcnt lgkmcnt(1)
    ds_read_b128 v[168:171], v8 offset:5312
    v_exp_f32 v36, v36
    v_exp_f32 v37, v37
    v_exp_f32 v38, v38
    v_exp_f32 v39, v39
    v_cvt_pk_bf16_f32 v60, v32, v33
    v_cvt_pk_bf16_f32 v61, v34, v35
    v_mfma_f32_32x32x16_bf16 v[72:87], v[164:167], v[56:59], v[72:87]
    s_add_u32 m0, s15, 12288
    s_nop 0
    buffer_load_dwordx4 v15, s[28:31], s17 offen offset:1024 sc1 lds
    v_exp_f32 v40, v40
    v_exp_f32 v41, v41
    v_exp_f32 v42, v42
    v_exp_f32 v43, v43
    v_cvt_pk_bf16_f32 v62, v36, v37
    v_cvt_pk_bf16_f32 v63, v38, v39
    v_mfma_f32_32x32x16_bf16 v[24:39], v[148:151], v[136:139], 0
    s_waitcnt lgkmcnt(0)
    buffer_load_dwordx4 a[20:23], v4, s[40:43], s18 offen offset:1024 sc1
    v_exp_f32 v44, v44
    v_exp_f32 v45, v45
    v_exp_f32 v46, v46
    v_exp_f32 v47, v47
    v_cvt_pk_bf16_f32 v64, v40, v41
    v_cvt_pk_bf16_f32 v65, v42, v43
    v_mfma_f32_32x32x8_bf16 v[24:39], v[152:153], v[144:145], v[24:39]
    buffer_load_dwordx4 a[24:27], v4, s[40:43], s18 offen offset:2048 sc1
    v_exp_f32 v48, v48
    v_exp_f32 v49, v49
    v_exp_f32 v50, v50
    v_exp_f32 v51, v51
    v_cvt_pk_bf16_f32 v66, v44, v45
    v_cvt_pk_bf16_f32 v67, v46, v47
    v_mfma_f32_32x32x16_bf16 v[72:87], v[168:171], v[60:63], v[72:87]
    buffer_load_dwordx4 a[28:31], v4, s[40:43], s18 offen offset:3072 sc1
    s_add_u32 s18, s18, 4096
    v_exp_f32 v52, v52
    v_exp_f32 v53, v53
    v_exp_f32 v54, v54
    v_exp_f32 v55, v55
    v_cvt_pk_bf16_f32 v68, v48, v49
    v_cvt_pk_bf16_f32 v69, v50, v51
    v_mfma_f32_32x32x16_bf16 v[88:103], v[164:167], v[64:67], v[88:103]
    ds_read_b128 v[172:175], v8 offset:7680
    buffer_load_dwordx4 a[32:35], v4, s[40:43], s18 offen offset:0 sc1
    v_exp_f32 v24, v24
    v_exp_f32 v25, v25
    v_exp_f32 v26, v26
    v_exp_f32 v27, v27
    v_cvt_pk_bf16_f32 v70, v52, v53
    v_cvt_pk_bf16_f32 v71, v54, v55
    v_mfma_f32_32x32x16_bf16 v[40:55], v[148:151], v[140:143], 0
    ds_read_b128 v[156:159], v6 offset:6144
    buffer_load_dwordx4 a[36:39], v4, s[40:43], s18 offen offset:1024 sc1
    v_exp_f32 v28, v28
    v_exp_f32 v29, v29
    v_exp_f32 v30, v30
    v_exp_f32 v31, v31
    v_cvt_pk_bf16_f32 v56, v24, v25
    v_cvt_pk_bf16_f32 v57, v26, v27
    v_mfma_f32_32x32x8_bf16 v[40:55], v[152:153], v[146:147], v[40:55]
    ds_read_b64 v[160:161], v7 offset:7168
    v_exp_f32 v32, v32
    v_exp_f32 v33, v33
    v_exp_f32 v34, v34
    v_exp_f32 v35, v35
    v_cvt_pk_bf16_f32 v58, v28, v29
    v_cvt_pk_bf16_f32 v59, v30, v31
    v_mfma_f32_32x32x16_bf16 v[88:103], v[168:171], v[68:71], v[88:103]
    s_waitcnt lgkmcnt(1)
    ds_read_b128 v[176:179], v8 offset:8384
    v_exp_f32 v36, v36
    v_exp_f32 v37, v37
    v_exp_f32 v38, v38
    v_exp_f32 v39, v39
    v_cvt_pk_bf16_f32 v60, v32, v33
    v_cvt_pk_bf16_f32 v61, v34, v35
    v_mfma_f32_32x32x16_bf16 v[72:87], v[172:175], v[56:59], v[72:87]
    s_add_u32 m0, s15, 12288
    s_nop 0
    buffer_load_dwordx4 v15, s[28:31], s17 offen offset:2048 sc1 lds
    s_add_u32 s17, s17, 12288
    v_exp_f32 v40, v40
    v_exp_f32 v41, v41
    v_exp_f32 v42, v42
    v_exp_f32 v43, v43
    v_cvt_pk_bf16_f32 v62, v36, v37
    v_cvt_pk_bf16_f32 v63, v38, v39
    v_mfma_f32_32x32x16_bf16 v[24:39], v[156:159], v[136:139], 0
    s_waitcnt lgkmcnt(0)
    buffer_load_dwordx4 a[40:43], v4, s[40:43], s18 offen offset:2048 sc1
    v_exp_f32 v44, v44
    v_exp_f32 v45, v45
    v_exp_f32 v46, v46
    v_exp_f32 v47, v47
    v_cvt_pk_bf16_f32 v64, v40, v41
    v_cvt_pk_bf16_f32 v65, v42, v43
    v_mfma_f32_32x32x8_bf16 v[24:39], v[160:161], v[144:145], v[24:39]
    buffer_load_dwordx4 a[44:47], v4, s[40:43], s18 offen offset:3072 sc1
    s_add_u32 s18, s18, 4096
    v_exp_f32 v48, v48
    v_exp_f32 v49, v49
    v_exp_f32 v50, v50
    v_exp_f32 v51, v51
    v_cvt_pk_bf16_f32 v66, v44, v45
    v_cvt_pk_bf16_f32 v67, v46, v47
    v_mfma_f32_32x32x16_bf16 v[72:87], v[176:179], v[60:63], v[72:87]
    buffer_load_dwordx4 a[48:51], v4, s[40:43], s18 offen offset:0 sc1
    v_exp_f32 v52, v52
    v_exp_f32 v53, v53
    v_exp_f32 v54, v54
    v_exp_f32 v55, v55
    v_cvt_pk_bf16_f32 v68, v48, v49
    v_cvt_pk_bf16_f32 v69, v50, v51
    v_mfma_f32_32x32x16_bf16 v[88:103], v[172:175], v[64:67], v[88:103]
    ds_read_b128 v[164:167], v8 offset:10752
    buffer_load_dwordx4 a[52:55], v4, s[40:43], s18 offen offset:1024 sc1
    v_exp_f32 v24, v24
    v_exp_f32 v25, v25
    v_exp_f32 v26, v26
    v_exp_f32 v27, v27
    v_cvt_pk_bf16_f32 v70, v52, v53
    v_cvt_pk_bf16_f32 v71, v54, v55
    v_mfma_f32_32x32x16_bf16 v[40:55], v[156:159], v[140:143], 0
    ds_read_b128 v[148:151], v6 offset:9216
    buffer_load_dwordx4 a[56:59], v4, s[40:43], s18 offen offset:2048 sc1
    v_exp_f32 v28, v28
    v_exp_f32 v29, v29
    v_exp_f32 v30, v30
    v_exp_f32 v31, v31
    v_cvt_pk_bf16_f32 v56, v24, v25
    v_cvt_pk_bf16_f32 v57, v26, v27
    v_mfma_f32_32x32x8_bf16 v[40:55], v[160:161], v[146:147], v[40:55]
    ds_read_b64 v[152:153], v7 offset:10240
    v_exp_f32 v32, v32
    v_exp_f32 v33, v33
    v_exp_f32 v34, v34
    v_exp_f32 v35, v35
    v_cvt_pk_bf16_f32 v58, v28, v29
    v_cvt_pk_bf16_f32 v59, v30, v31
    v_mfma_f32_32x32x16_bf16 v[88:103], v[176:179], v[68:71], v[88:103]
    s_waitcnt lgkmcnt(1)
    ds_read_b128 v[168:171], v8 offset:11456
    v_exp_f32 v36, v36
    v_exp_f32 v37, v37
    v_exp_f32 v38, v38
    v_exp_f32 v39, v39
    v_cvt_pk_bf16_f32 v60, v32, v33
    v_cvt_pk_bf16_f32 v61, v34, v35
    v_mfma_f32_32x32x16_bf16 v[72:87], v[164:167], v[56:59], v[72:87]
    buffer_load_dwordx4 a[60:63], v4, s[40:43], s18 offen offset:3072 sc1
    s_add_u32 s18, s18, 4096
    v_exp_f32 v40, v40
    v_exp_f32 v41, v41
    v_exp_f32 v42, v42
    v_exp_f32 v43, v43
    v_cvt_pk_bf16_f32 v62, v36, v37
    v_cvt_pk_bf16_f32 v63, v38, v39
    v_mfma_f32_32x32x16_bf16 v[24:39], v[148:151], v[136:139], 0
    s_waitcnt lgkmcnt(0)
    s_mul_i32 s63, s10, 110592
    s_lshl_b32 s64, s11, 11
    s_add_u32 s63, s63, s64
    s_add_u32 s63, s63, 7077888
    s_cmp_eq_u32 s12, 0
    s_cselect_b32 s63, s22, s63
    s_add_u32 s64, s63, 55296
    buffer_load_dwordx4 v[212:215], v4, s[40:43], s63 offen sc1
    v_exp_f32 v44, v44
    v_exp_f32 v45, v45
    v_exp_f32 v46, v46
    v_exp_f32 v47, v47
    v_cvt_pk_bf16_f32 v64, v40, v41
    v_cvt_pk_bf16_f32 v65, v42, v43
    v_mfma_f32_32x32x8_bf16 v[24:39], v[152:153], v[144:145], v[24:39]
    buffer_load_dwordx4 v[216:219], v4, s[40:43], s63 offen offset:1024 sc1
    v_exp_f32 v48, v48
    v_exp_f32 v49, v49
    v_exp_f32 v50, v50
    v_exp_f32 v51, v51
    v_cvt_pk_bf16_f32 v66, v44, v45
    v_cvt_pk_bf16_f32 v67, v46, v47
    v_mfma_f32_32x32x16_bf16 v[72:87], v[168:171], v[60:63], v[72:87]
    buffer_load_dwordx4 v[220:223], v4, s[40:43], s64 offen sc1
    v_exp_f32 v52, v52
    v_exp_f32 v53, v53
    v_exp_f32 v54, v54
    v_exp_f32 v55, v55
    v_cvt_pk_bf16_f32 v68, v48, v49
    v_cvt_pk_bf16_f32 v69, v50, v51
    v_mfma_f32_32x32x16_bf16 v[88:103], v[164:167], v[64:67], v[88:103]
    s_waitcnt vmcnt(14)
    s_barrier
    ds_read_b128 v[172:175], v8 offset:13824
    ds_read_b128 v[180:183], v9 offset:0
    buffer_load_dwordx4 v[224:227], v4, s[40:43], s64 offen offset:1024 sc1
    v_exp_f32 v24, v24
    v_exp_f32 v25, v25
    v_exp_f32 v26, v26
    v_exp_f32 v27, v27
    v_cvt_pk_bf16_f32 v70, v52, v53
    v_cvt_pk_bf16_f32 v71, v54, v55
    v_mfma_f32_32x32x16_bf16 v[40:55], v[148:151], v[140:143], 0
    ds_read_b128 v[156:159], v6 offset:12288
    ds_read_b128 v[184:187], v9 offset:4096
    v_exp_f32 v28, v28
    v_exp_f32 v29, v29
    v_exp_f32 v30, v30
    v_exp_f32 v31, v31
    v_cvt_pk_bf16_f32 v56, v24, v25
    v_cvt_pk_bf16_f32 v57, v26, v27
    v_mfma_f32_32x32x8_bf16 v[40:55], v[152:153], v[146:147], v[40:55]
    ds_read_b64 v[160:161], v7 offset:13312
    ds_read_b128 v[188:191], v10 offset:0
    v_exp_f32 v32, v32
    v_exp_f32 v33, v33
    v_exp_f32 v34, v34
    v_exp_f32 v35, v35
    v_cvt_pk_bf16_f32 v58, v28, v29
    v_cvt_pk_bf16_f32 v59, v30, v31
    v_mfma_f32_32x32x16_bf16 v[88:103], v[168:171], v[68:71], v[88:103]
    s_waitcnt lgkmcnt(3)
    ds_read_b128 v[176:179], v8 offset:14528
    ds_read_b128 v[192:195], v10 offset:4096
    v_exp_f32 v36, v36
    v_exp_f32 v37, v37
    v_exp_f32 v38, v38
    v_exp_f32 v39, v39
    v_cvt_pk_bf16_f32 v60, v32, v33
    v_cvt_pk_bf16_f32 v61, v34, v35
    s_mov_b32 s19, 4
.p2align 6
M_loop:
    s_cmp_lg_u32 s19, 1
    s_cbranch_scc1 M_hk_a
    buffer_load_dword v236, v245, s[40:43], 0 offen sc1
    buffer_load_dword v237, v244, s[40:43], 0 offen sc1
    buffer_load_dword v238, v243, s[40:43], 0 offen sc1
M_hk_a:
    s_cmp_lg_u32 s19, 3
    s_cbranch_scc1 M_hk_done
    s_and_b32 s63, s2, 7
    s_lshr_b32 s64, s2, 3
    s_lshr_b32 s52, s63, 1
    s_lshl_b32 s52, s52, 3
    s_and_b32 s65, s64, 7
    s_add_u32 s52, s52, s65
    s_and_b32 s53, s63, 1
    s_lshl_b32 s53, s53, 2
    s_lshr_b32 s65, s64, 3
    s_add_u32 s53, s53, s65
    s_mul_i32 s56, s3, 5120
    s_mul_i32 s58, s53, 240640
    s_add_u32 s58, s58, s56
    s_add_u32 s58, s58, 17825792
    s_lshl_b32 s63, s53, 8
    s_add_u32 s63, s63, 2867200
    v_min_u32 v245, 46, v1
    v_lshl_add_u32 v245, v245, 2, s63
    s_mul_i32 s53, s53, 160
    s_lshl_b32 s57, s52, 1
    s_lshr_b32 s64, s3, 1
    s_add_u32 s57, s57, s64
    s_mul_i32 s54, s57, 96256
    s_and_b32 s64, s3, 1
    s_lshl_b32 s64, s64, 8
    s_add_u32 s54, s54, s64
    s_add_u32 s54, s54, 10747904
    v_lshrrev_b32 v16, 4, v1
    v_lshlrev_b32 v16, 9, v16
    v_and_b32 v17, 15, v1
    v_lshl_add_u32 v240, v17, 4, v16
    v_add_u32 v241, 61440, v4
    v_add_u32 v242, 122880, v4
    s_lshl_b32 s63, s52, 7
    s_add_u32 s63, s63, 2842624
    v_min_u32 v243, 26, v1
    v_lshl_add_u32 v243, v243, 2, s63
    s_lshl_b32 s63, s57, 6
    s_add_u32 s63, s63, 2846720
    v_lshl_add_u32 v244, v17, 2, s63
    v_mov_b32 v16, s69
    v_mov_b32 v17, 0
    s_lshl_b32 s63, s8, 6
    s_lshl_b32 s64, s9, 1
    s_add_u32 s63, s63, s64
    s_add_u32 s63, s63, 2846720
    s_lshl_b32 s65, s10, 7
    s_lshl_b32 s64, s11, 2
    s_add_u32 s65, s65, s64
    s_add_u32 s65, s65, 2842624
    s_cmp_eq_u32 s12, 0
    s_cselect_b32 s65, s22, s65
    s_mov_b64 exec, 1
    buffer_store_dword v16, v17, s[40:43], s61 offen sc1
    buffer_store_dword v16, v17, s[40:43], s63 offen sc1
    buffer_store_dword v16, v17, s[40:43], s65 offen sc1
    s_mov_b64 exec, -1
M_hk_done:
    v_mfma_f32_32x32x16_bf16 v[72:87], v[172:175], v[56:59], v[72:87]
    ds_read_b128 v[196:199], v11 offset:0
    v_exp_f32 v40, v40
    v_exp_f32 v41, v41
    v_cvt_pk_bf16_f32 v62, v36, v37
    v_mfma_f32_32x32x16_bf16 v[104:119], a[0:3], v[180:183], v[104:119]
    s_waitcnt lgkmcnt(5)
    ds_read_b128 v[200:203], v11 offset:4096
    v_exp_f32 v42, v42
    v_exp_f32 v43, v43
    v_cvt_pk_bf16_f32 v63, v38, v39
    v_mfma_f32_32x32x16_bf16 v[24:39], v[156:159], v[136:139], 0
    s_add_u32 m0, s14, 0
    ds_read_b128 v[204:207], v12 offset:0
    buffer_load_dwordx4 v15, s[28:31], s17 offen offset:0 sc1 lds
    v_exp_f32 v44, v44
    v_exp_f32 v45, v45
    v_cvt_pk_bf16_f32 v64, v40, v41
    v_mfma_f32_32x32x16_bf16 v[120:135], a[0:3], v[184:187], v[120:135]
    s_waitcnt lgkmcnt(5)
    ds_read_b128 v[208:211], v12 offset:4096
    v_exp_f32 v46, v46
    v_exp_f32 v47, v47
    v_cvt_pk_bf16_f32 v65, v42, v43
    v_mfma_f32_32x32x8_bf16 v[24:39], v[160:161], v[144:145], v[24:39]
    s_add_u32 m0, s13, 49152
    buffer_load_dwordx4 a[0:3], v4, s[40:43], s18 offen offset:0 sc1
    v_exp_f32 v48, v48
    v_exp_f32 v49, v49
    v_cvt_pk_bf16_f32 v66, v44, v45
    v_mfma_f32_32x32x16_bf16 v[104:119], a[4:7], v[188:191], v[104:119]
    s_waitcnt lgkmcnt(4)
    buffer_load_dwordx4 v13, s[24:27], s16 offen offset:0 lds
    v_exp_f32 v50, v50
    v_exp_f32 v51, v51
    v_cvt_pk_bf16_f32 v67, v46, v47
    v_mfma_f32_32x32x16_bf16 v[72:87], v[176:179], v[60:63], v[72:87]
    s_add_u32 m0, s13, 50176
    v_exp_f32 v52, v52
    v_exp_f32 v53, v53
    v_cvt_pk_bf16_f32 v68, v48, v49
    v_mfma_f32_32x32x16_bf16 v[120:135], a[4:7], v[192:195], v[120:135]
    s_waitcnt lgkmcnt(0)
    buffer_load_dwordx4 v14, s[24:27], s16 offen offset:0 lds
    v_exp_f32 v54, v54
    v_exp_f32 v55, v55
    v_cvt_pk_bf16_f32 v69, v50, v51
    v_mfma_f32_32x32x16_bf16 v[88:103], v[172:175], v[64:67], v[88:103]
    ds_read_b128 v[164:167], v8 offset:16896
    v_exp_f32 v24, v24
    v_exp_f32 v25, v25
    v_cvt_pk_bf16_f32 v70, v52, v53
    v_mfma_f32_32x32x16_bf16 v[104:119], a[8:11], v[196:199], v[104:119]
    ds_read_b128 v[180:183], v9 offset:8192
    v_exp_f32 v26, v26
    v_exp_f32 v27, v27
    v_cvt_pk_bf16_f32 v71, v54, v55
    v_mfma_f32_32x32x16_bf16 v[40:55], v[156:159], v[140:143], 0
    ds_read_b128 v[148:151], v6 offset:15360
    buffer_load_dwordx4 a[4:7], v4, s[40:43], s18 offen offset:1024 sc1
    v_exp_f32 v28, v28
    v_exp_f32 v29, v29
    v_cvt_pk_bf16_f32 v56, v24, v25
    v_mfma_f32_32x32x16_bf16 v[120:135], a[8:11], v[200:203], v[120:135]
    ds_read_b128 v[184:187], v9 offset:12288
    v_exp_f32 v30, v30
    v_exp_f32 v31, v31
    v_cvt_pk_bf16_f32 v57, v26, v27
    v_mfma_f32_32x32x8_bf16 v[40:55], v[160:161], v[146:147], v[40:55]
    ds_read_b64 v[152:153], v7 offset:16384
    buffer_load_dwordx4 a[8:11], v4, s[40:43], s18 offen offset:2048 sc1
    v_exp_f32 v32, v32
    v_exp_f32 v33, v33
    v_cvt_pk_bf16_f32 v58, v28, v29
    v_mfma_f32_32x32x16_bf16 v[104:119], a[12:15], v[204:207], v[104:119]
    ds_read_b128 v[188:191], v10 offset:8192
    v_exp_f32 v34, v34
    v_exp_f32 v35, v35
    v_cvt_pk_bf16_f32 v59, v30, v31
    v_mfma_f32_32x32x16_bf16 v[88:103], v[176:179], v[68:71], v[88:103]
    ds_read_b128 v[168:171], v8 offset:17600
    v_exp_f32 v36, v36
    v_exp_f32 v37, v37
    v_cvt_pk_bf16_f32 v60, v32, v33
    v_mfma_f32_32x32x16_bf16 v[120:135], a[12:15], v[208:211], v[120:135]
    s_waitcnt lgkmcnt(5)
    ds_read_b128 v[192:195], v10 offset:12288
    buffer_load_dwordx4 a[12:15], v4, s[40:43], s18 offen offset:3072 sc1
    s_add_u32 s18, s18, 4096
    v_exp_f32 v38, v38
    v_exp_f32 v39, v39
    v_cvt_pk_bf16_f32 v61, v34, v35
    v_mfma_f32_32x32x16_bf16 v[72:87], v[164:167], v[56:59], v[72:87]
    ds_read_b128 v[196:199], v11 offset:8192
    v_exp_f32 v40, v40
    v_exp_f32 v41, v41
    v_cvt_pk_bf16_f32 v62, v36, v37
    v_mfma_f32_32x32x16_bf16 v[104:119], a[16:19], v[180:183], v[104:119]
    s_waitcnt lgkmcnt(5)
    ds_read_b128 v[200:203], v11 offset:12288
    v_exp_f32 v42, v42
    v_exp_f32 v43, v43
    v_cvt_pk_bf16_f32 v63, v38, v39
    v_mfma_f32_32x32x16_bf16 v[24:39], v[148:151], v[136:139], 0
    s_add_u32 m0, s14, 0
    ds_read_b128 v[204:207], v12 offset:8192
    buffer_load_dwordx4 v15, s[28:31], s17 offen offset:1024 sc1 lds
    v_exp_f32 v44, v44
    v_exp_f32 v45, v45
    v_cvt_pk_bf16_f32 v64, v40, v41
    v_mfma_f32_32x32x16_bf16 v[120:135], a[16:19], v[184:187], v[120:135]
    s_waitcnt lgkmcnt(5)
    ds_read_b128 v[208:211], v12 offset:12288
    v_exp_f32 v46, v46
    v_exp_f32 v47, v47
    v_cvt_pk_bf16_f32 v65, v42, v43
    v_mfma_f32_32x32x8_bf16 v[24:39], v[152:153], v[144:145], v[24:39]
    s_add_u32 m0, s13, 57216
    buffer_load_dwordx4 a[16:19], v4, s[40:43], s18 offen offset:0 sc1
    v_exp_f32 v48, v48
    v_exp_f32 v49, v49
    v_cvt_pk_bf16_f32 v66, v44, v45
    v_mfma_f32_32x32x16_bf16 v[104:119], a[20:23], v[188:191], v[104:119]
    s_waitcnt lgkmcnt(4)
    buffer_load_dwordx4 v13, s[24:27], s16 offen offset:128 lds
    v_exp_f32 v50, v50
    v_exp_f32 v51, v51
    v_cvt_pk_bf16_f32 v67, v46, v47
    v_mfma_f32_32x32x16_bf16 v[72:87], v[168:171], v[60:63], v[72:87]
    s_add_u32 m0, s13, 58240
    v_exp_f32 v52, v52
    v_exp_f32 v53, v53
    v_cvt_pk_bf16_f32 v68, v48, v49
    v_mfma_f32_32x32x16_bf16 v[120:135], a[20:23], v[192:195], v[120:135]
    s_waitcnt lgkmcnt(0)
    buffer_load_dwordx4 v14, s[24:27], s16 offen offset:128 lds
    v_exp_f32 v54, v54
    v_exp_f32 v55, v55
    v_cvt_pk_bf16_f32 v69, v50, v51
    v_mfma_f32_32x32x16_bf16 v[88:103], v[164:167], v[64:67], v[88:103]
    s_waitcnt vmcnt(13)
    s_barrier
    ds_read_b128 v[172:175], v8 offset:19968
    v_exp_f32 v24, v24
    v_exp_f32 v25, v25
    v_cvt_pk_bf16_f32 v70, v52, v53
    v_mfma_f32_32x32x16_bf16 v[104:119], a[24:27], v[196:199], v[104:119]
    ds_read_b128 v[180:183], v9 offset:16384
    v_exp_f32 v26, v26
    v_exp_f32 v27, v27
    v_cvt_pk_bf16_f32 v71, v54, v55
    v_mfma_f32_32x32x16_bf16 v[40:55], v[148:151], v[140:143], 0
    s_add_u32 s16, s16, 256
    s_cmp_ge_u32 s16, 4096
    s_cselect_b32 s16, s22, s16
    ds_read_b128 v[156:159], v6 offset:18432
    buffer_load_dwordx4 a[20:23], v4, s[40:43], s18 offen offset:1024 sc1
    v_exp_f32 v28, v28
    v_exp_f32 v29, v29
    v_cvt_pk_bf16_f32 v56, v24, v25
    v_mfma_f32_32x32x16_bf16 v[120:135], a[24:27], v[200:203], v[120:135]
    ds_read_b128 v[184:187], v9 offset:20480
    v_exp_f32 v30, v30
    v_exp_f32 v31, v31
    v_cvt_pk_bf16_f32 v57, v26, v27
    v_mfma_f32_32x32x8_bf16 v[40:55], v[152:153], v[146:147], v[40:55]
    ds_read_b64 v[160:161], v7 offset:19456
    buffer_load_dwordx4 a[24:27], v4, s[40:43], s18 offen offset:2048 sc1
    v_exp_f32 v32, v32
    v_exp_f32 v33, v33
    v_cvt_pk_bf16_f32 v58, v28, v29
    v_mfma_f32_32x32x16_bf16 v[104:119], a[28:31], v[204:207], v[104:119]
    ds_read_b128 v[188:191], v10 offset:16384
    v_exp_f32 v34, v34
    v_exp_f32 v35, v35
    v_cvt_pk_bf16_f32 v59, v30, v31
    v_mfma_f32_32x32x16_bf16 v[88:103], v[168:171], v[68:71], v[88:103]
    ds_read_b128 v[176:179], v8 offset:20672
    v_exp_f32 v36, v36
    v_exp_f32 v37, v37
    v_cvt_pk_bf16_f32 v60, v32, v33
    v_mfma_f32_32x32x16_bf16 v[120:135], a[28:31], v[208:211], v[120:135]
    s_waitcnt lgkmcnt(5)
    ds_read_b128 v[192:195], v10 offset:20480
    buffer_load_dwordx4 a[28:31], v4, s[40:43], s18 offen offset:3072 sc1
    s_add_u32 s18, s18, 4096
    v_exp_f32 v38, v38
    v_exp_f32 v39, v39
    v_cvt_pk_bf16_f32 v61, v34, v35
    v_mfma_f32_32x32x16_bf16 v[72:87], v[172:175], v[56:59], v[72:87]
    ds_read_b128 v[196:199], v11 offset:16384
    v_exp_f32 v40, v40
    v_exp_f32 v41, v41
    v_cvt_pk_bf16_f32 v62, v36, v37
    v_mfma_f32_32x32x16_bf16 v[104:119], a[32:35], v[180:183], v[104:119]
    s_waitcnt lgkmcnt(5)
    ds_read_b128 v[200:203], v11 offset:20480
    v_exp_f32 v42, v42
    v_exp_f32 v43, v43
    v_cvt_pk_bf16_f32 v63, v38, v39
    v_mfma_f32_32x32x16_bf16 v[24:39], v[156:159], v[136:139], 0
    s_add_u32 m0, s14, 0
    ds_read_b128 v[204:207], v12 offset:16384
    buffer_load_dwordx4 v15, s[28:31], s17 offen offset:2048 sc1 lds
    s_add_u32 s17, s17, 12288
    v_exp_f32 v44, v44
    v_exp_f32 v45, v45
    v_cvt_pk_bf16_f32 v64, v40, v41
    v_mfma_f32_32x32x16_bf16 v[120:135], a[32:35], v[184:187], v[120:135]
    s_waitcnt lgkmcnt(5)
    ds_read_b128 v[208:211], v12 offset:20480
    v_exp_f32 v46, v46
    v_exp_f32 v47, v47
    v_cvt_pk_bf16_f32 v65, v42, v43
    v_mfma_f32_32x32x8_bf16 v[24:39], v[160:161], v[144:145], v[24:39]
    s_add_u32 m0, s13, 0
    buffer_load_dwordx4 a[32:35], v4, s[40:43], s18 offen offset:0 sc1
    v_exp_f32 v48, v48
    v_exp_f32 v49, v49
    v_cvt_pk_bf16_f32 v66, v44, v45
    v_mfma_f32_32x32x16_bf16 v[104:119], a[36:39], v[188:191], v[104:119]
    s_waitcnt lgkmcnt(4)
    buffer_load_dwordx4 v13, s[24:27], s16 offen offset:0 lds
    v_exp_f32 v50, v50
    v_exp_f32 v51, v51
    v_cvt_pk_bf16_f32 v67, v46, v47
    v_mfma_f32_32x32x16_bf16 v[72:87], v[176:179], v[60:63], v[72:87]
    s_add_u32 m0, s13, 1024
    v_exp_f32 v52, v52
    v_exp_f32 v53, v53
    v_cvt_pk_bf16_f32 v68, v48, v49
    v_mfma_f32_32x32x16_bf16 v[120:135], a[36:39], v[192:195], v[120:135]
    s_waitcnt lgkmcnt(0)
    buffer_load_dwordx4 v14, s[24:27], s16 offen offset:0 lds
    v_exp_f32 v54, v54
    v_exp_f32 v55, v55
    v_cvt_pk_bf16_f32 v69, v50, v51
    v_mfma_f32_32x32x16_bf16 v[88:103], v[172:175], v[64:67], v[88:103]
    ds_read_b128 v[164:167], v8 offset:23040
    v_exp_f32 v24, v24
    v_exp_f32 v25, v25
    v_cvt_pk_bf16_f32 v70, v52, v53
    v_mfma_f32_32x32x16_bf16 v[104:119], a[40:43], v[196:199], v[104:119]
    ds_read_b128 v[180:183], v9 offset:24576
    v_exp_f32 v26, v26
    v_exp_f32 v27, v27
    v_cvt_pk_bf16_f32 v71, v54, v55
    v_mfma_f32_32x32x16_bf16 v[40:55], v[156:159], v[140:143], 0
    ds_read_b128 v[148:151], v6 offset:21504
    buffer_load_dwordx4 a[36:39], v4, s[40:43], s18 offen offset:1024 sc1
    v_exp_f32 v28, v28
    v_exp_f32 v29, v29
    v_cvt_pk_bf16_f32 v56, v24, v25
    v_mfma_f32_32x32x16_bf16 v[120:135], a[40:43], v[200:203], v[120:135]
    ds_read_b128 v[184:187], v9 offset:28672
    v_exp_f32 v30, v30
    v_exp_f32 v31, v31
    v_cvt_pk_bf16_f32 v57, v26, v27
    v_mfma_f32_32x32x8_bf16 v[40:55], v[160:161], v[146:147], v[40:55]
    ds_read_b64 v[152:153], v7 offset:22528
    buffer_load_dwordx4 a[40:43], v4, s[40:43], s18 offen offset:2048 sc1
    v_exp_f32 v32, v32
    v_exp_f32 v33, v33
    v_cvt_pk_bf16_f32 v58, v28, v29
    v_mfma_f32_32x32x16_bf16 v[104:119], a[44:47], v[204:207], v[104:119]
    ds_read_b128 v[188:191], v10 offset:24576
    v_exp_f32 v34, v34
    v_exp_f32 v35, v35
    v_cvt_pk_bf16_f32 v59, v30, v31
    v_mfma_f32_32x32x16_bf16 v[88:103], v[176:179], v[68:71], v[88:103]
    ds_read_b128 v[168:171], v8 offset:23744
    v_exp_f32 v36, v36
    v_exp_f32 v37, v37
    v_cvt_pk_bf16_f32 v60, v32, v33
    v_mfma_f32_32x32x16_bf16 v[120:135], a[44:47], v[208:211], v[120:135]
    s_waitcnt lgkmcnt(5)
    ds_read_b128 v[192:195], v10 offset:28672
    buffer_load_dwordx4 a[44:47], v4, s[40:43], s18 offen offset:3072 sc1
    s_add_u32 s18, s18, 4096
    v_exp_f32 v38, v38
    v_exp_f32 v39, v39
    v_cvt_pk_bf16_f32 v61, v34, v35
    v_mfma_f32_32x32x16_bf16 v[72:87], v[164:167], v[56:59], v[72:87]
    ds_read_b128 v[196:199], v11 offset:24576
    v_exp_f32 v40, v40
    v_exp_f32 v41, v41
    v_cvt_pk_bf16_f32 v62, v36, v37
    v_mfma_f32_32x32x16_bf16 v[104:119], a[48:51], v[180:183], v[104:119]
    s_waitcnt lgkmcnt(5)
    ds_read_b128 v[200:203], v11 offset:28672
    v_exp_f32 v42, v42
    v_exp_f32 v43, v43
    v_cvt_pk_bf16_f32 v63, v38, v39
    v_mfma_f32_32x32x16_bf16 v[24:39], v[148:151], v[136:139], 0
    ds_read_b128 v[204:207], v12 offset:24576
    buffer_load_dword v253, v252, s[24:27], s60 offen
    s_add_u32 s60, s60, 1024
    s_cmp_ge_u32 s60, 4096
    s_cselect_b32 s60, s22, s60
    v_exp_f32 v44, v44
    v_exp_f32 v45, v45
    v_cvt_pk_bf16_f32 v64, v40, v41
    v_mfma_f32_32x32x16_bf16 v[120:135], a[48:51], v[184:187], v[120:135]
    s_waitcnt lgkmcnt(5)
    ds_read_b128 v[208:211], v12 offset:28672
    v_exp_f32 v46, v46
    v_exp_f32 v47, v47
    v_cvt_pk_bf16_f32 v65, v42, v43
    v_mfma_f32_32x32x8_bf16 v[24:39], v[152:153], v[144:145], v[24:39]
    s_add_u32 m0, s13, 8064
    buffer_load_dwordx4 a[48:51], v4, s[40:43], s18 offen offset:0 sc1
    v_exp_f32 v48, v48
    v_exp_f32 v49, v49
    v_cvt_pk_bf16_f32 v66, v44, v45
    v_mfma_f32_32x32x16_bf16 v[104:119], a[52:55], v[188:191], v[104:119]
    s_waitcnt lgkmcnt(4)
    buffer_load_dwordx4 v13, s[24:27], s16 offen offset:128 lds
    v_exp_f32 v50, v50
    v_exp_f32 v51, v51
    v_cvt_pk_bf16_f32 v67, v46, v47
    v_mfma_f32_32x32x16_bf16 v[72:87], v[168:171], v[60:63], v[72:87]
    s_add_u32 m0, s13, 9088
    v_exp_f32 v52, v52
    v_exp_f32 v53, v53
    v_cvt_pk_bf16_f32 v68, v48, v49
    v_mfma_f32_32x32x16_bf16 v[120:135], a[52:55], v[192:195], v[120:135]
    s_waitcnt lgkmcnt(0)
    v_xor_b32 v6, 0x8000, v6
    v_xor_b32 v7, 0x8000, v7
    v_xor_b32 v8, 0x8000, v8
    s_xor_b32 s14, s14, 0x8000
    s_xor_b32 s15, s15, 0x8000
    buffer_load_dwordx4 v14, s[24:27], s16 offen offset:128 lds
    v_exp_f32 v54, v54
    v_exp_f32 v55, v55
    v_cvt_pk_bf16_f32 v69, v50, v51
    v_mfma_f32_32x32x16_bf16 v[88:103], v[164:167], v[64:67], v[88:103]
    s_waitcnt vmcnt(13)
    s_barrier
    ds_read_b128 v[172:175], v8 offset:1536
    v_exp_f32 v24, v24
    v_exp_f32 v25, v25
    v_cvt_pk_bf16_f32 v70, v52, v53
    v_mfma_f32_32x32x16_bf16 v[104:119], a[56:59], v[196:199], v[104:119]
    ds_read_b128 v[180:183], v9 offset:32768
    v_exp_f32 v26, v26
    v_exp_f32 v27, v27
    v_cvt_pk_bf16_f32 v71, v54, v55
    v_mfma_f32_32x32x16_bf16 v[40:55], v[148:151], v[140:143], 0
    s_add_u32 s16, s16, 256
    ds_read_b128 v[156:159], v6 offset:0
    buffer_load_dwordx4 a[52:55], v4, s[40:43], s18 offen offset:1024 sc1
    v_exp_f32 v28, v28
    v_exp_f32 v29, v29
    v_cvt_pk_bf16_f32 v56, v24, v25
    v_mfma_f32_32x32x16_bf16 v[120:135], a[56:59], v[200:203], v[120:135]
    ds_read_b128 v[184:187], v9 offset:36864
    v_exp_f32 v30, v30
    v_exp_f32 v31, v31
    v_cvt_pk_bf16_f32 v57, v26, v27
    v_mfma_f32_32x32x8_bf16 v[40:55], v[152:153], v[146:147], v[40:55]
    ds_read_b64 v[160:161], v7 offset:1024
    buffer_load_dwordx4 a[56:59], v4, s[40:43], s18 offen offset:2048 sc1
    v_exp_f32 v32, v32
    v_exp_f32 v33, v33
    v_cvt_pk_bf16_f32 v58, v28, v29
    v_mfma_f32_32x32x16_bf16 v[104:119], a[60:63], v[204:207], v[104:119]
    ds_read_b128 v[188:191], v10 offset:32768
    v_exp_f32 v34, v34
    v_exp_f32 v35, v35
    v_cvt_pk_bf16_f32 v59, v30, v31
    v_mfma_f32_32x32x16_bf16 v[88:103], v[168:171], v[68:71], v[88:103]
    ds_read_b128 v[176:179], v8 offset:2240
    v_exp_f32 v36, v36
    v_exp_f32 v37, v37
    v_cvt_pk_bf16_f32 v60, v32, v33
    v_mfma_f32_32x32x16_bf16 v[120:135], a[60:63], v[208:211], v[120:135]
    s_waitcnt lgkmcnt(5)
    ds_read_b128 v[192:195], v10 offset:36864
    buffer_load_dwordx4 a[60:63], v4, s[40:43], s18 offen offset:3072 sc1
    s_add_u32 s18, s18, 4096
    s_cmp_ge_u32 s18, s21
    s_cselect_b32 s18, s22, s18
    v_exp_f32 v38, v38
    v_exp_f32 v39, v39
    v_cvt_pk_bf16_f32 v61, v34, v35
    v_mfma_f32_32x32x16_bf16 v[72:87], v[172:175], v[56:59], v[72:87]
    ds_read_b128 v[196:199], v11 offset:32768
    v_exp_f32 v40, v40
    v_exp_f32 v41, v41
    v_cvt_pk_bf16_f32 v62, v36, v37
    v_mfma_f32_32x32x16_bf16 v[104:119], a[0:3], v[180:183], v[104:119]
    s_waitcnt lgkmcnt(5)
    ds_read_b128 v[200:203], v11 offset:36864
    v_exp_f32 v42, v42
    v_exp_f32 v43, v43
    v_cvt_pk_bf16_f32 v63, v38, v39
    v_mfma_f32_32x32x16_bf16 v[24:39], v[156:159], v[136:139], 0
    s_add_u32 m0, s15, 12288
    ds_read_b128 v[204:207], v12 offset:32768
    buffer_load_dwordx4 v15, s[28:31], s17 offen offset:0 sc1 lds
    v_exp_f32 v44, v44
    v_exp_f32 v45, v45
    v_cvt_pk_bf16_f32 v64, v40, v41
    v_mfma_f32_32x32x16_bf16 v[120:135], a[0:3], v[184:187], v[120:135]
    s_waitcnt lgkmcnt(5)
    ds_read_b128 v[208:211], v12 offset:36864
    v_exp_f32 v46, v46
    v_exp_f32 v47, v47
    v_cvt_pk_bf16_f32 v65, v42, v43
    v_mfma_f32_32x32x8_bf16 v[24:39], v[160:161], v[144:145], v[24:39]
    s_add_u32 m0, s13, 16384
    buffer_load_dwordx4 a[0:3], v4, s[40:43], s18 offen offset:0 sc1
    v_exp_f32 v48, v48
    v_exp_f32 v49, v49
    v_cvt_pk_bf16_f32 v66, v44, v45
    v_mfma_f32_32x32x16_bf16 v[104:119], a[4:7], v[188:191], v[104:119]
    s_waitcnt lgkmcnt(4)
    buffer_load_dwordx4 v13, s[24:27], s16 offen offset:0 lds
    v_exp_f32 v50, v50
    v_exp_f32 v51, v51
    v_cvt_pk_bf16_f32 v67, v46, v47
    v_mfma_f32_32x32x16_bf16 v[72:87], v[176:179], v[60:63], v[72:87]
    s_add_u32 m0, s13, 17408
    v_exp_f32 v52, v52
    v_exp_f32 v53, v53
    v_cvt_pk_bf16_f32 v68, v48, v49
    v_mfma_f32_32x32x16_bf16 v[120:135], a[4:7], v[192:195], v[120:135]
    s_waitcnt lgkmcnt(0)
    buffer_load_dwordx4 v14, s[24:27], s16 offen offset:0 lds
    v_exp_f32 v54, v54
    v_exp_f32 v55, v55
    v_cvt_pk_bf16_f32 v69, v50, v51
    v_mfma_f32_32x32x16_bf16 v[88:103], v[172:175], v[64:67], v[88:103]
    ds_read_b128 v[164:167], v8 offset:4608
    v_exp_f32 v24, v24
    v_exp_f32 v25, v25
    v_cvt_pk_bf16_f32 v70, v52, v53
    v_mfma_f32_32x32x16_bf16 v[104:119], a[8:11], v[196:199], v[104:119]
    ds_read_b128 v[180:183], v9 offset:40960
    v_exp_f32 v26, v26
    v_exp_f32 v27, v27
    v_cvt_pk_bf16_f32 v71, v54, v55
    v_mfma_f32_32x32x16_bf16 v[40:55], v[156:159], v[140:143], 0
    ds_read_b128 v[148:151], v6 offset:3072
    buffer_load_dwordx4 a[4:7], v4, s[40:43], s18 offen offset:1024 sc1
    v_exp_f32 v28, v28
    v_exp_f32 v29, v29
    v_cvt_pk_bf16_f32 v56, v24, v25
    v_mfma_f32_32x32x16_bf16 v[120:135], a[8:11], v[200:203], v[120:135]
    ds_read_b128 v[184:187], v9 offset:45056
    v_exp_f32 v30, v30
    v_exp_f32 v31, v31
    v_cvt_pk_bf16_f32 v57, v26, v27
    v_mfma_f32_32x32x8_bf16 v[40:55], v[160:161], v[146:147], v[40:55]
    ds_read_b64 v[152:153], v7 offset:4096
    buffer_load_dwordx4 a[8:11], v4, s[40:43], s18 offen offset:2048 sc1
    v_exp_f32 v32, v32
    v_exp_f32 v33, v33
    v_cvt_pk_bf16_f32 v58, v28, v29
    v_mfma_f32_32x32x16_bf16 v[104:119], a[12:15], v[204:207], v[104:119]
    ds_read_b128 v[188:191], v10 offset:40960
    v_exp_f32 v34, v34
    v_exp_f32 v35, v35
    v_cvt_pk_bf16_f32 v59, v30, v31
    v_mfma_f32_32x32x16_bf16 v[88:103], v[176:179], v[68:71], v[88:103]
    ds_read_b128 v[168:171], v8 offset:5312
    v_exp_f32 v36, v36
    v_exp_f32 v37, v37
    v_cvt_pk_bf16_f32 v60, v32, v33
    v_mfma_f32_32x32x16_bf16 v[120:135], a[12:15], v[208:211], v[120:135]
    s_waitcnt lgkmcnt(5)
    ds_read_b128 v[192:195], v10 offset:45056
    buffer_load_dwordx4 a[12:15], v4, s[40:43], s18 offen offset:3072 sc1
    s_add_u32 s18, s18, 4096
    v_exp_f32 v38, v38
    v_exp_f32 v39, v39
    v_cvt_pk_bf16_f32 v61, v34, v35
    v_mfma_f32_32x32x16_bf16 v[72:87], v[164:167], v[56:59], v[72:87]
    ds_read_b128 v[196:199], v11 offset:40960
    v_exp_f32 v40, v40
    v_exp_f32 v41, v41
    v_cvt_pk_bf16_f32 v62, v36, v37
    v_mfma_f32_32x32x16_bf16 v[104:119], a[16:19], v[180:183], v[104:119]
    s_waitcnt lgkmcnt(5)
    ds_read_b128 v[200:203], v11 offset:45056
    v_exp_f32 v42, v42
    v_exp_f32 v43, v43
    v_cvt_pk_bf16_f32 v63, v38, v39
    v_mfma_f32_32x32x16_bf16 v[24:39], v[148:151], v[136:139], 0
    s_add_u32 m0, s15, 12288
    ds_read_b128 v[204:207], v12 offset:40960
    buffer_load_dwordx4 v15, s[28:31], s17 offen offset:1024 sc1 lds
    v_exp_f32 v44, v44
    v_exp_f32 v45, v45
    v_cvt_pk_bf16_f32 v64, v40, v41
    v_mfma_f32_32x32x16_bf16 v[120:135], a[16:19], v[184:187], v[120:135]
    s_waitcnt lgkmcnt(5)
    ds_read_b128 v[208:211], v12 offset:45056
    v_exp_f32 v46, v46
    v_exp_f32 v47, v47
    v_cvt_pk_bf16_f32 v65, v42, v43
    v_mfma_f32_32x32x8_bf16 v[24:39], v[152:153], v[144:145], v[24:39]
    s_add_u32 m0, s13, 24448
    buffer_load_dwordx4 a[16:19], v4, s[40:43], s18 offen offset:0 sc1
    v_exp_f32 v48, v48
    v_exp_f32 v49, v49
    v_cvt_pk_bf16_f32 v66, v44, v45
    v_mfma_f32_32x32x16_bf16 v[104:119], a[20:23], v[188:191], v[104:119]
    s_waitcnt lgkmcnt(4)
    buffer_load_dwordx4 v13, s[24:27], s16 offen offset:128 lds
    v_exp_f32 v50, v50
    v_exp_f32 v51, v51
    v_cvt_pk_bf16_f32 v67, v46, v47
    v_mfma_f32_32x32x16_bf16 v[72:87], v[168:171], v[60:63], v[72:87]
    s_add_u32 m0, s13, 25472
    v_exp_f32 v52, v52
    v_exp_f32 v53, v53
    v_cvt_pk_bf16_f32 v68, v48, v49
    v_mfma_f32_32x32x16_bf16 v[120:135], a[20:23], v[192:195], v[120:135]
    s_waitcnt lgkmcnt(0)
    buffer_load_dwordx4 v14, s[24:27], s16 offen offset:128 lds
    v_exp_f32 v54, v54
    v_exp_f32 v55, v55
    v_cvt_pk_bf16_f32 v69, v50, v51
    v_mfma_f32_32x32x16_bf16 v[88:103], v[164:167], v[64:67], v[88:103]
    s_waitcnt vmcnt(13)
    s_barrier
    ds_read_b128 v[172:175], v8 offset:7680
    v_exp_f32 v24, v24
    v_exp_f32 v25, v25
    v_cvt_pk_bf16_f32 v70, v52, v53
    v_mfma_f32_32x32x16_bf16 v[104:119], a[24:27], v[196:199], v[104:119]
    ds_read_b128 v[180:183], v9 offset:49152
    v_exp_f32 v26, v26
    v_exp_f32 v27, v27
    v_cvt_pk_bf16_f32 v71, v54, v55
    v_mfma_f32_32x32x16_bf16 v[40:55], v[148:151], v[140:143], 0
    s_add_u32 s16, s16, 256
    ds_read_b128 v[156:159], v6 offset:6144
    buffer_load_dwordx4 a[20:23], v4, s[40:43], s18 offen offset:1024 sc1
    v_exp_f32 v28, v28
    v_exp_f32 v29, v29
    v_cvt_pk_bf16_f32 v56, v24, v25
    v_mfma_f32_32x32x16_bf16 v[120:135], a[24:27], v[200:203], v[120:135]
    ds_read_b128 v[184:187], v9 offset:53248
    v_exp_f32 v30, v30
    v_exp_f32 v31, v31
    v_cvt_pk_bf16_f32 v57, v26, v27
    v_mfma_f32_32x32x8_bf16 v[40:55], v[152:153], v[146:147], v[40:55]
    ds_read_b64 v[160:161], v7 offset:7168
    buffer_load_dwordx4 a[24:27], v4, s[40:43], s18 offen offset:2048 sc1
    v_exp_f32 v32, v32
    v_exp_f32 v33, v33
    v_cvt_pk_bf16_f32 v58, v28, v29
    v_mfma_f32_32x32x16_bf16 v[104:119], a[28:31], v[204:207], v[104:119]
    ds_read_b128 v[188:191], v10 offset:49152
    v_exp_f32 v34, v34
    v_exp_f32 v35, v35
    v_cvt_pk_bf16_f32 v59, v30, v31
    v_mfma_f32_32x32x16_bf16 v[88:103], v[168:171], v[68:71], v[88:103]
    ds_read_b128 v[176:179], v8 offset:8384
    v_exp_f32 v36, v36
    v_exp_f32 v37, v37
    v_cvt_pk_bf16_f32 v60, v32, v33
    v_mfma_f32_32x32x16_bf16 v[120:135], a[28:31], v[208:211], v[120:135]
    s_waitcnt lgkmcnt(5)
    ds_read_b128 v[192:195], v10 offset:53248
    buffer_load_dwordx4 a[28:31], v4, s[40:43], s18 offen offset:3072 sc1
    s_add_u32 s18, s18, 4096
    v_exp_f32 v38, v38
    v_exp_f32 v39, v39
    v_cvt_pk_bf16_f32 v61, v34, v35
    v_mfma_f32_32x32x16_bf16 v[72:87], v[172:175], v[56:59], v[72:87]
    ds_read_b128 v[196:199], v11 offset:49152
    v_exp_f32 v40, v40
    v_exp_f32 v41, v41
    v_cvt_pk_bf16_f32 v62, v36, v37
    v_mfma_f32_32x32x16_bf16 v[104:119], a[32:35], v[180:183], v[104:119]
    s_waitcnt lgkmcnt(5)
    ds_read_b128 v[200:203], v11 offset:53248
    v_exp_f32 v42, v42
    v_exp_f32 v43, v43
    v_cvt_pk_bf16_f32 v63, v38, v39
    v_mfma_f32_32x32x16_bf16 v[24:39], v[156:159], v[136:139], 0
    s_add_u32 m0, s15, 12288
    ds_read_b128 v[204:207], v12 offset:49152
    buffer_load_dwordx4 v15, s[28:31], s17 offen offset:2048 sc1 lds
    s_add_u32 s17, s17, 12288
    v_exp_f32 v44, v44
    v_exp_f32 v45, v45
    v_cvt_pk_bf16_f32 v64, v40, v41
    v_mfma_f32_32x32x16_bf16 v[120:135], a[32:35], v[184:187], v[120:135]
    s_waitcnt lgkmcnt(5)
    ds_read_b128 v[208:211], v12 offset:53248
    v_exp_f32 v46, v46
    v_exp_f32 v47, v47
    v_cvt_pk_bf16_f32 v65, v42, v43
    v_mfma_f32_32x32x8_bf16 v[24:39], v[160:161], v[144:145], v[24:39]
    s_add_u32 m0, s13, 32768
    buffer_load_dwordx4 a[32:35], v4, s[40:43], s18 offen offset:0 sc1
    v_exp_f32 v48, v48
    v_exp_f32 v49, v49
    v_cvt_pk_bf16_f32 v66, v44, v45
    v_mfma_f32_32x32x16_bf16 v[104:119], a[36:39], v[188:191], v[104:119]
    s_waitcnt lgkmcnt(4)
    buffer_load_dwordx4 v13, s[24:27], s16 offen offset:0 lds
    v_exp_f32 v50, v50
    v_exp_f32 v51, v51
    v_cvt_pk_bf16_f32 v67, v46, v47
    v_mfma_f32_32x32x16_bf16 v[72:87], v[176:179], v[60:63], v[72:87]
    s_add_u32 m0, s13, 33792
    v_exp_f32 v52, v52
    v_exp_f32 v53, v53
    v_cvt_pk_bf16_f32 v68, v48, v49
    v_mfma_f32_32x32x16_bf16 v[120:135], a[36:39], v[192:195], v[120:135]
    s_waitcnt lgkmcnt(0)
    buffer_load_dwordx4 v14, s[24:27], s16 offen offset:0 lds
    v_exp_f32 v54, v54
    v_exp_f32 v55, v55
    v_cvt_pk_bf16_f32 v69, v50, v51
    v_mfma_f32_32x32x16_bf16 v[88:103], v[172:175], v[64:67], v[88:103]
    ds_read_b128 v[164:167], v8 offset:10752
    v_exp_f32 v24, v24
    v_exp_f32 v25, v25
    v_cvt_pk_bf16_f32 v70, v52, v53
    v_mfma_f32_32x32x16_bf16 v[104:119], a[40:43], v[196:199], v[104:119]
    ds_read_b128 v[180:183], v9 offset:57344
    v_exp_f32 v26, v26
    v_exp_f32 v27, v27
    v_cvt_pk_bf16_f32 v71, v54, v55
    v_mfma_f32_32x32x16_bf16 v[40:55], v[156:159], v[140:143], 0
    ds_read_b128 v[148:151], v6 offset:9216
    buffer_load_dwordx4 a[36:39], v4, s[40:43], s18 offen offset:1024 sc1
    v_exp_f32 v28, v28
    v_exp_f32 v29, v29
    v_cvt_pk_bf16_f32 v56, v24, v25
    v_mfma_f32_32x32x16_bf16 v[120:135], a[40:43], v[200:203], v[120:135]
    ds_read_b128 v[184:187], v9 offset:61440
    v_exp_f32 v30, v30
    v_exp_f32 v31, v31
    v_cvt_pk_bf16_f32 v57, v26, v27
    v_mfma_f32_32x32x8_bf16 v[40:55], v[160:161], v[146:147], v[40:55]
    ds_read_b64 v[152:153], v7 offset:10240
    buffer_load_dwordx4 a[40:43], v4, s[40:43], s18 offen offset:2048 sc1
    v_exp_f32 v32, v32
    v_exp_f32 v33, v33
    v_cvt_pk_bf16_f32 v58, v28, v29
    v_mfma_f32_32x32x16_bf16 v[104:119], a[44:47], v[204:207], v[104:119]
    ds_read_b128 v[188:191], v10 offset:57344
    v_exp_f32 v34, v34
    v_exp_f32 v35, v35
    v_cvt_pk_bf16_f32 v59, v30, v31
    v_mfma_f32_32x32x16_bf16 v[88:103], v[176:179], v[68:71], v[88:103]
    ds_read_b128 v[168:171], v8 offset:11456
    v_exp_f32 v36, v36
    v_exp_f32 v37, v37
    v_cvt_pk_bf16_f32 v60, v32, v33
    v_mfma_f32_32x32x16_bf16 v[120:135], a[44:47], v[208:211], v[120:135]
    s_waitcnt lgkmcnt(5)
    ds_read_b128 v[192:195], v10 offset:61440
    buffer_load_dwordx4 a[44:47], v4, s[40:43], s18 offen offset:3072 sc1
    s_add_u32 s18, s18, 4096
    v_exp_f32 v38, v38
    v_exp_f32 v39, v39
    v_cvt_pk_bf16_f32 v61, v34, v35
    v_mfma_f32_32x32x16_bf16 v[72:87], v[164:167], v[56:59], v[72:87]
    ds_read_b128 v[196:199], v11 offset:57344
    v_exp_f32 v40, v40
    v_exp_f32 v41, v41
    v_cvt_pk_bf16_f32 v62, v36, v37
    v_mfma_f32_32x32x16_bf16 v[104:119], a[48:51], v[180:183], v[104:119]
    s_waitcnt lgkmcnt(5)
    ds_read_b128 v[200:203], v11 offset:61440
    v_exp_f32 v42, v42
    v_exp_f32 v43, v43
    v_cvt_pk_bf16_f32 v63, v38, v39
    v_mfma_f32_32x32x16_bf16 v[24:39], v[148:151], v[136:139], 0
    ds_read_b128 v[204:207], v12 offset:57344
    v_exp_f32 v44, v44
    v_exp_f32 v45, v45
    v_cvt_pk_bf16_f32 v64, v40, v41
    v_mfma_f32_32x32x16_bf16 v[120:135], a[48:51], v[184:187], v[120:135]
    s_waitcnt lgkmcnt(5)
    ds_read_b128 v[208:211], v12 offset:61440
    v_exp_f32 v46, v46
    v_exp_f32 v47, v47
    v_cvt_pk_bf16_f32 v65, v42, v43
    v_mfma_f32_32x32x8_bf16 v[24:39], v[152:153], v[144:145], v[24:39]
    s_add_u32 m0, s13, 40832
    buffer_load_dwordx4 a[48:51], v4, s[40:43], s18 offen offset:0 sc1
    v_exp_f32 v48, v48
    v_exp_f32 v49, v49
    v_cvt_pk_bf16_f32 v66, v44, v45
    v_mfma_f32_32x32x16_bf16 v[104:119], a[52:55], v[188:191], v[104:119]
    s_waitcnt lgkmcnt(4)
    buffer_load_dwordx4 v13, s[24:27], s16 offen offset:128 lds
    v_exp_f32 v50, v50
    v_exp_f32 v51, v51
    v_cvt_pk_bf16_f32 v67, v46, v47
    v_mfma_f32_32x32x16_bf16 v[72:87], v[168:171], v[60:63], v[72:87]
    s_add_u32 m0, s13, 41856
    v_exp_f32 v52, v52
    v_exp_f32 v53, v53
    v_cvt_pk_bf16_f32 v68, v48, v49
    v_mfma_f32_32x32x16_bf16 v[120:135], a[52:55], v[192:195], v[120:135]
    s_waitcnt lgkmcnt(0)
    buffer_load_dwordx4 v14, s[24:27], s16 offen offset:128 lds
    v_exp_f32 v54, v54
    v_exp_f32 v55, v55
    v_cvt_pk_bf16_f32 v69, v50, v51
    v_mfma_f32_32x32x16_bf16 v[88:103], v[164:167], v[64:67], v[88:103]
    s_waitcnt vmcnt(12)
    s_barrier
    ds_read_b128 v[172:175], v8 offset:13824
    v_exp_f32 v24, v24
    v_exp_f32 v25, v25
    v_cvt_pk_bf16_f32 v70, v52, v53
    v_mfma_f32_32x32x16_bf16 v[104:119], a[56:59], v[196:199], v[104:119]
    ds_read_b128 v[180:183], v9 offset:0
    v_exp_f32 v26, v26
    v_exp_f32 v27, v27
    v_cvt_pk_bf16_f32 v71, v54, v55
    v_mfma_f32_32x32x16_bf16 v[40:55], v[148:151], v[140:143], 0
    s_add_u32 s16, s16, 256
    ds_read_b128 v[156:159], v6 offset:12288
    buffer_load_dwordx4 a[52:55], v4, s[40:43], s18 offen offset:1024 sc1
    v_exp_f32 v28, v28
    v_exp_f32 v29, v29
    v_cvt_pk_bf16_f32 v56, v24, v25
    v_mfma_f32_32x32x16_bf16 v[120:135], a[56:59], v[200:203], v[120:135]
    ds_read_b128 v[184:187], v9 offset:4096
    v_exp_f32 v30, v30
    v_exp_f32 v31, v31
    v_cvt_pk_bf16_f32 v57, v26, v27
    v_mfma_f32_32x32x8_bf16 v[40:55], v[152:153], v[146:147], v[40:55]
    ds_read_b64 v[160:161], v7 offset:13312
    buffer_load_dwordx4 a[56:59], v4, s[40:43], s18 offen offset:2048 sc1
    v_exp_f32 v32, v32
    v_exp_f32 v33, v33
    v_cvt_pk_bf16_f32 v58, v28, v29
    v_mfma_f32_32x32x16_bf16 v[104:119], a[60:63], v[204:207], v[104:119]
    ds_read_b128 v[188:191], v10 offset:0
    v_exp_f32 v34, v34
    v_exp_f32 v35, v35
    v_cvt_pk_bf16_f32 v59, v30, v31
    v_mfma_f32_32x32x16_bf16 v[88:103], v[168:171], v[68:71], v[88:103]
    ds_read_b128 v[176:179], v8 offset:14528
    v_exp_f32 v36, v36
    v_exp_f32 v37, v37
    v_cvt_pk_bf16_f32 v60, v32, v33
    v_mfma_f32_32x32x16_bf16 v[120:135], a[60:63], v[208:211], v[120:135]
    s_waitcnt lgkmcnt(5)
    ds_read_b128 v[192:195], v10 offset:4096
    buffer_load_dwordx4 a[60:63], v4, s[40:43], s18 offen offset:3072 sc1
    s_add_u32 s18, s18, 4096
    v_exp_f32 v38, v38
    v_exp_f32 v39, v39
    v_cvt_pk_bf16_f32 v61, v34, v35
    s_sub_u32 s19, s19, 1
    s_cmp_lg_u32 s19, 0
    s_cbranch_scc1 M_loop
M_after:
    s_mov_b64 s[24:25], s[78:79]
    s_mov_b32 s26, 2621440
    s_mov_b32 s65, 0
M_fw_chk:
    v_cmp_ne_u32 vcc, s69, v236
    v_cmp_ne_u32 s[6:7], s69, v237
    s_nop 0
    s_or_b64 vcc, vcc, s[6:7]
    v_cmp_ne_u32 s[6:7], s69, v238
    s_nop 0
    s_or_b64 vcc, vcc, s[6:7]
    s_cbranch_vccz M_fw_ok
    s_sleep 1
    buffer_load_dword v236, v245, s[40:43], 0 offen sc1
    buffer_load_dword v237, v244, s[40:43], 0 offen sc1
    buffer_load_dword v238, v243, s[40:43], 0 offen sc1
    s_waitcnt vmcnt(0)
    s_add_u32 s65, s65, 1
    s_cmp_lt_u32 s65, 262144
    s_cbranch_scc1 M_fw_chk
M_fw_ok:
    s_and_b32 s63, s52, 7
    s_lshl_b32 s63, s63, 2
    s_add_u32 s63, s63, s3
    s_mul_i32 s63, s63, 3200
    s_sub_u32 s64, s58, s56
    v_lshrrev_b32 v16, 1, v1
    v_min_u32 v16, 24, v16
    v_lshl_add_u32 v16, v16, 7, s63
    buffer_load_dword v253, v16, s[40:43], s64 offen sc1
    v_mfma_f32_32x32x16_bf16 v[72:87], v[172:175], v[56:59], v[72:87]
    s_waitcnt lgkmcnt(5)
    s_add_u32 m0, s56, 122880
    s_add_u32 s55, s58, 163840
    s_nop 0
    buffer_load_dwordx4 v4, s[40:43], s55 offen offset:0 sc1 lds
    v_exp_f32 v40, v40
    v_exp_f32 v41, v41
    v_exp_f32 v42, v42
    v_exp_f32 v43, v43
    v_cvt_pk_bf16_f32 v62, v36, v37
    v_cvt_pk_bf16_f32 v63, v38, v39
    v_mfma_f32_32x32x16_bf16 v[24:39], v[156:159], v[136:139], 0
    s_waitcnt lgkmcnt(1)
    s_add_u32 m0, s56, 122880
    s_nop 0
    buffer_load_dwordx4 v4, s[40:43], s55 offen offset:1024 sc1 lds
    v_exp_f32 v44, v44
    v_exp_f32 v45, v45
    v_exp_f32 v46, v46
    v_exp_f32 v47, v47
    v_cvt_pk_bf16_f32 v64, v40, v41
    v_cvt_pk_bf16_f32 v65, v42, v43
    v_mfma_f32_32x32x8_bf16 v[24:39], v[160:161], v[144:145], v[24:39]
    s_add_u32 m0, s56, 122880
    s_nop 0
    buffer_load_dwordx4 v4, s[40:43], s55 offen offset:2048 sc1 lds
    v_exp_f32 v48, v48
    v_exp_f32 v49, v49
    v_exp_f32 v50, v50
    v_exp_f32 v51, v51
    v_cvt_pk_bf16_f32 v66, v44, v45
    v_cvt_pk_bf16_f32 v67, v46, v47
    s_mov_b32 s65, 0
M_gt_chk:
    v_cmp_ne_u32 vcc, s69, v229
    v_cmp_ne_u32 s[6:7], s69, v231
    s_nop 0
    s_or_b64 vcc, vcc, s[6:7]
    v_cmp_ne_u32 s[6:7], s69, v233
    s_nop 0
    s_or_b64 vcc, vcc, s[6:7]
    s_cbranch_vccz M_gt_ok
    s_sleep 1
    buffer_load_dwordx2 v[228:229], v23, s[40:43], s23 offen sc1
    buffer_load_dwordx2 v[230:231], v23, s[40:43], s4 offen sc1
    buffer_load_dwordx2 v[232:233], v23, s[40:43], s4 offen offset:256 sc1
    s_waitcnt vmcnt(0)
    s_add_u32 s65, s65, 1
    s_cmp_lt_u32 s65, 262144
    s_cbranch_scc1 M_gt_chk
M_gt_ok:
    v_sub_f32 v16, 1.0, v230
    v_lshlrev_b32 v18, 16, v234
    v_mul_f32 v18, v18, v16
    v_mov_b32 v17, v16
    v_mov_b32 v19, v18
    v_pk_fma_f32 v[104:105], v[104:105], v[16:17], v[18:19]
    v_pk_fma_f32 v[106:107], v[106:107], v[16:17], v[18:19]
    v_pk_fma_f32 v[108:109], v[108:109], v[16:17], v[18:19]
    v_pk_fma_f32 v[110:111], v[110:111], v[16:17], v[18:19]
    v_pk_fma_f32 v[112:113], v[112:113], v[16:17], v[18:19]
    v_pk_fma_f32 v[114:115], v[114:115], v[16:17], v[18:19]
    v_pk_fma_f32 v[116:117], v[116:117], v[16:17], v[18:19]
    v_pk_fma_f32 v[118:119], v[118:119], v[16:17], v[18:19]
    v_lshlrev_b32 v196, 16, v212
    v_and_b32 v197, 0xffff0000, v212
    v_lshlrev_b32 v198, 16, v213
    v_and_b32 v199, 0xffff0000, v213
    v_lshlrev_b32 v200, 16, v214
    v_and_b32 v201, 0xffff0000, v214
    v_lshlrev_b32 v202, 16, v215
    v_and_b32 v203, 0xffff0000, v215
    v_lshlrev_b32 v204, 16, v216
    v_and_b32 v205, 0xffff0000, v216
    v_lshlrev_b32 v206, 16, v217
    v_and_b32 v207, 0xffff0000, v217
    v_lshlrev_b32 v208, 16, v218
    v_and_b32 v209, 0xffff0000, v218
    v_lshlrev_b32 v210, 16, v219
    v_and_b32 v211, 0xffff0000, v219
    v_pk_mul_f32 v[104:105], v[104:105], v[196:197]
    v_pk_mul_f32 v[106:107], v[106:107], v[198:199]
    v_pk_mul_f32 v[108:109], v[108:109], v[200:201]
    v_pk_mul_f32 v[110:111], v[110:111], v[202:203]
    v_pk_mul_f32 v[112:113], v[112:113], v[204:205]
    v_pk_mul_f32 v[114:115], v[114:115], v[206:207]
    v_pk_mul_f32 v[116:117], v[116:117], v[208:209]
    v_pk_mul_f32 v[118:119], v[118:119], v[210:211]
    v_cvt_pk_bf16_f32 v212, v104, v105
    v_cvt_pk_bf16_f32 v213, v106, v107
    v_cvt_pk_bf16_f32 v214, v108, v109
    v_cvt_pk_bf16_f32 v215, v110, v111
    v_cvt_pk_bf16_f32 v216, v112, v113
    v_cvt_pk_bf16_f32 v217, v114, v115
    v_cvt_pk_bf16_f32 v218, v116, v117
    v_cvt_pk_bf16_f32 v219, v118, v119
    buffer_store_dwordx4 v[212:215], v4, s[40:43], s59 offen sc1
    buffer_store_dwordx4 v[216:219], v4, s[40:43], s59 offen offset:1024 sc1
    v_sub_f32 v16, 1.0, v232
    v_lshlrev_b32 v18, 16, v235
    v_mul_f32 v18, v18, v16
    v_mov_b32 v17, v16
    v_mov_b32 v19, v18
    v_pk_fma_f32 v[120:121], v[120:121], v[16:17], v[18:19]
    v_pk_fma_f32 v[122:123], v[122:123], v[16:17], v[18:19]
    v_pk_fma_f32 v[124:125], v[124:125], v[16:17], v[18:19]
    v_pk_fma_f32 v[126:127], v[126:127], v[16:17], v[18:19]
    v_pk_fma_f32 v[128:129], v[128:129], v[16:17], v[18:19]
    v_pk_fma_f32 v[130:131], v[130:131], v[16:17], v[18:19]
    v_pk_fma_f32 v[132:133], v[132:133], v[16:17], v[18:19]
    v_pk_fma_f32 v[134:135], v[134:135], v[16:17], v[18:19]
    v_lshlrev_b32 v196, 16, v220
    v_and_b32 v197, 0xffff0000, v220
    v_lshlrev_b32 v198, 16, v221
    v_and_b32 v199, 0xffff0000, v221
    v_lshlrev_b32 v200, 16, v222
    v_and_b32 v201, 0xffff0000, v222
    v_lshlrev_b32 v202, 16, v223
    v_and_b32 v203, 0xffff0000, v223
    v_lshlrev_b32 v204, 16, v224
    v_and_b32 v205, 0xffff0000, v224
    v_lshlrev_b32 v206, 16, v225
    v_and_b32 v207, 0xffff0000, v225
    v_lshlrev_b32 v208, 16, v226
    v_and_b32 v209, 0xffff0000, v226
    v_lshlrev_b32 v210, 16, v227
    v_and_b32 v211, 0xffff0000, v227
    v_pk_mul_f32 v[120:121], v[120:121], v[196:197]
    v_pk_mul_f32 v[122:123], v[122:123], v[198:199]
    v_pk_mul_f32 v[124:125], v[124:125], v[200:201]
    v_pk_mul_f32 v[126:127], v[126:127], v[202:203]
    v_pk_mul_f32 v[128:129], v[128:129], v[204:205]
    v_pk_mul_f32 v[130:131], v[130:131], v[206:207]
    v_pk_mul_f32 v[132:133], v[132:133], v[208:209]
    v_pk_mul_f32 v[134:135], v[134:135], v[210:211]
    v_cvt_pk_bf16_f32 v220, v120, v121
    v_cvt_pk_bf16_f32 v221, v122, v123
    v_cvt_pk_bf16_f32 v222, v124, v125
    v_cvt_pk_bf16_f32 v223, v126, v127
    v_cvt_pk_bf16_f32 v224, v128, v129
    v_cvt_pk_bf16_f32 v225, v130, v131
    v_cvt_pk_bf16_f32 v226, v132, v133
    v_cvt_pk_bf16_f32 v227, v134, v135
    buffer_store_dwordx4 v[220:223], v4, s[40:43], s66 offen sc1
    buffer_store_dwordx4 v[224:227], v4, s[40:43], s66 offen offset:1024 sc1
    v_mfma_f32_32x32x16_bf16 v[72:87], v[176:179], v[60:63], v[72:87]
    s_add_u32 m0, s56, 122880
    s_nop 0
    buffer_load_dwordx4 v4, s[40:43], s55 offen offset:3072 sc1 lds
    v_exp_f32 v52, v52
    v_exp_f32 v53, v53
    v_exp_f32 v54, v54
    v_exp_f32 v55, v55
    v_cvt_pk_bf16_f32 v68, v48, v49
    v_cvt_pk_bf16_f32 v69, v50, v51
    v_mfma_f32_32x32x16_bf16 v[88:103], v[172:175], v[64:67], v[88:103]
    s_add_u32 m0, s56, 126976
    s_add_u32 s55, s55, 4096
    ds_read_b128 v[164:167], v8 offset:16896
    buffer_load_dwordx4 v4, s[40:43], s55 offen offset:0 sc1 lds
    v_exp_f32 v24, v24
    v_exp_f32 v25, v25
    v_exp_f32 v26, v26
    v_exp_f32 v27, v27
    v_cvt_pk_bf16_f32 v70, v52, v53
    v_cvt_pk_bf16_f32 v71, v54, v55
    v_mfma_f32_32x32x16_bf16 v[40:55], v[156:159], v[140:143], 0
    ds_read_b128 v[148:151], v6 offset:15360
    v_exp_f32 v28, v28
    v_exp_f32 v29, v29
    v_exp_f32 v30, v30
    v_exp_f32 v31, v31
    v_cvt_pk_bf16_f32 v56, v24, v25
    v_cvt_pk_bf16_f32 v57, v26, v27
    v_mfma_f32_32x32x8_bf16 v[40:55], v[160:161], v[146:147], v[40:55]
    ds_read_b64 v[152:153], v7 offset:16384
    v_exp_f32 v32, v32
    v_exp_f32 v33, v33
    v_exp_f32 v34, v34
    v_exp_f32 v35, v35
    v_cvt_pk_bf16_f32 v58, v28, v29
    v_cvt_pk_bf16_f32 v59, v30, v31
    v_mfma_f32_32x32x16_bf16 v[88:103], v[176:179], v[68:71], v[88:103]
    s_waitcnt lgkmcnt(1)
    ds_read_b128 v[168:171], v8 offset:17600
    v_exp_f32 v36, v36
    v_exp_f32 v37, v37
    v_exp_f32 v38, v38
    v_exp_f32 v39, v39
    v_cvt_pk_bf16_f32 v60, v32, v33
    v_cvt_pk_bf16_f32 v61, v34, v35
    v_mfma_f32_32x32x16_bf16 v[72:87], v[164:167], v[56:59], v[72:87]
    s_add_u32 m0, s56, 143360
    s_add_u32 s55, s58, 184320
    s_nop 0
    buffer_load_dwordx4 v4, s[40:43], s55 offen offset:0 sc1 lds
    v_exp_f32 v40, v40
    v_exp_f32 v41, v41
    v_exp_f32 v42, v42
    v_exp_f32 v43, v43
    v_cvt_pk_bf16_f32 v62, v36, v37
    v_cvt_pk_bf16_f32 v63, v38, v39
    v_mfma_f32_32x32x16_bf16 v[24:39], v[148:151], v[136:139], 0
    s_waitcnt lgkmcnt(0)
    s_add_u32 m0, s56, 143360
    s_nop 0
    buffer_load_dwordx4 v4, s[40:43], s55 offen offset:1024 sc1 lds
    v_exp_f32 v44, v44
    v_exp_f32 v45, v45
    v_exp_f32 v46, v46
    v_exp_f32 v47, v47
    v_cvt_pk_bf16_f32 v64, v40, v41
    v_cvt_pk_bf16_f32 v65, v42, v43
    v_mfma_f32_32x32x8_bf16 v[24:39], v[152:153], v[144:145], v[24:39]
    s_add_u32 m0, s56, 143360
    s_nop 0
    buffer_load_dwordx4 v4, s[40:43], s55 offen offset:2048 sc1 lds
    v_exp_f32 v48, v48
    v_exp_f32 v49, v49
    v_exp_f32 v50, v50
    v_exp_f32 v51, v51
    v_cvt_pk_bf16_f32 v66, v44, v45
    v_cvt_pk_bf16_f32 v67, v46, v47
    v_mfma_f32_32x32x16_bf16 v[72:87], v[168:171], v[60:63], v[72:87]
    s_add_u32 m0, s56, 143360
    s_nop 0
    buffer_load_dwordx4 v4, s[40:43], s55 offen offset:3072 sc1 lds
    v_exp_f32 v52, v52
    v_exp_f32 v53, v53
    v_exp_f32 v54, v54
    v_exp_f32 v55, v55
    v_cvt_pk_bf16_f32 v68, v48, v49
    v_cvt_pk_bf16_f32 v69, v50, v51
    v_mfma_f32_32x32x16_bf16 v[88:103], v[164:167], v[64:67], v[88:103]
    s_waitcnt vmcnt(17)
    s_barrier
    s_add_u32 m0, s56, 147456
    s_add_u32 s55, s55, 4096
    ds_read_b128 v[172:175], v8 offset:19968
    buffer_load_dwordx4 v4, s[40:43], s55 offen offset:0 sc1 lds
    v_exp_f32 v24, v24
    v_exp_f32 v25, v25
    v_exp_f32 v26, v26
    v_exp_f32 v27, v27
    v_cvt_pk_bf16_f32 v70, v52, v53
    v_cvt_pk_bf16_f32 v71, v54, v55
    v_mfma_f32_32x32x16_bf16 v[40:55], v[148:151], v[140:143], 0
    ds_read_b128 v[156:159], v6 offset:18432
    v_exp_f32 v28, v28
    v_exp_f32 v29, v29
    v_exp_f32 v30, v30
    v_exp_f32 v31, v31
    v_cvt_pk_bf16_f32 v56, v24, v25
    v_cvt_pk_bf16_f32 v57, v26, v27
    v_mfma_f32_32x32x8_bf16 v[40:55], v[152:153], v[146:147], v[40:55]
    ds_read_b64 v[160:161], v7 offset:19456
    v_exp_f32 v32, v32
    v_exp_f32 v33, v33
    v_exp_f32 v34, v34
    v_exp_f32 v35, v35
    v_cvt_pk_bf16_f32 v58, v28, v29
    v_cvt_pk_bf16_f32 v59, v30, v31
    v_mfma_f32_32x32x16_bf16 v[88:103], v[168:171], v[68:71], v[88:103]
    s_waitcnt lgkmcnt(1)
    ds_read_b128 v[176:179], v8 offset:20672
    v_exp_f32 v36, v36
    v_exp_f32 v37, v37
    v_exp_f32 v38, v38
    v_exp_f32 v39, v39
    v_cvt_pk_bf16_f32 v60, v32, v33
    v_cvt_pk_bf16_f32 v61, v34, v35
    v_mfma_f32_32x32x16_bf16 v[72:87], v[172:175], v[56:59], v[72:87]
    s_add_u32 m0, s56, 0
    s_add_u32 s55, s58, 102400
    s_nop 0
    buffer_load_dwordx4 v4, s[40:43], s55 offen offset:0 sc1 lds
    v_exp_f32 v40, v40
    v_exp_f32 v41, v41
    v_exp_f32 v42, v42
    v_exp_f32 v43, v43
    v_cvt_pk_bf16_f32 v62, v36, v37
    v_cvt_pk_bf16_f32 v63, v38, v39
    v_mfma_f32_32x32x16_bf16 v[24:39], v[156:159], v[136:139], 0
    s_waitcnt lgkmcnt(0)
    s_add_u32 m0, s56, 0
    s_nop 0
    buffer_load_dwordx4 v4, s[40:43], s55 offen offset:1024 sc1 lds
    v_exp_f32 v44, v44
    v_exp_f32 v45, v45
    v_exp_f32 v46, v46
    v_exp_f32 v47, v47
    v_cvt_pk_bf16_f32 v64, v40, v41
    v_cvt_pk_bf16_f32 v65, v42, v43
    v_mfma_f32_32x32x8_bf16 v[24:39], v[160:161], v[144:145], v[24:39]
    s_add_u32 m0, s56, 0
    s_nop 0
    buffer_load_dwordx4 v4, s[40:43], s55 offen offset:2048 sc1 lds
    v_exp_f32 v48, v48
    v_exp_f32 v49, v49
    v_exp_f32 v50, v50
    v_exp_f32 v51, v51
    v_cvt_pk_bf16_f32 v66, v44, v45
    v_cvt_pk_bf16_f32 v67, v46, v47
    v_mfma_f32_32x32x16_bf16 v[72:87], v[176:179], v[60:63], v[72:87]
    s_add_u32 m0, s56, 0
    s_nop 0
    buffer_load_dwordx4 v4, s[40:43], s55 offen offset:3072 sc1 lds
    v_exp_f32 v52, v52
    v_exp_f32 v53, v53
    v_exp_f32 v54, v54
    v_exp_f32 v55, v55
    v_cvt_pk_bf16_f32 v68, v48, v49
    v_cvt_pk_bf16_f32 v69, v50, v51
    v_mfma_f32_32x32x16_bf16 v[88:103], v[172:175], v[64:67], v[88:103]
    s_add_u32 m0, s56, 4096
    s_add_u32 s55, s55, 4096
    ds_read_b128 v[164:167], v8 offset:23040
    buffer_load_dwordx4 v4, s[40:43], s55 offen offset:0 sc1 lds
    v_exp_f32 v24, v24
    v_exp_f32 v25, v25
    v_exp_f32 v26, v26
    v_exp_f32 v27, v27
    v_cvt_pk_bf16_f32 v70, v52, v53
    v_cvt_pk_bf16_f32 v71, v54, v55
    v_mfma_f32_32x32x16_bf16 v[40:55], v[156:159], v[140:143], 0
    ds_read_b128 v[148:151], v6 offset:21504
    v_exp_f32 v28, v28
    v_exp_f32 v29, v29
    v_exp_f32 v30, v30
    v_exp_f32 v31, v31
    v_cvt_pk_bf16_f32 v56, v24, v25
    v_cvt_pk_bf16_f32 v57, v26, v27
    v_mfma_f32_32x32x8_bf16 v[40:55], v[160:161], v[146:147], v[40:55]
    ds_read_b64 v[152:153], v7 offset:22528
    v_exp_f32 v32, v32
    v_exp_f32 v33, v33
    v_exp_f32 v34, v34
    v_exp_f32 v35, v35
    v_cvt_pk_bf16_f32 v58, v28, v29
    v_cvt_pk_bf16_f32 v59, v30, v31
    v_mfma_f32_32x32x16_bf16 v[88:103], v[176:179], v[68:71], v[88:103]
    s_waitcnt lgkmcnt(1)
    ds_read_b128 v[168:171], v8 offset:23744
    v_exp_f32 v36, v36
    v_exp_f32 v37, v37
    v_exp_f32 v38, v38
    v_exp_f32 v39, v39
    v_cvt_pk_bf16_f32 v60, v32, v33
    v_cvt_pk_bf16_f32 v61, v34, v35
    v_mfma_f32_32x32x16_bf16 v[72:87], v[164:167], v[56:59], v[72:87]
    s_add_u32 m0, s56, 20480
    s_add_u32 s55, s58, 122880
    s_nop 0
    buffer_load_dwordx4 v4, s[40:43], s55 offen offset:0 sc1 lds
    v_exp_f32 v40, v40
    v_exp_f32 v41, v41
    v_exp_f32 v42, v42
    v_exp_f32 v43, v43
    v_cvt_pk_bf16_f32 v62, v36, v37
    v_cvt_pk_bf16_f32 v63, v38, v39
    v_mfma_f32_32x32x16_bf16 v[24:39], v[148:151], v[136:139], 0
    s_waitcnt lgkmcnt(0)
    s_add_u32 m0, s56, 20480
    s_nop 0
    buffer_load_dwordx4 v4, s[40:43], s55 offen offset:1024 sc1 lds
    v_exp_f32 v44, v44
    v_exp_f32 v45, v45
    v_exp_f32 v46, v46
    v_exp_f32 v47, v47
    v_cvt_pk_bf16_f32 v64, v40, v41
    v_cvt_pk_bf16_f32 v65, v42, v43
    v_mfma_f32_32x32x8_bf16 v[24:39], v[152:153], v[144:145], v[24:39]
    s_add_u32 m0, s56, 20480
    s_nop 0
    buffer_load_dwordx4 v4, s[40:43], s55 offen offset:2048 sc1 lds
    v_exp_f32 v48, v48
    v_exp_f32 v49, v49
    v_exp_f32 v50, v50
    v_exp_f32 v51, v51
    v_cvt_pk_bf16_f32 v66, v44, v45
    v_cvt_pk_bf16_f32 v67, v46, v47
    v_mfma_f32_32x32x16_bf16 v[72:87], v[168:171], v[60:63], v[72:87]
    s_add_u32 m0, s56, 20480
    v_xor_b32 v6, 0x8000, v6
    v_xor_b32 v7, 0x8000, v7
    v_xor_b32 v8, 0x8000, v8
    s_xor_b32 s14, s14, 0x8000
    s_xor_b32 s15, s15, 0x8000
    buffer_load_dwordx4 v4, s[40:43], s55 offen offset:3072 sc1 lds
    v_exp_f32 v52, v52
    v_exp_f32 v53, v53
    v_exp_f32 v54, v54
    v_exp_f32 v55, v55
    v_cvt_pk_bf16_f32 v68, v48, v49
    v_cvt_pk_bf16_f32 v69, v50, v51
    v_mfma_f32_32x32x16_bf16 v[88:103], v[164:167], v[64:67], v[88:103]
    s_barrier
    s_add_u32 m0, s56, 24576
    s_add_u32 s55, s55, 4096
    ds_read_b128 v[172:175], v8 offset:1536
    buffer_load_dwordx4 v4, s[40:43], s55 offen offset:0 sc1 lds
    v_exp_f32 v24, v24
    v_exp_f32 v25, v25
    v_exp_f32 v26, v26
    v_exp_f32 v27, v27
    v_cvt_pk_bf16_f32 v70, v52, v53
    v_cvt_pk_bf16_f32 v71, v54, v55
    v_mfma_f32_32x32x16_bf16 v[40:55], v[148:151], v[140:143], 0
    ds_read_b128 v[156:159], v6 offset:0
    v_exp_f32 v28, v28
    v_exp_f32 v29, v29
    v_exp_f32 v30, v30
    v_exp_f32 v31, v31
    v_cvt_pk_bf16_f32 v56, v24, v25
    v_cvt_pk_bf16_f32 v57, v26, v27
    v_mfma_f32_32x32x8_bf16 v[40:55], v[152:153], v[146:147], v[40:55]
    ds_read_b64 v[160:161], v7 offset:1024
    v_exp_f32 v32, v32
    v_exp_f32 v33, v33
    v_exp_f32 v34, v34
    v_exp_f32 v35, v35
    v_cvt_pk_bf16_f32 v58, v28, v29
    v_cvt_pk_bf16_f32 v59, v30, v31
    v_mfma_f32_32x32x16_bf16 v[88:103], v[168:171], v[68:71], v[88:103]
    s_waitcnt lgkmcnt(1)
    ds_read_b128 v[176:179], v8 offset:2240
    v_exp_f32 v36, v36
    v_exp_f32 v37, v37
    v_exp_f32 v38, v38
    v_exp_f32 v39, v39
    v_cvt_pk_bf16_f32 v60, v32, v33
    v_cvt_pk_bf16_f32 v61, v34, v35
    v_mfma_f32_32x32x16_bf16 v[72:87], v[172:175], v[56:59], v[72:87]
    s_add_u32 m0, s56, 40960
    s_add_u32 s55, s58, 143360
    s_nop 0
    buffer_load_dwordx4 v4, s[40:43], s55 offen offset:0 sc1 lds
    v_exp_f32 v40, v40
    v_exp_f32 v41, v41
    v_exp_f32 v42, v42
    v_exp_f32 v43, v43
    v_cvt_pk_bf16_f32 v62, v36, v37
    v_cvt_pk_bf16_f32 v63, v38, v39
    v_mfma_f32_32x32x16_bf16 v[24:39], v[156:159], v[136:139], 0
    s_waitcnt lgkmcnt(0)
    s_add_u32 m0, s56, 40960
    s_nop 0
    buffer_load_dwordx4 v4, s[40:43], s55 offen offset:1024 sc1 lds
    v_exp_f32 v44, v44
    v_exp_f32 v45, v45
    v_exp_f32 v46, v46
    v_exp_f32 v47, v47
    v_cvt_pk_bf16_f32 v64, v40, v41
    v_cvt_pk_bf16_f32 v65, v42, v43
    v_mfma_f32_32x32x8_bf16 v[24:39], v[160:161], v[144:145], v[24:39]
    s_add_u32 m0, s56, 40960
    s_nop 0
    buffer_load_dwordx4 v4, s[40:43], s55 offen offset:2048 sc1 lds
    v_exp_f32 v48, v48
    v_exp_f32 v49, v49
    v_exp_f32 v50, v50
    v_exp_f32 v51, v51
    v_cvt_pk_bf16_f32 v66, v44, v45
    v_cvt_pk_bf16_f32 v67, v46, v47
    v_mfma_f32_32x32x16_bf16 v[72:87], v[176:179], v[60:63], v[72:87]
    s_add_u32 m0, s56, 40960
    s_nop 0
    buffer_load_dwordx4 v4, s[40:43], s55 offen offset:3072 sc1 lds
    v_exp_f32 v52, v52
    v_exp_f32 v53, v53
    v_exp_f32 v54, v54
    v_exp_f32 v55, v55
    v_cvt_pk_bf16_f32 v68, v48, v49
    v_cvt_pk_bf16_f32 v69, v50, v51
    v_mfma_f32_32x32x16_bf16 v[88:103], v[172:175], v[64:67], v[88:103]
    s_add_u32 m0, s56, 45056
    s_add_u32 s55, s55, 4096
    ds_read_b128 v[164:167], v8 offset:4608
    buffer_load_dwordx4 v4, s[40:43], s55 offen offset:0 sc1 lds
    v_exp_f32 v24, v24
    v_exp_f32 v25, v25
    v_exp_f32 v26, v26
    v_exp_f32 v27, v27
    v_cvt_pk_bf16_f32 v70, v52, v53
    v_cvt_pk_bf16_f32 v71, v54, v55
    v_mfma_f32_32x32x16_bf16 v[40:55], v[156:159], v[140:143], 0
    ds_read_b128 v[148:151], v6 offset:3072
    v_exp_f32 v28, v28
    v_exp_f32 v29, v29
    v_exp_f32 v30, v30
    v_exp_f32 v31, v31
    v_cvt_pk_bf16_f32 v56, v24, v25
    v_cvt_pk_bf16_f32 v57, v26, v27
    v_mfma_f32_32x32x8_bf16 v[40:55], v[160:161], v[146:147], v[40:55]
    ds_read_b64 v[152:153], v7 offset:4096
    v_exp_f32 v32, v32
    v_exp_f32 v33, v33
    v_exp_f32 v34, v34
    v_exp_f32 v35, v35
    v_cvt_pk_bf16_f32 v58, v28, v29
    v_cvt_pk_bf16_f32 v59, v30, v31
    v_mfma_f32_32x32x16_bf16 v[88:103], v[176:179], v[68:71], v[88:103]
    s_waitcnt lgkmcnt(1)
    ds_read_b128 v[168:171], v8 offset:5312
    v_exp_f32 v36, v36
    v_exp_f32 v37, v37
    v_exp_f32 v38, v38
    v_exp_f32 v39, v39
    v_cvt_pk_bf16_f32 v60, v32, v33
    v_cvt_pk_bf16_f32 v61, v34, v35
    v_mfma_f32_32x32x16_bf16 v[72:87], v[164:167], v[56:59], v[72:87]
    s_add_u32 m0, s56, 61440
    s_add_u32 s55, s58, 204800
    s_nop 0
    buffer_load_dwordx4 v4, s[40:43], s55 offen offset:0 sc1 lds
    v_exp_f32 v40, v40
    v_exp_f32 v41, v41
    v_exp_f32 v42, v42
    v_exp_f32 v43, v43
    v_cvt_pk_bf16_f32 v62, v36, v37
    v_cvt_pk_bf16_f32 v63, v38, v39
    v_mfma_f32_32x32x16_bf16 v[24:39], v[148:151], v[136:139], 0
    s_waitcnt lgkmcnt(0)
    s_add_u32 m0, s56, 61440
    s_nop 0
    buffer_load_dwordx4 v4, s[40:43], s55 offen offset:1024 sc1 lds
    v_exp_f32 v44, v44
    v_exp_f32 v45, v45
    v_exp_f32 v46, v46
    v_exp_f32 v47, v47
    v_cvt_pk_bf16_f32 v64, v40, v41
    v_cvt_pk_bf16_f32 v65, v42, v43
    v_mfma_f32_32x32x8_bf16 v[24:39], v[152:153], v[144:145], v[24:39]
    s_add_u32 m0, s56, 61440
    s_nop 0
    buffer_load_dwordx4 v4, s[40:43], s55 offen offset:2048 sc1 lds
    v_exp_f32 v48, v48
    v_exp_f32 v49, v49
    v_exp_f32 v50, v50
    v_exp_f32 v51, v51
    v_cvt_pk_bf16_f32 v66, v44, v45
    v_cvt_pk_bf16_f32 v67, v46, v47
    v_mfma_f32_32x32x16_bf16 v[72:87], v[168:171], v[60:63], v[72:87]
    s_add_u32 m0, s56, 61440
    s_nop 0
    buffer_load_dwordx4 v4, s[40:43], s55 offen offset:3072 sc1 lds
    v_exp_f32 v52, v52
    v_exp_f32 v53, v53
    v_exp_f32 v54, v54
    v_exp_f32 v55, v55
    v_cvt_pk_bf16_f32 v68, v48, v49
    v_cvt_pk_bf16_f32 v69, v50, v51
    v_mfma_f32_32x32x16_bf16 v[88:103], v[164:167], v[64:67], v[88:103]
    s_add_u32 m0, s56, 65536
    s_add_u32 s55, s55, 4096
    ds_read_b128 v[172:175], v8 offset:7680
    buffer_load_dwordx4 v4, s[40:43], s55 offen offset:0 sc1 lds
    v_exp_f32 v24, v24
    v_exp_f32 v25, v25
    v_exp_f32 v26, v26
    v_exp_f32 v27, v27
    v_cvt_pk_bf16_f32 v70, v52, v53
    v_cvt_pk_bf16_f32 v71, v54, v55
    v_mfma_f32_32x32x16_bf16 v[40:55], v[148:151], v[140:143], 0
    ds_read_b128 v[156:159], v6 offset:6144
    v_exp_f32 v28, v28
    v_exp_f32 v29, v29
    v_exp_f32 v30, v30
    v_exp_f32 v31, v31
    v_cvt_pk_bf16_f32 v56, v24, v25
    v_cvt_pk_bf16_f32 v57, v26, v27
    v_mfma_f32_32x32x8_bf16 v[40:55], v[152:153], v[146:147], v[40:55]
    ds_read_b64 v[160:161], v7 offset:7168
    v_exp_f32 v32, v32
    v_exp_f32 v33, v33
    v_exp_f32 v34, v34
    v_exp_f32 v35, v35
    v_cvt_pk_bf16_f32 v58, v28, v29
    v_cvt_pk_bf16_f32 v59, v30, v31
    v_mfma_f32_32x32x16_bf16 v[88:103], v[168:171], v[68:71], v[88:103]
    s_waitcnt lgkmcnt(1)
    ds_read_b128 v[176:179], v8 offset:8384
    v_exp_f32 v36, v36
    v_exp_f32 v37, v37
    v_exp_f32 v38, v38
    v_exp_f32 v39, v39
    v_cvt_pk_bf16_f32 v60, v32, v33
    v_cvt_pk_bf16_f32 v61, v34, v35
    v_mfma_f32_32x32x16_bf16 v[72:87], v[172:175], v[56:59], v[72:87]
    s_add_u32 s67, s54, 40960
    buffer_load_dwordx4 a[0:3], v240, s[40:43], s67 offen offset:0 sc1
    v_exp_f32 v40, v40
    v_exp_f32 v41, v41
    v_exp_f32 v42, v42
    v_exp_f32 v43, v43
    v_cvt_pk_bf16_f32 v62, v36, v37
    v_cvt_pk_bf16_f32 v63, v38, v39
    v_mfma_f32_32x32x16_bf16 v[24:39], v[156:159], v[136:139], 0
    s_waitcnt lgkmcnt(0)
    buffer_load_dwordx4 a[4:7], v240, s[40:43], s67 offen offset:2048 sc1
    v_exp_f32 v44, v44
    v_exp_f32 v45, v45
    v_exp_f32 v46, v46
    v_exp_f32 v47, v47
    v_cvt_pk_bf16_f32 v64, v40, v41
    v_cvt_pk_bf16_f32 v65, v42, v43
    v_mfma_f32_32x32x8_bf16 v[24:39], v[160:161], v[144:145], v[24:39]
    s_add_u32 s67, s54, 45056
    buffer_load_dwordx4 a[8:11], v240, s[40:43], s67 offen offset:0 sc1
    v_exp_f32 v48, v48
    v_exp_f32 v49, v49
    v_exp_f32 v50, v50
    v_exp_f32 v51, v51
    v_cvt_pk_bf16_f32 v66, v44, v45
    v_cvt_pk_bf16_f32 v67, v46, v47
    v_mfma_f32_32x32x16_bf16 v[72:87], v[176:179], v[60:63], v[72:87]
    buffer_load_dwordx4 a[12:15], v240, s[40:43], s67 offen offset:2048 sc1
    v_exp_f32 v52, v52
    v_exp_f32 v53, v53
    v_exp_f32 v54, v54
    v_exp_f32 v55, v55
    v_cvt_pk_bf16_f32 v68, v48, v49
    v_cvt_pk_bf16_f32 v69, v50, v51
    v_mfma_f32_32x32x16_bf16 v[88:103], v[172:175], v[64:67], v[88:103]
    s_add_u32 s67, s54, 49152
    ds_read_b128 v[164:167], v8 offset:10752
    buffer_load_dwordx4 a[16:19], v240, s[40:43], s67 offen offset:0 sc1
    v_exp_f32 v24, v24
    v_exp_f32 v25, v25
    v_exp_f32 v26, v26
    v_exp_f32 v27, v27
    v_cvt_pk_bf16_f32 v70, v52, v53
    v_cvt_pk_bf16_f32 v71, v54, v55
    v_mfma_f32_32x32x16_bf16 v[40:55], v[156:159], v[140:143], 0
    ds_read_b128 v[148:151], v6 offset:9216
    buffer_load_dwordx4 a[20:23], v240, s[40:43], s67 offen offset:2048 sc1
    v_exp_f32 v28, v28
    v_exp_f32 v29, v29
    v_exp_f32 v30, v30
    v_exp_f32 v31, v31
    v_cvt_pk_bf16_f32 v56, v24, v25
    v_cvt_pk_bf16_f32 v57, v26, v27
    v_mfma_f32_32x32x8_bf16 v[40:55], v[160:161], v[146:147], v[40:55]
    ds_read_b64 v[152:153], v7 offset:10240
    v_exp_f32 v32, v32
    v_exp_f32 v33, v33
    v_exp_f32 v34, v34
    v_exp_f32 v35, v35
    v_cvt_pk_bf16_f32 v58, v28, v29
    v_cvt_pk_bf16_f32 v59, v30, v31
    v_mfma_f32_32x32x16_bf16 v[88:103], v[176:179], v[68:71], v[88:103]
    s_waitcnt lgkmcnt(1)
    ds_read_b128 v[168:171], v8 offset:11456
    v_exp_f32 v36, v36
    v_exp_f32 v37, v37
    v_exp_f32 v38, v38
    v_exp_f32 v39, v39
    v_cvt_pk_bf16_f32 v60, v32, v33
    v_cvt_pk_bf16_f32 v61, v34, v35
    v_mfma_f32_32x32x16_bf16 v[72:87], v[164:167], v[56:59], v[72:87]
    s_add_u32 s67, s54, 53248
    buffer_load_dwordx4 a[24:27], v240, s[40:43], s67 offen offset:0 sc1
    v_exp_f32 v40, v40
    v_exp_f32 v41, v41
    v_exp_f32 v42, v42
    v_exp_f32 v43, v43
    v_cvt_pk_bf16_f32 v62, v36, v37
    v_cvt_pk_bf16_f32 v63, v38, v39
    v_mfma_f32_32x32x16_bf16 v[24:39], v[148:151], v[136:139], 0
    s_waitcnt lgkmcnt(0)
    buffer_load_dwordx4 a[28:31], v240, s[40:43], s67 offen offset:2048 sc1
    v_exp_f32 v44, v44
    v_exp_f32 v45, v45
    v_exp_f32 v46, v46
    v_exp_f32 v47, v47
    v_cvt_pk_bf16_f32 v64, v40, v41
    v_cvt_pk_bf16_f32 v65, v42, v43
    v_mfma_f32_32x32x8_bf16 v[24:39], v[152:153], v[144:145], v[24:39]
    s_add_u32 s67, s54, 57344
    buffer_load_dwordx4 a[32:35], v240, s[40:43], s67 offen offset:0 sc1
    v_exp_f32 v48, v48
    v_exp_f32 v49, v49
    v_exp_f32 v50, v50
    v_exp_f32 v51, v51
    v_cvt_pk_bf16_f32 v66, v44, v45
    v_cvt_pk_bf16_f32 v67, v46, v47
    v_mfma_f32_32x32x16_bf16 v[72:87], v[168:171], v[60:63], v[72:87]
    buffer_load_dwordx4 a[36:39], v240, s[40:43], s67 offen offset:2048 sc1
    v_exp_f32 v52, v52
    v_exp_f32 v53, v53
    v_exp_f32 v54, v54
    v_exp_f32 v55, v55
    v_cvt_pk_bf16_f32 v68, v48, v49
    v_cvt_pk_bf16_f32 v69, v50, v51
    v_mfma_f32_32x32x16_bf16 v[88:103], v[164:167], v[64:67], v[88:103]
    s_waitcnt vmcnt(25)
    s_barrier
    s_add_u32 s67, s54, 61440
    ds_read_b128 v[172:175], v8 offset:13824
    buffer_load_dwordx4 a[40:43], v240, s[40:43], s67 offen offset:0 sc1
    v_exp_f32 v24, v24
    v_exp_f32 v25, v25
    v_exp_f32 v26, v26
    v_exp_f32 v27, v27
    v_cvt_pk_bf16_f32 v70, v52, v53
    v_cvt_pk_bf16_f32 v71, v54, v55
    v_mfma_f32_32x32x16_bf16 v[40:55], v[148:151], v[140:143], 0
    ds_read_b128 v[156:159], v6 offset:12288
    buffer_load_dwordx4 a[44:47], v240, s[40:43], s67 offen offset:2048 sc1
    v_exp_f32 v28, v28
    v_exp_f32 v29, v29
    v_exp_f32 v30, v30
    v_exp_f32 v31, v31
    v_cvt_pk_bf16_f32 v56, v24, v25
    v_cvt_pk_bf16_f32 v57, v26, v27
    v_mfma_f32_32x32x8_bf16 v[40:55], v[152:153], v[146:147], v[40:55]
    ds_read_b64 v[160:161], v7 offset:13312
    v_exp_f32 v32, v32
    v_exp_f32 v33, v33
    v_exp_f32 v34, v34
    v_exp_f32 v35, v35
    v_cvt_pk_bf16_f32 v58, v28, v29
    v_cvt_pk_bf16_f32 v59, v30, v31
    v_mfma_f32_32x32x16_bf16 v[88:103], v[168:171], v[68:71], v[88:103]
    s_waitcnt lgkmcnt(1)
    ds_read_b128 v[176:179], v8 offset:14528
    v_exp_f32 v36, v36
    v_exp_f32 v37, v37
    v_exp_f32 v38, v38
    v_exp_f32 v39, v39
    v_cvt_pk_bf16_f32 v60, v32, v33
    v_cvt_pk_bf16_f32 v61, v34, v35
    v_mfma_f32_32x32x16_bf16 v[72:87], v[172:175], v[56:59], v[72:87]
    s_add_u32 s67, s54, 65536
    buffer_load_dwordx4 a[48:51], v240, s[40:43], s67 offen offset:0 sc1
    v_exp_f32 v40, v40
    v_exp_f32 v41, v41
    v_exp_f32 v42, v42
    v_exp_f32 v43, v43
    v_cvt_pk_bf16_f32 v62, v36, v37
    v_cvt_pk_bf16_f32 v63, v38, v39
    v_mfma_f32_32x32x16_bf16 v[24:39], v[156:159], v[136:139], 0
    s_waitcnt lgkmcnt(0)
    buffer_load_dwordx4 a[52:55], v240, s[40:43], s67 offen offset:2048 sc1
    v_exp_f32 v44, v44
    v_exp_f32 v45, v45
    v_exp_f32 v46, v46
    v_exp_f32 v47, v47
    v_cvt_pk_bf16_f32 v64, v40, v41
    v_cvt_pk_bf16_f32 v65, v42, v43
    v_mfma_f32_32x32x8_bf16 v[24:39], v[160:161], v[144:145], v[24:39]
    s_add_u32 s67, s54, 69632
    buffer_load_dwordx4 a[56:59], v240, s[40:43], s67 offen offset:0 sc1
    v_exp_f32 v48, v48
    v_exp_f32 v49, v49
    v_exp_f32 v50, v50
    v_exp_f32 v51, v51
    v_cvt_pk_bf16_f32 v66, v44, v45
    v_cvt_pk_bf16_f32 v67, v46, v47
    v_mfma_f32_32x32x16_bf16 v[72:87], v[176:179], v[60:63], v[72:87]
    buffer_load_dwordx4 a[60:63], v240, s[40:43], s67 offen offset:2048 sc1
    v_exp_f32 v52, v52
    v_exp_f32 v53, v53
    v_exp_f32 v54, v54
    v_exp_f32 v55, v55
    v_cvt_pk_bf16_f32 v68, v48, v49
    v_cvt_pk_bf16_f32 v69, v50, v51
    v_mfma_f32_32x32x16_bf16 v[88:103], v[172:175], v[64:67], v[88:103]
    s_add_u32 s67, s54, 73728
    ds_read_b128 v[164:167], v8 offset:16896
    buffer_load_dwordx4 a[64:67], v240, s[40:43], s67 offen offset:0 sc1
    v_exp_f32 v24, v24
    v_exp_f32 v25, v25
    v_exp_f32 v26, v26
    v_exp_f32 v27, v27
    v_cvt_pk_bf16_f32 v70, v52, v53
    v_cvt_pk_bf16_f32 v71, v54, v55
    v_mfma_f32_32x32x16_bf16 v[40:55], v[156:159], v[140:143], 0
    ds_read_b128 v[148:151], v6 offset:15360
    buffer_load_dwordx4 a[68:71], v240, s[40:43], s67 offen offset:2048 sc1
    v_exp_f32 v28, v28
    v_exp_f32 v29, v29
    v_exp_f32 v30, v30
    v_exp_f32 v31, v31
    v_cvt_pk_bf16_f32 v56, v24, v25
    v_cvt_pk_bf16_f32 v57, v26, v27
    v_mfma_f32_32x32x8_bf16 v[40:55], v[160:161], v[146:147], v[40:55]
    s_add_u32 m0, s56, 81920
    s_add_u32 s55, s58, 225280
    s_cmp_eq_u32 s3, 3
    s_cselect_b32 s55, s22, s55
    ds_read_b64 v[152:153], v7 offset:16384
    buffer_load_dwordx4 v4, s[40:43], s55 offen offset:0 sc1 lds
    v_exp_f32 v32, v32
    v_exp_f32 v33, v33
    v_exp_f32 v34, v34
    v_exp_f32 v35, v35
    v_cvt_pk_bf16_f32 v58, v28, v29
    v_cvt_pk_bf16_f32 v59, v30, v31
    v_mfma_f32_32x32x16_bf16 v[88:103], v[176:179], v[68:71], v[88:103]
    s_waitcnt lgkmcnt(1)
    ds_read_b128 v[168:171], v8 offset:17600
    v_exp_f32 v36, v36
    v_exp_f32 v37, v37
    v_exp_f32 v38, v38
    v_exp_f32 v39, v39
    v_cvt_pk_bf16_f32 v60, v32, v33
    v_cvt_pk_bf16_f32 v61, v34, v35
    v_mfma_f32_32x32x16_bf16 v[72:87], v[164:167], v[56:59], v[72:87]
    s_add_u32 s67, s54, 77824
    buffer_load_dwordx4 a[72:75], v240, s[40:43], s67 offen offset:0 sc1
    v_exp_f32 v40, v40
    v_exp_f32 v41, v41
    v_exp_f32 v42, v42
    v_exp_f32 v43, v43
    v_cvt_pk_bf16_f32 v62, v36, v37
    v_cvt_pk_bf16_f32 v63, v38, v39
    v_mfma_f32_32x32x16_bf16 v[24:39], v[148:151], v[136:139], 0
    s_waitcnt lgkmcnt(0)
    buffer_load_dwordx4 a[76:79], v240, s[40:43], s67 offen offset:2048 sc1
    v_exp_f32 v44, v44
    v_exp_f32 v45, v45
    v_exp_f32 v46, v46
    v_exp_f32 v47, v47
    v_cvt_pk_bf16_f32 v64, v40, v41
    v_cvt_pk_bf16_f32 v65, v42, v43
    v_mfma_f32_32x32x8_bf16 v[24:39], v[152:153], v[144:145], v[24:39]
    s_add_u32 s67, s54, 81920
    buffer_load_dwordx4 a[80:83], v240, s[40:43], s67 offen offset:0 sc1
    v_exp_f32 v48, v48
    v_exp_f32 v49, v49
    v_exp_f32 v50, v50
    v_exp_f32 v51, v51
    v_cvt_pk_bf16_f32 v66, v44, v45
    v_cvt_pk_bf16_f32 v67, v46, v47
    v_mfma_f32_32x32x16_bf16 v[72:87], v[168:171], v[60:63], v[72:87]
    buffer_load_dwordx4 a[84:87], v240, s[40:43], s67 offen offset:2048 sc1
    v_exp_f32 v52, v52
    v_exp_f32 v53, v53
    v_exp_f32 v54, v54
    v_exp_f32 v55, v55
    v_cvt_pk_bf16_f32 v68, v48, v49
    v_cvt_pk_bf16_f32 v69, v50, v51
    v_mfma_f32_32x32x16_bf16 v[88:103], v[164:167], v[64:67], v[88:103]
    s_add_u32 s67, s54, 86016
    ds_read_b128 v[172:175], v8 offset:19968
    buffer_load_dwordx4 a[88:91], v240, s[40:43], s67 offen offset:0 sc1
    v_exp_f32 v24, v24
    v_exp_f32 v25, v25
    v_exp_f32 v26, v26
    v_exp_f32 v27, v27
    v_cvt_pk_bf16_f32 v70, v52, v53
    v_cvt_pk_bf16_f32 v71, v54, v55
    v_mfma_f32_32x32x16_bf16 v[40:55], v[148:151], v[140:143], 0
    ds_read_b128 v[156:159], v6 offset:18432
    buffer_load_dwordx4 a[92:95], v240, s[40:43], s67 offen offset:2048 sc1
    v_exp_f32 v28, v28
    v_exp_f32 v29, v29
    v_exp_f32 v30, v30
    v_exp_f32 v31, v31
    v_cvt_pk_bf16_f32 v56, v24, v25
    v_cvt_pk_bf16_f32 v57, v26, v27
    v_mfma_f32_32x32x8_bf16 v[40:55], v[152:153], v[146:147], v[40:55]
    s_add_u32 m0, s56, 81920
    ds_read_b64 v[160:161], v7 offset:19456
    buffer_load_dwordx4 v4, s[40:43], s55 offen offset:1024 sc1 lds
    v_exp_f32 v32, v32
    v_exp_f32 v33, v33
    v_exp_f32 v34, v34
    v_exp_f32 v35, v35
    v_cvt_pk_bf16_f32 v58, v28, v29
    v_cvt_pk_bf16_f32 v59, v30, v31
    v_mfma_f32_32x32x16_bf16 v[88:103], v[168:171], v[68:71], v[88:103]
    s_waitcnt lgkmcnt(1)
    ds_read_b128 v[176:179], v8 offset:20672
    v_exp_f32 v36, v36
    v_exp_f32 v37, v37
    v_exp_f32 v38, v38
    v_exp_f32 v39, v39
    v_cvt_pk_bf16_f32 v60, v32, v33
    v_cvt_pk_bf16_f32 v61, v34, v35
    v_mfma_f32_32x32x16_bf16 v[72:87], v[172:175], v[56:59], v[72:87]
    s_add_u32 s67, s54, 90112
    buffer_load_dwordx4 a[96:99], v240, s[40:43], s67 offen offset:0 sc1
    v_exp_f32 v40, v40
    v_exp_f32 v41, v41
    v_exp_f32 v42, v42
    v_exp_f32 v43, v43
    v_cvt_pk_bf16_f32 v62, v36, v37
    v_cvt_pk_bf16_f32 v63, v38, v39
    v_mfma_f32_32x32x16_bf16 v[24:39], v[156:159], v[136:139], 0
    s_waitcnt lgkmcnt(0)
    buffer_load_dwordx4 a[100:103], v240, s[40:43], s67 offen offset:2048 sc1
    v_exp_f32 v44, v44
    v_exp_f32 v45, v45
    v_exp_f32 v46, v46
    v_exp_f32 v47, v47
    v_cvt_pk_bf16_f32 v64, v40, v41
    v_cvt_pk_bf16_f32 v65, v42, v43
    v_mfma_f32_32x32x8_bf16 v[24:39], v[160:161], v[144:145], v[24:39]
    s_add_u32 s67, s54, 94208
    buffer_load_dwordx4 a[104:107], v240, s[40:43], s67 offen offset:0 sc1
    v_exp_f32 v48, v48
    v_exp_f32 v49, v49
    v_exp_f32 v50, v50
    v_exp_f32 v51, v51
    v_cvt_pk_bf16_f32 v66, v44, v45
    v_cvt_pk_bf16_f32 v67, v46, v47
    v_mfma_f32_32x32x16_bf16 v[72:87], v[176:179], v[60:63], v[72:87]
    s_add_u32 m0, s56, 81920
    s_nop 0
    buffer_load_dwordx4 v4, s[40:43], s55 offen offset:2048 sc1 lds
    v_exp_f32 v52, v52
    v_exp_f32 v53, v53
    v_exp_f32 v54, v54
    v_exp_f32 v55, v55
    v_cvt_pk_bf16_f32 v68, v48, v49
    v_cvt_pk_bf16_f32 v69, v50, v51
    v_mfma_f32_32x32x16_bf16 v[88:103], v[172:175], v[64:67], v[88:103]
    s_add_u32 m0, s56, 81920
    ds_read_b128 v[164:167], v8 offset:23040
    buffer_load_dwordx4 v4, s[40:43], s55 offen offset:3072 sc1 lds
    v_exp_f32 v24, v24
    v_exp_f32 v25, v25
    v_exp_f32 v26, v26
    v_exp_f32 v27, v27
    v_cvt_pk_bf16_f32 v70, v52, v53
    v_cvt_pk_bf16_f32 v71, v54, v55
    v_mfma_f32_32x32x16_bf16 v[40:55], v[156:159], v[140:143], 0
    s_add_u32 m0, s56, 86016
    s_add_u32 s55, s55, 4096
    ds_read_b128 v[148:151], v6 offset:21504
    buffer_load_dwordx4 v4, s[40:43], s55 offen offset:0 sc1 lds
    v_exp_f32 v28, v28
    v_exp_f32 v29, v29
    v_exp_f32 v30, v30
    v_exp_f32 v31, v31
    v_cvt_pk_bf16_f32 v56, v24, v25
    v_cvt_pk_bf16_f32 v57, v26, v27
    v_mfma_f32_32x32x8_bf16 v[40:55], v[160:161], v[146:147], v[40:55]
    ds_read_b64 v[152:153], v7 offset:22528
    v_exp_f32 v32, v32
    v_exp_f32 v33, v33
    v_exp_f32 v34, v34
    v_exp_f32 v35, v35
    v_cvt_pk_bf16_f32 v58, v28, v29
    v_cvt_pk_bf16_f32 v59, v30, v31
    v_mfma_f32_32x32x16_bf16 v[88:103], v[176:179], v[68:71], v[88:103]
    s_waitcnt lgkmcnt(1)
    ds_read_b128 v[168:171], v8 offset:23744
    v_exp_f32 v36, v36
    v_exp_f32 v37, v37
    v_exp_f32 v38, v38
    v_exp_f32 v39, v39
    v_cvt_pk_bf16_f32 v60, v32, v33
    v_cvt_pk_bf16_f32 v61, v34, v35
    v_mfma_f32_32x32x16_bf16 v[72:87], v[164:167], v[56:59], v[72:87]
    v_exp_f32 v40, v40
    v_exp_f32 v41, v41
    v_exp_f32 v42, v42
    v_exp_f32 v43, v43
    v_cvt_pk_bf16_f32 v62, v36, v37
    v_cvt_pk_bf16_f32 v63, v38, v39
    s_waitcnt lgkmcnt(0)
    v_exp_f32 v44, v44
    v_exp_f32 v45, v45
    v_exp_f32 v46, v46
    v_exp_f32 v47, v47
    v_cvt_pk_bf16_f32 v64, v40, v41
    v_cvt_pk_bf16_f32 v65, v42, v43
    v_exp_f32 v48, v48
    v_exp_f32 v49, v49
    v_exp_f32 v50, v50
    v_exp_f32 v51, v51
    v_cvt_pk_bf16_f32 v66, v44, v45
    v_cvt_pk_bf16_f32 v67, v46, v47
    v_mfma_f32_32x32x16_bf16 v[72:87], v[168:171], v[60:63], v[72:87]
    v_exp_f32 v52, v52
    v_exp_f32 v53, v53
    v_exp_f32 v54, v54
    v_exp_f32 v55, v55
    v_cvt_pk_bf16_f32 v68, v48, v49
    v_cvt_pk_bf16_f32 v69, v50, v51
    v_mfma_f32_32x32x16_bf16 v[88:103], v[164:167], v[64:67], v[88:103]
    v_cvt_pk_bf16_f32 v70, v52, v53
    v_cvt_pk_bf16_f32 v71, v54, v55
    s_nop 1
    v_mfma_f32_32x32x16_bf16 v[88:103], v[168:171], v[68:71], v[88:103]
    v_mov_b32 v16, v80
    v_mov_b32 v84, v80
    s_nop 1
    v_permlane32_swap_b32 v16, v84
    s_nop 6
    v_mov_b32 v16, v96
    v_mov_b32 v100, v96
    s_nop 1
    v_permlane32_swap_b32 v16, v100
    v_min_f32 v16, v84, v100
    v_mov_b32 v17, 0x26800000
    v_cmp_nge_f32 vcc, v16, v17
    v_add_f32 v18, v84, v100
    v_max3_f32 v18, abs(v72), abs(v73), v18
    v_max3_f32 v18, abs(v88), abs(v89), v18
    v_max3_f32 v18, abs(v74), abs(v75), v18
    v_max3_f32 v18, abs(v90), abs(v91), v18
    v_max3_f32 v18, abs(v76), abs(v77), v18
    v_max3_f32 v18, abs(v92), abs(v93), v18
    v_max3_f32 v18, abs(v78), abs(v79), v18
    v_max3_f32 v18, abs(v94), abs(v95), v18
    v_max3_f32 v18, abs(v80), abs(v81), v18
    v_max3_f32 v18, abs(v96), abs(v97), v18
    v_max3_f32 v18, abs(v82), abs(v83), v18
    v_max3_f32 v18, abs(v98), abs(v99), v18
    v_cmp_u_f32 s[6:7], v84, v100
    s_nop 0
    s_or_b64 vcc, vcc, s[6:7]
    v_mov_b32 v17, 0x7e800000
    v_cmp_nle_f32 s[6:7], v18, v17
    s_nop 0
    s_or_b64 vcc, vcc, s[6:7]
    s_cbranch_vccnz M_fallback
M_epi:
    v_rcp_f32 v16, v84
    v_rcp_f32 v18, v100
    v_mul_f32 v16, v16, v228
    v_mul_f32 v18, v18, v228
    v_mov_b32 v17, v16
    v_mov_b32 v19, v18
    v_pk_mul_f32 v[72:73], v[72:73], v[16:17]
    v_pk_mul_f32 v[74:75], v[74:75], v[16:17]
    v_pk_mul_f32 v[76:77], v[76:77], v[16:17]
    v_pk_mul_f32 v[78:79], v[78:79], v[16:17]
    v_pk_mul_f32 v[80:81], v[80:81], v[16:17]
    v_pk_mul_f32 v[82:83], v[82:83], v[16:17]
    v_pk_mul_f32 v[88:89], v[88:89], v[18:19]
    v_pk_mul_f32 v[90:91], v[90:91], v[18:19]
    v_pk_mul_f32 v[92:93], v[92:93], v[18:19]
    v_pk_mul_f32 v[94:95], v[94:95], v[18:19]
    v_pk_mul_f32 v[96:97], v[96:97], v[18:19]
    v_pk_mul_f32 v[98:99], v[98:99], v[18:19]
    v_cvt_pk_bf16_f32 v40, v72, v73
    v_cvt_pk_bf16_f32 v41, v74, v75
    v_cvt_pk_bf16_f32 v42, v76, v77
    v_cvt_pk_bf16_f32 v43, v78, v79
    v_cvt_pk_bf16_f32 v44, v88, v89
    v_cvt_pk_bf16_f32 v45, v90, v91
    v_cvt_pk_bf16_f32 v46, v92, v93
    v_cvt_pk_bf16_f32 v47, v94, v95
    v_cvt_pk_bf16_f32 v48, v80, v81
    v_cvt_pk_bf16_f32 v49, v82, v83
    v_cvt_pk_bf16_f32 v50, v96, v97
    v_cvt_pk_bf16_f32 v51, v98, v99
    s_mul_i32 s64, s8, 96256
    s_add_u32 s64, s64, 10747904
    s_lshl_b32 s63, s9, 10
    s_add_u32 s63, s63, s64
    buffer_store_dwordx4 v[40:43], v4, s[40:43], s63 offen sc1
    buffer_store_dwordx4 v[44:47], v4, s[40:43], s63 offen offset:1024 sc1
    s_lshl_b32 s63, s9, 8
    s_add_u32 s63, s63, s64
    s_add_u32 s63, s63, 32768
    s_mov_b32 exec_hi, 0
    buffer_store_dwordx4 v[48:51], v4, s[40:43], s63 offen sc1
    s_mov_b64 exec, -1
    s_add_u32 s68, s56, 61440
    v_and_b32 v24, 15, v1
    v_mul_u32_u24 v24, 176, v24
    v_lshrrev_b32 v25, 4, v1
    v_lshl_add_u32 v24, v25, 3, v24
    v_add_u32 v24, s68, v24
    v_add_u32 v32, 0, v1
    v_mul_u32_u24 v33, 6554, v32
    v_lshrrev_b32 v33, 16, v33
    v_mul_u32_u24 v34, 10, v33
    v_sub_u32 v32, v32, v34
    v_lshlrev_b32 v32, 4, v32
    v_mul_u32_u24 v26, 176, v33
    v_add3_u32 v26, v26, v32, s68
    v_mul_u32_u24 v29, 1280, v33
    v_add_u32 v29, v29, v32
    v_add_u32 v32, 64, v1
    v_mul_u32_u24 v33, 6554, v32
    v_lshrrev_b32 v33, 16, v33
    v_mul_u32_u24 v34, 10, v33
    v_sub_u32 v32, v32, v34
    v_lshlrev_b32 v32, 4, v32
    v_mul_u32_u24 v27, 176, v33
    v_add3_u32 v27, v27, v32, s68
    v_mul_u32_u24 v30, 1280, v33
    v_add_u32 v30, v30, v32
    v_add_u32 v32, 128, v1
    v_mul_u32_u24 v33, 6554, v32
    v_lshrrev_b32 v33, 16, v33
    v_mul_u32_u24 v34, 10, v33
    v_sub_u32 v32, v32, v34
    v_lshlrev_b32 v32, 4, v32
    v_mul_u32_u24 v28, 176, v33
    v_add3_u32 v28, v28, v32, s68
    v_mul_u32_u24 v31, 1280, v33
    v_add_u32 v31, v31, v32
    s_waitcnt vmcnt(35)
    s_barrier
    ds_read_b128 v[168:171], v4 offset:0
    ds_read_b128 v[172:175], v4 offset:1024
    ds_read_b128 v[176:179], v4 offset:2048
    ds_read_b128 v[180:183], v4 offset:3072
    ds_read_b128 v[184:187], v4 offset:4096
    ds_read_b128 v[188:191], v4 offset:5120
    ds_read_b128 v[192:195], v4 offset:6144
    ds_read_b128 v[196:199], v4 offset:7168
    ds_read_b128 v[200:203], v4 offset:8192
    ds_read_b128 v[204:207], v4 offset:9216
    ds_read_b128 v[208:211], v4 offset:10240
    ds_read_b128 v[212:215], v4 offset:11264
    s_add_u32 m0, s56, 102400
    s_add_u32 s55, s58, 0
    buffer_load_dwordx4 v4, s[40:43], s55 offen offset:0 sc1 lds
    s_add_u32 m0, s56, 102400
    s_nop 0
    buffer_load_dwordx4 v4, s[40:43], s55 offen offset:1024 sc1 lds
    s_add_u32 m0, s56, 102400
    s_nop 0
    buffer_load_dwordx4 v4, s[40:43], s55 offen offset:2048 sc1 lds
    s_add_u32 m0, s56, 102400
    s_nop 0
    buffer_load_dwordx4 v4, s[40:43], s55 offen offset:3072 sc1 lds
    s_add_u32 m0, s56, 106496
    s_add_u32 s55, s55, 4096
    buffer_load_dwordx4 v4, s[40:43], s55 offen offset:0 sc1 lds
    s_waitcnt vmcnt(11)
    s_mov_b32 s65, 0
M_ychk:
    v_mov_b32 v16, 0
    v_accvgpr_read_b32 v17, a0
    v_accvgpr_read_b32 v18, a4
    v_max3_u32 v16, v17, v18, v16
    v_accvgpr_read_b32 v19, a8
    v_accvgpr_read_b32 v20, a12
    v_max3_u32 v16, v19, v20, v16
    v_accvgpr_read_b32 v17, a16
    v_accvgpr_read_b32 v18, a20
    v_max3_u32 v16, v17, v18, v16
    v_accvgpr_read_b32 v19, a24
    v_accvgpr_read_b32 v20, a28
    v_max3_u32 v16, v19, v20, v16
    v_accvgpr_read_b32 v17, a32
    v_accvgpr_read_b32 v18, a36
    v_max3_u32 v16, v17, v18, v16
    v_accvgpr_read_b32 v19, a40
    v_accvgpr_read_b32 v20, a44
    v_max3_u32 v16, v19, v20, v16
    v_accvgpr_read_b32 v17, a48
    v_accvgpr_read_b32 v18, a52
    v_max3_u32 v16, v17, v18, v16
    v_accvgpr_read_b32 v19, a56
    v_accvgpr_read_b32 v20, a60
    v_max3_u32 v16, v19, v20, v16
    v_accvgpr_read_b32 v17, a64
    v_accvgpr_read_b32 v18, a68
    v_max3_u32 v16, v17, v18, v16
    v_accvgpr_read_b32 v19, a72
    v_accvgpr_read_b32 v20, a76
    v_max3_u32 v16, v19, v20, v16
    v_accvgpr_read_b32 v17, a80
    v_accvgpr_read_b32 v18, a84
    v_max3_u32 v16, v17, v18, v16
    v_accvgpr_read_b32 v19, a88
    v_accvgpr_read_b32 v20, a92
    v_max3_u32 v16, v19, v20, v16
    v_accvgpr_read_b32 v17, a96
    v_accvgpr_read_b32 v18, a100
    v_max3_u32 v16, v17, v18, v16
    v_accvgpr_read_b32 v19, a104
    v_accvgpr_read_b32 v20, a104
    v_max3_u32 v16, v19, v20, v16
    v_cmp_eq_u32 vcc, -1, v16
    s_cbranch_vccz M_yok
    s_add_u32 s67, s54, 40960
    buffer_load_dwordx4 a[0:3], v240, s[40:43], s67 offen offset:0 sc1
    buffer_load_dwordx4 a[4:7], v240, s[40:43], s67 offen offset:2048 sc1
    s_add_u32 s67, s54, 45056
    buffer_load_dwordx4 a[8:11], v240, s[40:43], s67 offen offset:0 sc1
    buffer_load_dwordx4 a[12:15], v240, s[40:43], s67 offen offset:2048 sc1
    s_add_u32 s67, s54, 49152
    buffer_load_dwordx4 a[16:19], v240, s[40:43], s67 offen offset:0 sc1
    buffer_load_dwordx4 a[20:23], v240, s[40:43], s67 offen offset:2048 sc1
    s_add_u32 s67, s54, 53248
    buffer_load_dwordx4 a[24:27], v240, s[40:43], s67 offen offset:0 sc1
    buffer_load_dwordx4 a[28:31], v240, s[40:43], s67 offen offset:2048 sc1
    s_add_u32 s67, s54, 57344
    buffer_load_dwordx4 a[32:35], v240, s[40:43], s67 offen offset:0 sc1
    buffer_load_dwordx4 a[36:39], v240, s[40:43], s67 offen offset:2048 sc1
    s_add_u32 s67, s54, 61440
    buffer_load_dwordx4 a[40:43], v240, s[40:43], s67 offen offset:0 sc1
    buffer_load_dwordx4 a[44:47], v240, s[40:43], s67 offen offset:2048 sc1
    s_add_u32 s67, s54, 65536
    buffer_load_dwordx4 a[48:51], v240, s[40:43], s67 offen offset:0 sc1
    buffer_load_dwordx4 a[52:55], v240, s[40:43], s67 offen offset:2048 sc1
    s_add_u32 s67, s54, 69632
    buffer_load_dwordx4 a[56:59], v240, s[40:43], s67 offen offset:0 sc1
    buffer_load_dwordx4 a[60:63], v240, s[40:43], s67 offen offset:2048 sc1
    s_add_u32 s67, s54, 73728
    buffer_load_dwordx4 a[64:67], v240, s[40:43], s67 offen offset:0 sc1
    buffer_load_dwordx4 a[68:71], v240, s[40:43], s67 offen offset:2048 sc1
    s_add_u32 s67, s54, 77824
    buffer_load_dwordx4 a[72:75], v240, s[40:43], s67 offen offset:0 sc1
    buffer_load_dwordx4 a[76:79], v240, s[40:43], s67 offen offset:2048 sc1
    s_add_u32 s67, s54, 81920
    buffer_load_dwordx4 a[80:83], v240, s[40:43], s67 offen offset:0 sc1
    buffer_load_dwordx4 a[84:87], v240, s[40:43], s67 offen offset:2048 sc1
    s_add_u32 s67, s54, 86016
    buffer_load_dwordx4 a[88:91], v240, s[40:43], s67 offen offset:0 sc1
    buffer_load_dwordx4 a[92:95], v240, s[40:43], s67 offen offset:2048 sc1
    s_add_u32 s67, s54, 90112
    buffer_load_dwordx4 a[96:99], v240, s[40:43], s67 offen offset:0 sc1
    buffer_load_dwordx4 a[100:103], v240, s[40:43], s67 offen offset:2048 sc1
    s_add_u32 s67, s54, 94208
    buffer_load_dwordx4 a[104:107], v240, s[40:43], s67 offen offset:0 sc1
    s_waitcnt vmcnt(0)
    s_add_u32 s65, s65, 1
    s_cmp_lt_u32 s65, 16384
    s_cbranch_scc1 M_ychk
M_yok:
    s_waitcnt lgkmcnt(8)
    v_mfma_f32_16x16x32_bf16 v[104:107], v[168:171], a[0:3], 0
    ds_read_b128 v[216:219], v4 offset:12288
    v_mfma_f32_16x16x32_bf16 v[108:111], v[172:175], a[0:3], 0
    ds_read_b128 v[168:171], v4 offset:13312
    v_mfma_f32_16x16x32_bf16 v[112:115], v[176:179], a[0:3], 0
    ds_read_b128 v[172:175], v4 offset:14336
    v_mfma_f32_16x16x32_bf16 v[116:119], v[180:183], a[0:3], 0
    ds_read_b128 v[176:179], v4 offset:15360
    s_waitcnt lgkmcnt(8)
    v_mfma_f32_16x16x32_bf16 v[120:123], v[184:187], a[0:3], 0
    ds_read_b128 v[180:183], v4 offset:16384
    v_mfma_f32_16x16x32_bf16 v[104:107], v[188:191], a[4:7], v[104:107]
    ds_read_b128 v[184:187], v4 offset:17408
    v_mfma_f32_16x16x32_bf16 v[108:111], v[192:195], a[4:7], v[108:111]
    ds_read_b128 v[188:191], v4 offset:18432
    v_mfma_f32_16x16x32_bf16 v[112:115], v[196:199], a[4:7], v[112:115]
    ds_read_b128 v[192:195], v4 offset:19456
    s_waitcnt lgkmcnt(8)
    v_mfma_f32_16x16x32_bf16 v[116:119], v[200:203], a[4:7], v[116:119]
    ds_read_b128 v[196:199], v4 offset:20480
    v_mfma_f32_16x16x32_bf16 v[120:123], v[204:207], a[4:7], v[120:123]
    ds_read_b128 v[200:203], v4 offset:21504
    v_mfma_f32_16x16x32_bf16 v[104:107], v[208:211], a[8:11], v[104:107]
    ds_read_b128 v[204:207], v4 offset:22528
    v_mfma_f32_16x16x32_bf16 v[108:111], v[212:215], a[8:11], v[108:111]
    ds_read_b128 v[208:211], v4 offset:23552
    s_waitcnt lgkmcnt(8)
    v_mfma_f32_16x16x32_bf16 v[112:115], v[216:219], a[8:11], v[112:115]
    s_add_u32 s67, s54, 0
    ds_read_b128 v[212:215], v4 offset:24576
    buffer_load_dwordx4 v[56:59], v240, s[40:43], s67 offen offset:0 sc1
    v_mfma_f32_16x16x32_bf16 v[116:119], v[168:171], a[8:11], v[116:119]
    ds_read_b128 v[216:219], v4 offset:25600
    v_mfma_f32_16x16x32_bf16 v[120:123], v[172:175], a[8:11], v[120:123]
    ds_read_b128 v[168:171], v4 offset:26624
    v_mfma_f32_16x16x32_bf16 v[104:107], v[176:179], a[12:15], v[104:107]
    ds_read_b128 v[172:175], v4 offset:27648
    s_waitcnt lgkmcnt(8)
    v_mfma_f32_16x16x32_bf16 v[108:111], v[180:183], a[12:15], v[108:111]
    ds_read_b128 v[176:179], v4 offset:28672
    buffer_load_dwordx4 v[60:63], v240, s[40:43], s67 offen offset:2048 sc1
    v_mfma_f32_16x16x32_bf16 v[112:115], v[184:187], a[12:15], v[112:115]
    ds_read_b128 v[180:183], v4 offset:29696
    v_mfma_f32_16x16x32_bf16 v[116:119], v[188:191], a[12:15], v[116:119]
    ds_read_b128 v[184:187], v4 offset:30720
    v_mfma_f32_16x16x32_bf16 v[120:123], v[192:195], a[12:15], v[120:123]
    ds_read_b128 v[188:191], v4 offset:31744
    s_waitcnt lgkmcnt(8)
    v_mfma_f32_16x16x32_bf16 v[104:107], v[196:199], a[16:19], v[104:107]
    s_add_u32 s67, s54, 4096
    ds_read_b128 v[192:195], v4 offset:32768
    buffer_load_dwordx4 v[64:67], v240, s[40:43], s67 offen offset:0 sc1
    v_mfma_f32_16x16x32_bf16 v[108:111], v[200:203], a[16:19], v[108:111]
    ds_read_b128 v[196:199], v4 offset:33792
    v_mfma_f32_16x16x32_bf16 v[112:115], v[204:207], a[16:19], v[112:115]
    ds_read_b128 v[200:203], v4 offset:34816
    v_mfma_f32_16x16x32_bf16 v[116:119], v[208:211], a[16:19], v[116:119]
    ds_read_b128 v[204:207], v4 offset:35840
    s_waitcnt lgkmcnt(8)
    v_mfma_f32_16x16x32_bf16 v[120:123], v[212:215], a[16:19], v[120:123]
    ds_read_b128 v[208:211], v4 offset:36864
    buffer_load_dwordx4 v[68:71], v240, s[40:43], s67 offen offset:2048 sc1
    v_mfma_f32_16x16x32_bf16 v[104:107], v[216:219], a[20:23], v[104:107]
    ds_read_b128 v[212:215], v4 offset:37888
    v_mfma_f32_16x16x32_bf16 v[108:111], v[168:171], a[20:23], v[108:111]
    ds_read_b128 v[216:219], v4 offset:38912
    v_mfma_f32_16x16x32_bf16 v[112:115], v[172:175], a[20:23], v[112:115]
    ds_read_b128 v[168:171], v4 offset:39936
    s_waitcnt lgkmcnt(8)
    v_mfma_f32_16x16x32_bf16 v[116:119], v[176:179], a[20:23], v[116:119]
    s_add_u32 s67, s54, 8192
    ds_read_b128 v[172:175], v4 offset:40960
    buffer_load_dwordx4 v[72:75], v240, s[40:43], s67 offen offset:0 sc1
    v_mfma_f32_16x16x32_bf16 v[120:123], v[180:183], a[20:23], v[120:123]
    ds_read_b128 v[176:179], v4 offset:41984
    v_mfma_f32_16x16x32_bf16 v[104:107], v[184:187], a[24:27], v[104:107]
    ds_read_b128 v[180:183], v4 offset:43008
    v_mfma_f32_16x16x32_bf16 v[108:111], v[188:191], a[24:27], v[108:111]
    ds_read_b128 v[184:187], v4 offset:44032
    s_waitcnt lgkmcnt(8)
    v_mfma_f32_16x16x32_bf16 v[112:115], v[192:195], a[24:27], v[112:115]
    ds_read_b128 v[188:191], v4 offset:45056
    buffer_load_dwordx4 v[76:79], v240, s[40:43], s67 offen offset:2048 sc1
    v_mfma_f32_16x16x32_bf16 v[116:119], v[196:199], a[24:27], v[116:119]
    ds_read_b128 v[192:195], v4 offset:46080
    v_mfma_f32_16x16x32_bf16 v[120:123], v[200:203], a[24:27], v[120:123]
    ds_read_b128 v[196:199], v4 offset:47104
    v_mfma_f32_16x16x32_bf16 v[104:107], v[204:207], a[28:31], v[104:107]
    ds_read_b128 v[200:203], v4 offset:48128
    s_waitcnt lgkmcnt(8)
    v_mfma_f32_16x16x32_bf16 v[108:111], v[208:211], a[28:31], v[108:111]
    s_add_u32 s67, s54, 12288
    ds_read_b128 v[204:207], v4 offset:49152
    buffer_load_dwordx4 v[80:83], v240, s[40:43], s67 offen offset:0 sc1
    v_mfma_f32_16x16x32_bf16 v[112:115], v[212:215], a[28:31], v[112:115]
    ds_read_b128 v[208:211], v4 offset:50176
    v_mfma_f32_16x16x32_bf16 v[116:119], v[216:219], a[28:31], v[116:119]
    ds_read_b128 v[212:215], v4 offset:51200
    v_mfma_f32_16x16x32_bf16 v[120:123], v[168:171], a[28:31], v[120:123]
    ds_read_b128 v[216:219], v4 offset:52224
    s_waitcnt lgkmcnt(8)
    v_mfma_f32_16x16x32_bf16 v[104:107], v[172:175], a[32:35], v[104:107]
    ds_read_b128 v[168:171], v4 offset:53248
    buffer_load_dwordx4 v[84:87], v240, s[40:43], s67 offen offset:2048 sc1
    v_mfma_f32_16x16x32_bf16 v[108:111], v[176:179], a[32:35], v[108:111]
    ds_read_b128 v[172:175], v4 offset:54272
    v_mfma_f32_16x16x32_bf16 v[112:115], v[180:183], a[32:35], v[112:115]
    ds_read_b128 v[176:179], v4 offset:55296
    v_mfma_f32_16x16x32_bf16 v[116:119], v[184:187], a[32:35], v[116:119]
    ds_read_b128 v[180:183], v4 offset:56320
    s_waitcnt lgkmcnt(8)
    v_mfma_f32_16x16x32_bf16 v[120:123], v[188:191], a[32:35], v[120:123]
    s_add_u32 s67, s54, 16384
    ds_read_b128 v[184:187], v4 offset:57344
    buffer_load_dwordx4 v[88:91], v240, s[40:43], s67 offen offset:0 sc1
    v_mfma_f32_16x16x32_bf16 v[104:107], v[192:195], a[36:39], v[104:107]
    ds_read_b128 v[188:191], v4 offset:58368
    v_mfma_f32_16x16x32_bf16 v[108:111], v[196:199], a[36:39], v[108:111]
    ds_read_b128 v[192:195], v4 offset:59392
    v_mfma_f32_16x16x32_bf16 v[112:115], v[200:203], a[36:39], v[112:115]
    ds_read_b128 v[196:199], v4 offset:60416
    s_waitcnt lgkmcnt(8)
    v_mfma_f32_16x16x32_bf16 v[116:119], v[204:207], a[36:39], v[116:119]
    s_barrier
    ds_read_b128 v[200:203], v242 offset:0
    buffer_load_dwordx4 v[92:95], v240, s[40:43], s67 offen offset:2048 sc1
    v_mfma_f32_16x16x32_bf16 v[120:123], v[208:211], a[36:39], v[120:123]
    ds_read_b128 v[204:207], v242 offset:1024
    v_mfma_f32_16x16x32_bf16 v[104:107], v[212:215], a[40:43], v[104:107]
    ds_read_b128 v[208:211], v242 offset:2048
    v_mfma_f32_16x16x32_bf16 v[108:111], v[216:219], a[40:43], v[108:111]
    ds_read_b128 v[212:215], v242 offset:3072
    s_waitcnt lgkmcnt(8)
    v_mfma_f32_16x16x32_bf16 v[112:115], v[168:171], a[40:43], v[112:115]
    s_add_u32 s67, s54, 20480
    ds_read_b128 v[216:219], v242 offset:4096
    buffer_load_dwordx4 v[96:99], v240, s[40:43], s67 offen offset:0 sc1
    v_mfma_f32_16x16x32_bf16 v[116:119], v[172:175], a[40:43], v[116:119]
    ds_read_b128 v[168:171], v242 offset:5120
    v_mfma_f32_16x16x32_bf16 v[120:123], v[176:179], a[40:43], v[120:123]
    ds_read_b128 v[172:175], v242 offset:6144
    v_mfma_f32_16x16x32_bf16 v[104:107], v[180:183], a[44:47], v[104:107]
    ds_read_b128 v[176:179], v242 offset:7168
    s_waitcnt lgkmcnt(8)
    v_mfma_f32_16x16x32_bf16 v[108:111], v[184:187], a[44:47], v[108:111]
    ds_read_b128 v[180:183], v242 offset:8192
    buffer_load_dwordx4 v[100:103], v240, s[40:43], s67 offen offset:2048 sc1
    v_mfma_f32_16x16x32_bf16 v[112:115], v[188:191], a[44:47], v[112:115]
    ds_read_b128 v[184:187], v242 offset:9216
    v_mfma_f32_16x16x32_bf16 v[116:119], v[192:195], a[44:47], v[116:119]
    ds_read_b128 v[188:191], v242 offset:10240
    v_mfma_f32_16x16x32_bf16 v[120:123], v[196:199], a[44:47], v[120:123]
    ds_read_b128 v[192:195], v242 offset:11264
    s_waitcnt lgkmcnt(8)
    v_mfma_f32_16x16x32_bf16 v[104:107], v[200:203], a[48:51], v[104:107]
    s_add_u32 s67, s54, 24576
    ds_read_b128 v[196:199], v242 offset:12288
    buffer_load_dwordx4 v[136:139], v240, s[40:43], s67 offen offset:0 sc1
    v_mfma_f32_16x16x32_bf16 v[108:111], v[204:207], a[48:51], v[108:111]
    ds_read_b128 v[200:203], v242 offset:13312
    v_mfma_f32_16x16x32_bf16 v[112:115], v[208:211], a[48:51], v[112:115]
    ds_read_b128 v[204:207], v242 offset:14336
    v_mfma_f32_16x16x32_bf16 v[116:119], v[212:215], a[48:51], v[116:119]
    ds_read_b128 v[208:211], v242 offset:15360
    s_waitcnt lgkmcnt(8)
    v_mfma_f32_16x16x32_bf16 v[120:123], v[216:219], a[48:51], v[120:123]
    ds_read_b128 v[212:215], v242 offset:16384
    buffer_load_dwordx4 v[140:143], v240, s[40:43], s67 offen offset:2048 sc1
    v_mfma_f32_16x16x32_bf16 v[104:107], v[168:171], a[52:55], v[104:107]
    ds_read_b128 v[216:219], v242 offset:17408
    v_mfma_f32_16x16x32_bf16 v[108:111], v[172:175], a[52:55], v[108:111]
    ds_read_b128 v[168:171], v242 offset:18432
    v_mfma_f32_16x16x32_bf16 v[112:115], v[176:179], a[52:55], v[112:115]
    ds_read_b128 v[172:175], v242 offset:19456
    s_waitcnt lgkmcnt(8)
    v_mfma_f32_16x16x32_bf16 v[116:119], v[180:183], a[52:55], v[116:119]
    s_add_u32 s67, s54, 28672
    ds_read_b128 v[176:179], v242 offset:20480
    buffer_load_dwordx4 v[144:147], v240, s[40:43], s67 offen offset:0 sc1
    v_mfma_f32_16x16x32_bf16 v[120:123], v[184:187], a[52:55], v[120:123]
    ds_read_b128 v[180:183], v242 offset:21504
    v_mfma_f32_16x16x32_bf16 v[104:107], v[188:191], a[56:59], v[104:107]
    ds_read_b128 v[184:187], v242 offset:22528
    v_mfma_f32_16x16x32_bf16 v[108:111], v[192:195], a[56:59], v[108:111]
    ds_read_b128 v[188:191], v242 offset:23552
    s_waitcnt lgkmcnt(8)
    v_mfma_f32_16x16x32_bf16 v[112:115], v[196:199], a[56:59], v[112:115]
    ds_read_b128 v[192:195], v242 offset:24576
    buffer_load_dwordx4 v[148:151], v240, s[40:43], s67 offen offset:2048 sc1
    v_mfma_f32_16x16x32_bf16 v[116:119], v[200:203], a[56:59], v[116:119]
    ds_read_b128 v[196:199], v242 offset:25600
    v_mfma_f32_16x16x32_bf16 v[120:123], v[204:207], a[56:59], v[120:123]
    ds_read_b128 v[200:203], v242 offset:26624
    v_mfma_f32_16x16x32_bf16 v[104:107], v[208:211], a[60:63], v[104:107]
    ds_read_b128 v[204:207], v242 offset:27648
    s_waitcnt lgkmcnt(8)
    v_mfma_f32_16x16x32_bf16 v[108:111], v[212:215], a[60:63], v[108:111]
    s_add_u32 s67, s54, 32768
    ds_read_b128 v[208:211], v242 offset:28672
    buffer_load_dwordx4 v[152:155], v240, s[40:43], s67 offen offset:0 sc1
    v_mfma_f32_16x16x32_bf16 v[112:115], v[216:219], a[60:63], v[112:115]
    ds_read_b128 v[212:215], v242 offset:29696
    v_mfma_f32_16x16x32_bf16 v[116:119], v[168:171], a[60:63], v[116:119]
    ds_read_b128 v[216:219], v242 offset:30720
    v_mfma_f32_16x16x32_bf16 v[120:123], v[172:175], a[60:63], v[120:123]
    ds_read_b128 v[168:171], v242 offset:31744
    s_waitcnt lgkmcnt(8)
    v_mfma_f32_16x16x32_bf16 v[104:107], v[176:179], a[64:67], v[104:107]
    ds_read_b128 v[172:175], v242 offset:32768
    buffer_load_dwordx4 v[156:159], v240, s[40:43], s67 offen offset:2048 sc1
    v_mfma_f32_16x16x32_bf16 v[108:111], v[180:183], a[64:67], v[108:111]
    ds_read_b128 v[176:179], v242 offset:33792
    v_mfma_f32_16x16x32_bf16 v[112:115], v[184:187], a[64:67], v[112:115]
    ds_read_b128 v[180:183], v242 offset:34816
    v_mfma_f32_16x16x32_bf16 v[116:119], v[188:191], a[64:67], v[116:119]
    ds_read_b128 v[184:187], v242 offset:35840
    s_waitcnt lgkmcnt(8)
    v_mfma_f32_16x16x32_bf16 v[120:123], v[192:195], a[64:67], v[120:123]
    s_add_u32 s67, s54, 36864
    ds_read_b128 v[188:191], v242 offset:36864
    buffer_load_dwordx4 v[160:163], v240, s[40:43], s67 offen offset:0 sc1
    v_mfma_f32_16x16x32_bf16 v[104:107], v[196:199], a[68:71], v[104:107]
    ds_read_b128 v[192:195], v242 offset:37888
    v_mfma_f32_16x16x32_bf16 v[108:111], v[200:203], a[68:71], v[108:111]
    ds_read_b128 v[196:199], v242 offset:38912
    v_mfma_f32_16x16x32_bf16 v[112:115], v[204:207], a[68:71], v[112:115]
    ds_read_b128 v[200:203], v242 offset:39936
    s_waitcnt lgkmcnt(8)
    v_mfma_f32_16x16x32_bf16 v[116:119], v[208:211], a[68:71], v[116:119]
    s_barrier
    ds_read_b128 v[204:207], v241 offset:0
    buffer_load_dwordx4 v[164:167], v240, s[40:43], s67 offen offset:2048 sc1
    v_mfma_f32_16x16x32_bf16 v[120:123], v[212:215], a[68:71], v[120:123]
    s_add_u32 m0, s56, 0
    s_add_u32 s55, s58, 20480
    ds_read_b128 v[208:211], v241 offset:1024
    buffer_load_dwordx4 v4, s[40:43], s55 offen offset:0 sc1 lds
    v_mfma_f32_16x16x32_bf16 v[104:107], v[216:219], a[72:75], v[104:107]
    ds_read_b128 v[212:215], v241 offset:2048
    v_mfma_f32_16x16x32_bf16 v[108:111], v[168:171], a[72:75], v[108:111]
    ds_read_b128 v[216:219], v241 offset:3072
    s_waitcnt lgkmcnt(8)
    v_mfma_f32_16x16x32_bf16 v[112:115], v[172:175], a[72:75], v[112:115]
    s_add_u32 m0, s56, 0
    ds_read_b128 v[168:171], v241 offset:4096
    buffer_load_dwordx4 v4, s[40:43], s55 offen offset:1024 sc1 lds
    v_mfma_f32_16x16x32_bf16 v[116:119], v[176:179], a[72:75], v[116:119]
    ds_read_b128 v[172:175], v241 offset:5120
    v_mfma_f32_16x16x32_bf16 v[120:123], v[180:183], a[72:75], v[120:123]
    ds_read_b128 v[176:179], v241 offset:6144
    v_mfma_f32_16x16x32_bf16 v[104:107], v[184:187], a[76:79], v[104:107]
    ds_read_b128 v[180:183], v241 offset:7168
    s_waitcnt lgkmcnt(8)
    v_mfma_f32_16x16x32_bf16 v[108:111], v[188:191], a[76:79], v[108:111]
    s_add_u32 m0, s56, 0
    ds_read_b128 v[184:187], v241 offset:8192
    buffer_load_dwordx4 v4, s[40:43], s55 offen offset:2048 sc1 lds
    v_mfma_f32_16x16x32_bf16 v[112:115], v[192:195], a[76:79], v[112:115]
    ds_read_b128 v[188:191], v241 offset:9216
    v_mfma_f32_16x16x32_bf16 v[116:119], v[196:199], a[76:79], v[116:119]
    ds_read_b128 v[192:195], v241 offset:10240
    v_mfma_f32_16x16x32_bf16 v[120:123], v[200:203], a[76:79], v[120:123]
    ds_read_b128 v[196:199], v241 offset:11264
    s_waitcnt lgkmcnt(8)
    v_mfma_f32_16x16x32_bf16 v[104:107], v[204:207], a[80:83], v[104:107]
    s_add_u32 m0, s56, 0
    ds_read_b128 v[200:203], v241 offset:12288
    buffer_load_dwordx4 v4, s[40:43], s55 offen offset:3072 sc1 lds
    v_mfma_f32_16x16x32_bf16 v[108:111], v[208:211], a[80:83], v[108:111]
    ds_read_b128 v[204:207], v241 offset:13312
    v_mfma_f32_16x16x32_bf16 v[112:115], v[212:215], a[80:83], v[112:115]
    ds_read_b128 v[208:211], v241 offset:14336
    v_mfma_f32_16x16x32_bf16 v[116:119], v[216:219], a[80:83], v[116:119]
    ds_read_b128 v[212:215], v241 offset:15360
    s_waitcnt lgkmcnt(8)
    v_mfma_f32_16x16x32_bf16 v[120:123], v[168:171], a[80:83], v[120:123]
    s_add_u32 m0, s56, 4096
    s_add_u32 s55, s55, 4096
    ds_read_b128 v[216:219], v241 offset:16384
    buffer_load_dwordx4 v4, s[40:43], s55 offen offset:0 sc1 lds
    v_mfma_f32_16x16x32_bf16 v[104:107], v[172:175], a[84:87], v[104:107]
    ds_read_b128 v[168:171], v241 offset:17408
    v_mfma_f32_16x16x32_bf16 v[108:111], v[176:179], a[84:87], v[108:111]
    ds_read_b128 v[172:175], v241 offset:18432
    v_mfma_f32_16x16x32_bf16 v[112:115], v[180:183], a[84:87], v[112:115]
    ds_read_b128 v[176:179], v241 offset:19456
    s_waitcnt lgkmcnt(8)
    v_mfma_f32_16x16x32_bf16 v[116:119], v[184:187], a[84:87], v[116:119]
    s_add_u32 m0, s56, 20480
    s_add_u32 s55, s58, 40960
    s_waitcnt vmcnt(33)
    s_barrier
    ds_read_b128 v[180:183], v241 offset:20480
    buffer_load_dwordx4 v4, s[40:43], s55 offen offset:0 sc1 lds
    v_mfma_f32_16x16x32_bf16 v[120:123], v[188:191], a[84:87], v[120:123]
    ds_read_b128 v[184:187], v241 offset:21504
    v_mfma_f32_16x16x32_bf16 v[104:107], v[192:195], a[88:91], v[104:107]
    ds_read_b128 v[188:191], v241 offset:22528
    v_mfma_f32_16x16x32_bf16 v[108:111], v[196:199], a[88:91], v[108:111]
    ds_read_b128 v[192:195], v241 offset:23552
    s_waitcnt lgkmcnt(8)
    v_mfma_f32_16x16x32_bf16 v[112:115], v[200:203], a[88:91], v[112:115]
    s_add_u32 m0, s56, 20480
    ds_read_b128 v[196:199], v241 offset:24576
    buffer_load_dwordx4 v4, s[40:43], s55 offen offset:1024 sc1 lds
    v_mfma_f32_16x16x32_bf16 v[116:119], v[204:207], a[88:91], v[116:119]
    ds_read_b128 v[200:203], v241 offset:25600
    v_mfma_f32_16x16x32_bf16 v[120:123], v[208:211], a[88:91], v[120:123]
    ds_read_b128 v[204:207], v241 offset:26624
    v_mfma_f32_16x16x32_bf16 v[104:107], v[212:215], a[92:95], v[104:107]
    ds_read_b128 v[208:211], v241 offset:27648
    s_waitcnt lgkmcnt(8)
    v_mfma_f32_16x16x32_bf16 v[108:111], v[216:219], a[92:95], v[108:111]
    s_add_u32 m0, s56, 20480
    ds_read_b128 v[212:215], v241 offset:28672
    buffer_load_dwordx4 v4, s[40:43], s55 offen offset:2048 sc1 lds
    v_mfma_f32_16x16x32_bf16 v[112:115], v[168:171], a[92:95], v[112:115]
    ds_read_b128 v[216:219], v241 offset:29696
    v_mfma_f32_16x16x32_bf16 v[116:119], v[172:175], a[92:95], v[116:119]
    ds_read_b128 v[168:171], v241 offset:30720
    v_mfma_f32_16x16x32_bf16 v[120:123], v[176:179], a[92:95], v[120:123]
    ds_read_b128 v[172:175], v241 offset:31744
    s_waitcnt lgkmcnt(8)
    v_mfma_f32_16x16x32_bf16 v[104:107], v[180:183], a[96:99], v[104:107]
    s_add_u32 m0, s56, 20480
    ds_read_b128 v[176:179], v241 offset:32768
    buffer_load_dwordx4 v4, s[40:43], s55 offen offset:3072 sc1 lds
    v_mfma_f32_16x16x32_bf16 v[108:111], v[184:187], a[96:99], v[108:111]
    ds_read_b128 v[180:183], v241 offset:33792
    v_mfma_f32_16x16x32_bf16 v[112:115], v[188:191], a[96:99], v[112:115]
    ds_read_b128 v[184:187], v241 offset:34816
    v_mfma_f32_16x16x32_bf16 v[116:119], v[192:195], a[96:99], v[116:119]
    s_waitcnt vmcnt(29)
    s_barrier
    ds_read_b128 v[188:191], v241 offset:40960
    s_waitcnt lgkmcnt(8)
    v_mfma_f32_16x16x32_bf16 v[120:123], v[196:199], a[96:99], v[120:123]
    s_add_u32 m0, s56, 24576
    s_add_u32 s55, s55, 4096
    ds_read_b128 v[192:195], v241 offset:41984
    buffer_load_dwordx4 v4, s[40:43], s55 offen offset:0 sc1 lds
    v_mfma_f32_16x16x32_bf16 v[104:107], v[200:203], a[100:103], v[104:107]
    ds_read_b128 v[196:199], v241 offset:43008
    v_mfma_f32_16x16x32_bf16 v[108:111], v[204:207], a[100:103], v[108:111]
    ds_read_b128 v[200:203], v241 offset:44032
    v_mfma_f32_16x16x32_bf16 v[112:115], v[208:211], a[100:103], v[112:115]
    ds_read_b128 v[204:207], v241 offset:45056
    s_waitcnt lgkmcnt(8)
    v_mfma_f32_16x16x32_bf16 v[116:119], v[212:215], a[100:103], v[116:119]
    s_add_u32 m0, s56, 40960
    s_add_u32 s55, s58, 61440
    ds_read_b128 v[208:211], v241 offset:46080
    buffer_load_dwordx4 v4, s[40:43], s55 offen offset:0 sc1 lds
    v_mfma_f32_16x16x32_bf16 v[120:123], v[216:219], a[100:103], v[120:123]
    ds_read_b128 v[212:215], v241 offset:47104
    v_mfma_f32_16x16x32_bf16 v[104:107], v[168:171], a[104:107], v[104:107]
    ds_read_b128 v[216:219], v241 offset:48128
    v_mfma_f32_16x16x32_bf16 v[108:111], v[172:175], a[104:107], v[108:111]
    ds_read_b128 v[168:171], v241 offset:49152
    s_waitcnt lgkmcnt(8)
    v_mfma_f32_16x16x32_bf16 v[112:115], v[176:179], a[104:107], v[112:115]
    s_add_u32 m0, s56, 40960
    ds_read_b128 v[172:175], v241 offset:50176
    buffer_load_dwordx4 v4, s[40:43], s55 offen offset:1024 sc1 lds
    v_mfma_f32_16x16x32_bf16 v[116:119], v[180:183], a[104:107], v[116:119]
    ds_read_b128 v[176:179], v241 offset:51200
    v_mfma_f32_16x16x32_bf16 v[120:123], v[184:187], a[104:107], v[120:123]
    ds_read_b128 v[180:183], v241 offset:52224
    s_waitcnt vmcnt(12)
    s_mov_b32 s65, 0
M_ochk:
    v_max_u32 v16, v56, v60
    v_max3_u32 v16, v64, v68, v16
    v_max3_u32 v16, v72, v76, v16
    v_max3_u32 v16, v80, v84, v16
    v_max3_u32 v16, v88, v92, v16
    v_max3_u32 v16, v96, v100, v16
    v_max3_u32 v16, v136, v140, v16
    v_max3_u32 v16, v144, v148, v16
    v_max3_u32 v16, v152, v156, v16
    v_max3_u32 v16, v160, v164, v16
    v_cmp_eq_u32 vcc, -1, v16
    s_cbranch_vccz M_ook
    s_add_u32 s67, s54, 0
    buffer_load_dwordx4 v[56:59], v240, s[40:43], s67 offen offset:0 sc1
    buffer_load_dwordx4 v[60:63], v240, s[40:43], s67 offen offset:2048 sc1
    s_add_u32 s67, s54, 4096
    buffer_load_dwordx4 v[64:67], v240, s[40:43], s67 offen offset:0 sc1
    buffer_load_dwordx4 v[68:71], v240, s[40:43], s67 offen offset:2048 sc1
    s_add_u32 s67, s54, 8192
    buffer_load_dwordx4 v[72:75], v240, s[40:43], s67 offen offset:0 sc1
    buffer_load_dwordx4 v[76:79], v240, s[40:43], s67 offen offset:2048 sc1
    s_add_u32 s67, s54, 12288
    buffer_load_dwordx4 v[80:83], v240, s[40:43], s67 offen offset:0 sc1
    buffer_load_dwordx4 v[84:87], v240, s[40:43], s67 offen offset:2048 sc1
    s_add_u32 s67, s54, 16384
    buffer_load_dwordx4 v[88:91], v240, s[40:43], s67 offen offset:0 sc1
    buffer_load_dwordx4 v[92:95], v240, s[40:43], s67 offen offset:2048 sc1
    s_add_u32 s67, s54, 20480
    buffer_load_dwordx4 v[96:99], v240, s[40:43], s67 offen offset:0 sc1
    buffer_load_dwordx4 v[100:103], v240, s[40:43], s67 offen offset:2048 sc1
    s_add_u32 s67, s54, 24576
    buffer_load_dwordx4 v[136:139], v240, s[40:43], s67 offen offset:0 sc1
    buffer_load_dwordx4 v[140:143], v240, s[40:43], s67 offen offset:2048 sc1
    s_add_u32 s67, s54, 28672
    buffer_load_dwordx4 v[144:147], v240, s[40:43], s67 offen offset:0 sc1
    buffer_load_dwordx4 v[148:151], v240, s[40:43], s67 offen offset:2048 sc1
    s_add_u32 s67, s54, 32768
    buffer_load_dwordx4 v[152:155], v240, s[40:43], s67 offen offset:0 sc1
    buffer_load_dwordx4 v[156:159], v240, s[40:43], s67 offen offset:2048 sc1
    s_add_u32 s67, s54, 36864
    buffer_load_dwordx4 v[160:163], v240, s[40:43], s67 offen offset:0 sc1
    buffer_load_dwordx4 v[164:167], v240, s[40:43], s67 offen offset:2048 sc1
    s_waitcnt vmcnt(0)
    s_add_u32 s65, s65, 1
    s_cmp_lt_u32 s65, 16384
    s_cbranch_scc1 M_ochk
M_ook:
    v_mfma_f32_16x16x32_bf16 v[104:107], v[188:191], v[56:59], v[104:107]
    ds_read_b128 v[184:187], v241 offset:53248
    s_waitcnt lgkmcnt(8)
    v_mfma_f32_16x16x32_bf16 v[108:111], v[192:195], v[56:59], v[108:111]
    s_add_u32 m0, s56, 40960
    ds_read_b128 v[188:191], v241 offset:54272
    buffer_load_dwordx4 v4, s[40:43], s55 offen offset:2048 sc1 lds
    v_mfma_f32_16x16x32_bf16 v[112:115], v[196:199], v[56:59], v[112:115]
    ds_read_b128 v[192:195], v241 offset:55296
    v_mfma_f32_16x16x32_bf16 v[116:119], v[200:203], v[56:59], v[116:119]
    ds_read_b128 v[196:199], v241 offset:56320
    v_mfma_f32_16x16x32_bf16 v[120:123], v[204:207], v[56:59], v[120:123]
    ds_read_b128 v[200:203], v241 offset:57344
    s_waitcnt lgkmcnt(8)
    v_mfma_f32_16x16x32_bf16 v[104:107], v[208:211], v[60:63], v[104:107]
    s_add_u32 m0, s56, 40960
    ds_read_b128 v[204:207], v241 offset:58368
    buffer_load_dwordx4 v4, s[40:43], s55 offen offset:3072 sc1 lds
    v_mfma_f32_16x16x32_bf16 v[108:111], v[212:215], v[60:63], v[108:111]
    ds_read_b128 v[208:211], v241 offset:59392
    v_mfma_f32_16x16x32_bf16 v[112:115], v[216:219], v[60:63], v[112:115]
    ds_read_b128 v[212:215], v241 offset:60416
    v_mfma_f32_16x16x32_bf16 v[116:119], v[168:171], v[60:63], v[116:119]
    s_waitcnt vmcnt(9)
    s_barrier
    ds_read_b128 v[216:219], v4 offset:0
    s_waitcnt lgkmcnt(8)
    v_mfma_f32_16x16x32_bf16 v[120:123], v[172:175], v[60:63], v[120:123]
    s_add_u32 m0, s56, 45056
    s_add_u32 s55, s55, 4096
    ds_read_b128 v[168:171], v4 offset:1024
    buffer_load_dwordx4 v4, s[40:43], s55 offen offset:0 sc1 lds
    v_mfma_f32_16x16x32_bf16 v[104:107], v[176:179], v[64:67], v[104:107]
    ds_read_b128 v[172:175], v4 offset:2048
    v_mfma_f32_16x16x32_bf16 v[108:111], v[180:183], v[64:67], v[108:111]
    ds_read_b128 v[176:179], v4 offset:3072
    v_mfma_f32_16x16x32_bf16 v[112:115], v[184:187], v[64:67], v[112:115]
    ds_read_b128 v[180:183], v4 offset:4096
    s_waitcnt lgkmcnt(8)
    v_mfma_f32_16x16x32_bf16 v[116:119], v[188:191], v[64:67], v[116:119]
    s_add_u32 m0, s56, 122880
    s_add_u32 s55, s58, 81920
    ds_read_b128 v[184:187], v4 offset:5120
    buffer_load_dwordx4 v4, s[40:43], s55 offen offset:0 sc1 lds
    v_mfma_f32_16x16x32_bf16 v[120:123], v[192:195], v[64:67], v[120:123]
    ds_read_b128 v[188:191], v4 offset:6144
    v_mfma_f32_16x16x32_bf16 v[104:107], v[196:199], v[68:71], v[104:107]
    ds_read_b128 v[192:195], v4 offset:7168
    v_mfma_f32_16x16x32_bf16 v[108:111], v[200:203], v[68:71], v[108:111]
    ds_read_b128 v[196:199], v4 offset:8192
    s_waitcnt lgkmcnt(8)
    v_mfma_f32_16x16x32_bf16 v[112:115], v[204:207], v[68:71], v[112:115]
    s_add_u32 m0, s56, 122880
    ds_read_b128 v[200:203], v4 offset:9216
    buffer_load_dwordx4 v4, s[40:43], s55 offen offset:1024 sc1 lds
    v_mfma_f32_16x16x32_bf16 v[116:119], v[208:211], v[68:71], v[116:119]
    ds_read_b128 v[204:207], v4 offset:10240
    v_mfma_f32_16x16x32_bf16 v[120:123], v[212:215], v[68:71], v[120:123]
    ds_read_b128 v[208:211], v4 offset:11264
    v_mfma_f32_16x16x32_bf16 v[104:107], v[216:219], v[72:75], v[104:107]
    ds_read_b128 v[212:215], v4 offset:12288
    s_waitcnt lgkmcnt(8)
    v_mfma_f32_16x16x32_bf16 v[108:111], v[168:171], v[72:75], v[108:111]
    s_add_u32 m0, s56, 122880
    ds_read_b128 v[216:219], v4 offset:13312
    buffer_load_dwordx4 v4, s[40:43], s55 offen offset:2048 sc1 lds
    v_mfma_f32_16x16x32_bf16 v[112:115], v[172:175], v[72:75], v[112:115]
    ds_read_b128 v[168:171], v4 offset:14336
    v_mfma_f32_16x16x32_bf16 v[116:119], v[176:179], v[72:75], v[116:119]
    ds_read_b128 v[172:175], v4 offset:15360
    v_mfma_f32_16x16x32_bf16 v[120:123], v[180:183], v[72:75], v[120:123]
    ds_read_b128 v[176:179], v4 offset:16384
    s_waitcnt lgkmcnt(8)
    v_mfma_f32_16x16x32_bf16 v[104:107], v[184:187], v[76:79], v[104:107]
    s_add_u32 m0, s56, 122880
    ds_read_b128 v[180:183], v4 offset:17408
    buffer_load_dwordx4 v4, s[40:43], s55 offen offset:3072 sc1 lds
    v_mfma_f32_16x16x32_bf16 v[108:111], v[188:191], v[76:79], v[108:111]
    ds_read_b128 v[184:187], v4 offset:18432
    v_mfma_f32_16x16x32_bf16 v[112:115], v[192:195], v[76:79], v[112:115]
    ds_read_b128 v[188:191], v4 offset:19456
    v_mfma_f32_16x16x32_bf16 v[116:119], v[196:199], v[76:79], v[116:119]
    s_waitcnt vmcnt(9)
    s_barrier
    ds_read_b128 v[192:195], v4 offset:20480
    s_waitcnt lgkmcnt(8)
    v_mfma_f32_16x16x32_bf16 v[120:123], v[200:203], v[76:79], v[120:123]
    s_add_u32 m0, s56, 126976
    s_add_u32 s55, s55, 4096
    ds_read_b128 v[196:199], v4 offset:21504
    buffer_load_dwordx4 v4, s[40:43], s55 offen offset:0 sc1 lds
    v_mfma_f32_16x16x32_bf16 v[104:107], v[204:207], v[80:83], v[104:107]
    ds_read_b128 v[200:203], v4 offset:22528
    v_mfma_f32_16x16x32_bf16 v[108:111], v[208:211], v[80:83], v[108:111]
    ds_read_b128 v[204:207], v4 offset:23552
    v_mfma_f32_16x16x32_bf16 v[112:115], v[212:215], v[80:83], v[112:115]
    ds_read_b128 v[208:211], v4 offset:24576
    s_waitcnt lgkmcnt(8)
    v_mfma_f32_16x16x32_bf16 v[116:119], v[216:219], v[80:83], v[116:119]
    ds_read_b128 v[212:215], v4 offset:25600
    v_mfma_f32_16x16x32_bf16 v[120:123], v[168:171], v[80:83], v[120:123]
    ds_read_b128 v[216:219], v4 offset:26624
    v_mfma_f32_16x16x32_bf16 v[104:107], v[172:175], v[84:87], v[104:107]
    ds_read_b128 v[168:171], v4 offset:27648
    v_mfma_f32_16x16x32_bf16 v[108:111], v[176:179], v[84:87], v[108:111]
    ds_read_b128 v[172:175], v4 offset:28672
    s_waitcnt lgkmcnt(8)
    v_mfma_f32_16x16x32_bf16 v[112:115], v[180:183], v[84:87], v[112:115]
    ds_read_b128 v[176:179], v4 offset:29696
    v_mfma_f32_16x16x32_bf16 v[116:119], v[184:187], v[84:87], v[116:119]
    ds_read_b128 v[180:183], v4 offset:30720
    v_mfma_f32_16x16x32_bf16 v[120:123], v[188:191], v[84:87], v[120:123]
    ds_read_b128 v[184:187], v4 offset:31744
    v_mfma_f32_16x16x32_bf16 v[104:107], v[192:195], v[88:91], v[104:107]
    ds_read_b128 v[188:191], v4 offset:32768
    s_waitcnt lgkmcnt(8)
    v_mfma_f32_16x16x32_bf16 v[108:111], v[196:199], v[88:91], v[108:111]
    ds_read_b128 v[192:195], v4 offset:33792
    v_mfma_f32_16x16x32_bf16 v[112:115], v[200:203], v[88:91], v[112:115]
    ds_read_b128 v[196:199], v4 offset:34816
    v_mfma_f32_16x16x32_bf16 v[116:119], v[204:207], v[88:91], v[116:119]
    ds_read_b128 v[200:203], v4 offset:35840
    v_mfma_f32_16x16x32_bf16 v[120:123], v[208:211], v[88:91], v[120:123]
    ds_read_b128 v[204:207], v4 offset:36864
    s_waitcnt lgkmcnt(8)
    v_mfma_f32_16x16x32_bf16 v[104:107], v[212:215], v[92:95], v[104:107]
    ds_read_b128 v[208:211], v4 offset:37888
    v_mfma_f32_16x16x32_bf16 v[108:111], v[216:219], v[92:95], v[108:111]
    ds_read_b128 v[212:215], v4 offset:38912
    v_mfma_f32_16x16x32_bf16 v[112:115], v[168:171], v[92:95], v[112:115]
    ds_read_b128 v[216:219], v4 offset:39936
    v_mfma_f32_16x16x32_bf16 v[116:119], v[172:175], v[92:95], v[116:119]
    s_waitcnt vmcnt(5)
    s_barrier
    ds_read_b128 v[168:171], v4 offset:40960
    s_waitcnt lgkmcnt(8)
    v_mfma_f32_16x16x32_bf16 v[120:123], v[176:179], v[92:95], v[120:123]
    ds_read_b128 v[172:175], v4 offset:41984
    v_mfma_f32_16x16x32_bf16 v[104:107], v[180:183], v[96:99], v[104:107]
    ds_read_b128 v[176:179], v4 offset:43008
    v_mfma_f32_16x16x32_bf16 v[108:111], v[184:187], v[96:99], v[108:111]
    ds_read_b128 v[180:183], v4 offset:44032
    v_mfma_f32_16x16x32_bf16 v[112:115], v[188:191], v[96:99], v[112:115]
    ds_read_b128 v[184:187], v4 offset:45056
    s_waitcnt lgkmcnt(8)
    v_mfma_f32_16x16x32_bf16 v[116:119], v[192:195], v[96:99], v[116:119]
    ds_read_b128 v[188:191], v4 offset:46080
    v_mfma_f32_16x16x32_bf16 v[120:123], v[196:199], v[96:99], v[120:123]
    ds_read_b128 v[192:195], v4 offset:47104
    v_mfma_f32_16x16x32_bf16 v[104:107], v[200:203], v[100:103], v[104:107]
    ds_read_b128 v[196:199], v4 offset:48128
    v_mfma_f32_16x16x32_bf16 v[108:111], v[204:207], v[100:103], v[108:111]
    ds_read_b128 v[200:203], v4 offset:49152
    s_waitcnt lgkmcnt(8)
    v_mfma_f32_16x16x32_bf16 v[112:115], v[208:211], v[100:103], v[112:115]
    ds_read_b128 v[204:207], v4 offset:50176
    v_mfma_f32_16x16x32_bf16 v[116:119], v[212:215], v[100:103], v[116:119]
    ds_read_b128 v[208:211], v4 offset:51200
    v_mfma_f32_16x16x32_bf16 v[120:123], v[216:219], v[100:103], v[120:123]
    ds_read_b128 v[212:215], v4 offset:52224
    v_mfma_f32_16x16x32_bf16 v[104:107], v[168:171], v[136:139], v[104:107]
    ds_read_b128 v[216:219], v4 offset:53248
    s_waitcnt lgkmcnt(8)
    v_mfma_f32_16x16x32_bf16 v[108:111], v[172:175], v[136:139], v[108:111]
    ds_read_b128 v[168:171], v4 offset:54272
    v_mfma_f32_16x16x32_bf16 v[112:115], v[176:179], v[136:139], v[112:115]
    ds_read_b128 v[172:175], v4 offset:55296
    v_mfma_f32_16x16x32_bf16 v[116:119], v[180:183], v[136:139], v[116:119]
    ds_read_b128 v[176:179], v4 offset:56320
    v_mfma_f32_16x16x32_bf16 v[120:123], v[184:187], v[136:139], v[120:123]
    ds_read_b128 v[180:183], v4 offset:57344
    s_waitcnt lgkmcnt(8)
    v_mfma_f32_16x16x32_bf16 v[104:107], v[188:191], v[140:143], v[104:107]
    ds_read_b128 v[184:187], v4 offset:58368
    v_mfma_f32_16x16x32_bf16 v[108:111], v[192:195], v[140:143], v[108:111]
    ds_read_b128 v[188:191], v4 offset:59392
    v_mfma_f32_16x16x32_bf16 v[112:115], v[196:199], v[140:143], v[112:115]
    ds_read_b128 v[192:195], v4 offset:60416
    v_mfma_f32_16x16x32_bf16 v[116:119], v[200:203], v[140:143], v[116:119]
    s_waitcnt vmcnt(0)
    s_barrier
    ds_read_b128 v[196:199], v242 offset:0
    s_waitcnt lgkmcnt(8)
    v_mfma_f32_16x16x32_bf16 v[120:123], v[204:207], v[140:143], v[120:123]
    ds_read_b128 v[200:203], v242 offset:1024
    v_mfma_f32_16x16x32_bf16 v[104:107], v[208:211], v[144:147], v[104:107]
    ds_read_b128 v[204:207], v242 offset:2048
    v_mfma_f32_16x16x32_bf16 v[108:111], v[212:215], v[144:147], v[108:111]
    ds_read_b128 v[208:211], v242 offset:3072
    v_mfma_f32_16x16x32_bf16 v[112:115], v[216:219], v[144:147], v[112:115]
    ds_read_b128 v[212:215], v242 offset:4096
    s_waitcnt lgkmcnt(8)
    v_mfma_f32_16x16x32_bf16 v[116:119], v[168:171], v[144:147], v[116:119]
    ds_read_b128 v[216:219], v242 offset:5120
    v_mfma_f32_16x16x32_bf16 v[120:123], v[172:175], v[144:147], v[120:123]
    ds_read_b128 v[168:171], v242 offset:6144
    v_mfma_f32_16x16x32_bf16 v[104:107], v[176:179], v[148:151], v[104:107]
    ds_read_b128 v[172:175], v242 offset:7168
    v_mfma_f32_16x16x32_bf16 v[108:111], v[180:183], v[148:151], v[108:111]
    ds_read_b128 v[176:179], v242 offset:8192
    s_waitcnt lgkmcnt(8)
    v_mfma_f32_16x16x32_bf16 v[112:115], v[184:187], v[148:151], v[112:115]
    ds_read_b128 v[180:183], v242 offset:9216
    v_mfma_f32_16x16x32_bf16 v[116:119], v[188:191], v[148:151], v[116:119]
    ds_read_b128 v[184:187], v242 offset:10240
    v_mfma_f32_16x16x32_bf16 v[120:123], v[192:195], v[148:151], v[120:123]
    ds_read_b128 v[188:191], v242 offset:11264
    v_mfma_f32_16x16x32_bf16 v[104:107], v[196:199], v[152:155], v[104:107]
    ds_read_b128 v[192:195], v242 offset:12288
    s_waitcnt lgkmcnt(8)
    v_mfma_f32_16x16x32_bf16 v[108:111], v[200:203], v[152:155], v[108:111]
    ds_read_b128 v[196:199], v242 offset:13312
    v_mfma_f32_16x16x32_bf16 v[112:115], v[204:207], v[152:155], v[112:115]
    ds_read_b128 v[200:203], v242 offset:14336
    v_mfma_f32_16x16x32_bf16 v[116:119], v[208:211], v[152:155], v[116:119]
    ds_read_b128 v[204:207], v242 offset:15360
    v_mfma_f32_16x16x32_bf16 v[120:123], v[212:215], v[152:155], v[120:123]
    ds_read_b128 v[208:211], v242 offset:16384
    s_waitcnt lgkmcnt(8)
    v_mfma_f32_16x16x32_bf16 v[104:107], v[216:219], v[156:159], v[104:107]
    ds_read_b128 v[212:215], v242 offset:17408
    v_mfma_f32_16x16x32_bf16 v[108:111], v[168:171], v[156:159], v[108:111]
    ds_read_b128 v[216:219], v242 offset:18432
    v_mfma_f32_16x16x32_bf16 v[112:115], v[172:175], v[156:159], v[112:115]
    ds_read_b128 v[168:171], v242 offset:19456
    v_mfma_f32_16x16x32_bf16 v[116:119], v[176:179], v[156:159], v[116:119]
    s_waitcnt lgkmcnt(7)
    v_mfma_f32_16x16x32_bf16 v[120:123], v[180:183], v[156:159], v[120:123]
    v_mfma_f32_16x16x32_bf16 v[104:107], v[184:187], v[160:163], v[104:107]
    v_mfma_f32_16x16x32_bf16 v[108:111], v[188:191], v[160:163], v[108:111]
    v_mfma_f32_16x16x32_bf16 v[112:115], v[192:195], v[160:163], v[112:115]
    s_waitcnt lgkmcnt(3)
    v_mfma_f32_16x16x32_bf16 v[116:119], v[196:199], v[160:163], v[116:119]
    v_mfma_f32_16x16x32_bf16 v[120:123], v[200:203], v[160:163], v[120:123]
    v_mfma_f32_16x16x32_bf16 v[104:107], v[204:207], v[164:167], v[104:107]
    v_mfma_f32_16x16x32_bf16 v[108:111], v[208:211], v[164:167], v[108:111]
    s_waitcnt lgkmcnt(0)
    v_mfma_f32_16x16x32_bf16 v[112:115], v[212:215], v[164:167], v[112:115]
    v_mfma_f32_16x16x32_bf16 v[116:119], v[216:219], v[164:167], v[116:119]
    v_mfma_f32_16x16x32_bf16 v[120:123], v[168:171], v[164:167], v[120:123]
    s_lshl_b32 s63, s52, 6
    s_lshl_b32 s64, s3, 4
    s_add_u32 s63, s63, s64
    s_mul_i32 s63, s63, 1280
    s_add_u32 s63, s63, s53
    v_cvt_pk_bf16_f32 v124, v104, v105
    v_cvt_pk_bf16_f32 v125, v106, v107
    ds_write_b64 v24, v[124:125] offset:0
    v_cvt_pk_bf16_f32 v126, v108, v109
    v_cvt_pk_bf16_f32 v127, v110, v111
    ds_write_b64 v24, v[126:127] offset:32
    v_cvt_pk_bf16_f32 v128, v112, v113
    v_cvt_pk_bf16_f32 v129, v114, v115
    ds_write_b64 v24, v[128:129] offset:64
    v_cvt_pk_bf16_f32 v130, v116, v117
    v_cvt_pk_bf16_f32 v131, v118, v119
    ds_write_b64 v24, v[130:131] offset:96
    v_cvt_pk_bf16_f32 v132, v120, v121
    v_cvt_pk_bf16_f32 v133, v122, v123
    ds_write_b64 v24, v[132:133] offset:128
    s_waitcnt lgkmcnt(0)
    ds_read_b128 v[168:171], v26
    ds_read_b128 v[172:175], v27
    ds_read_b128 v[176:179], v28
    s_waitcnt lgkmcnt(0)
    buffer_store_dwordx4 v[168:171], v29, s[24:27], s63 offen
    buffer_store_dwordx4 v[172:175], v30, s[24:27], s63 offen
    s_mov_b32 exec_hi, 0
    buffer_store_dwordx4 v[176:179], v31, s[24:27], s63 offen
M_end:
    s_endpgm
M_fallback:
    s_mov_b32 exec_lo, 0
    v_mov_b32 v144, 0
    v_mov_b32 v145, 0
    v_mov_b32 v146, 0
    v_mov_b32 v147, 0
    s_mov_b64 exec, -1
    v_mov_b32 v17, 0xff800000
    v_mov_b32 v18, 0xff800000
    s_mov_b32 s63, 0
M_fb1:
    buffer_load_dwordx4 v[148:151], v4, s[28:31], s63 offen sc1
    buffer_load_dwordx2 v[152:153], v5, s[28:31], s63 offen offset:1024 sc1
    s_waitcnt vmcnt(0)
    v_mfma_f32_32x32x16_bf16 v[24:39], v[148:151], v[136:139], 0
    v_mfma_f32_32x32x8_bf16 v[24:39], v[152:153], v[144:145], v[24:39]
    v_mfma_f32_32x32x16_bf16 v[40:55], v[148:151], v[140:143], 0
    v_mfma_f32_32x32x8_bf16 v[40:55], v[152:153], v[146:147], v[40:55]
    s_nop 9
    v_max3_f32 v17, v24, v25, v17
    v_max3_f32 v17, v26, v27, v17
    v_max3_f32 v17, v28, v29, v17
    v_max3_f32 v17, v30, v31, v17
    v_max3_f32 v17, v32, v33, v17
    v_max3_f32 v17, v34, v35, v17
    v_max3_f32 v17, v36, v37, v17
    v_max3_f32 v17, v38, v39, v17
    v_max3_f32 v18, v40, v41, v18
    v_max3_f32 v18, v42, v43, v18
    v_max3_f32 v18, v44, v45, v18
    v_max3_f32 v18, v46, v47, v18
    v_max3_f32 v18, v48, v49, v18
    v_max3_f32 v18, v50, v51, v18
    v_max3_f32 v18, v52, v53, v18
    v_max3_f32 v18, v54, v55, v18
    s_add_u32 s63, s63, 3072
    s_cmp_lt_u32 s63, 196608
    s_cbranch_scc1 M_fb1
    v_mov_b32 v19, v17
    s_nop 1
    v_permlane32_swap_b32 v17, v19
    v_max_f32 v17, v17, v19
    v_sub_f32 v20, 0, v17
    v_and_b32 v21, 0xffff0000, v20
    v_sub_f32 v20, v20, v21
    v_and_b32 v22, 0xffff0000, v20
    v_sub_f32 v20, v20, v22
    v_lshrrev_b32 v21, 16, v21
    s_mov_b32 exec_lo, 0
    v_or_b32 v144, v21, v22
    v_lshrrev_b32 v145, 16, v20
    s_mov_b64 exec, -1
    v_mov_b32 v19, v18
    s_nop 1
    v_permlane32_swap_b32 v18, v19
    v_max_f32 v18, v18, v19
    v_sub_f32 v20, 0, v18
    v_and_b32 v21, 0xffff0000, v20
    v_sub_f32 v20, v20, v21
    v_and_b32 v22, 0xffff0000, v20
    v_sub_f32 v20, v20, v22
    v_lshrrev_b32 v21, 16, v21
    s_mov_b32 exec_lo, 0
    v_or_b32 v146, v21, v22
    v_lshrrev_b32 v147, 16, v20
    s_mov_b64 exec, -1
    v_mov_b32 v72, 0
    v_mov_b32 v73, 0
    v_mov_b32 v74, 0
    v_mov_b32 v75, 0
    v_mov_b32 v76, 0
    v_mov_b32 v77, 0
    v_mov_b32 v78, 0
    v_mov_b32 v79, 0
    v_mov_b32 v80, 0
    v_mov_b32 v81, 0
    v_mov_b32 v82, 0
    v_mov_b32 v83, 0
    v_mov_b32 v84, 0
    v_mov_b32 v85, 0
    v_mov_b32 v86, 0
    v_mov_b32 v87, 0
    v_mov_b32 v88, 0
    v_mov_b32 v89, 0
    v_mov_b32 v90, 0
    v_mov_b32 v91, 0
    v_mov_b32 v92, 0
    v_mov_b32 v93, 0
    v_mov_b32 v94, 0
    v_mov_b32 v95, 0
    v_mov_b32 v96, 0
    v_mov_b32 v97, 0
    v_mov_b32 v98, 0
    v_mov_b32 v99, 0
    v_mov_b32 v100, 0
    v_mov_b32 v101, 0
    v_mov_b32 v102, 0
    v_mov_b32 v103, 0
    v_and_b32 v8, 0x7fff, v8
    s_mov_b32 s63, 193536
    s_mov_b32 s64, 0
M_fb2:
    buffer_load_dwordx4 v[148:151], v4, s[28:31], s63 offen sc1
    buffer_load_dwordx2 v[152:153], v5, s[28:31], s63 offen offset:1024 sc1
    buffer_load_dwordx4 v[164:167], v8, s[28:31], s64 offen offset:1536 sc1
    buffer_load_dwordx4 v[168:171], v8, s[28:31], s64 offen offset:2240 sc1
    s_waitcnt vmcnt(0)
    v_mfma_f32_32x32x16_bf16 v[24:39], v[148:151], v[136:139], 0
    v_mfma_f32_32x32x8_bf16 v[24:39], v[152:153], v[144:145], v[24:39]
    v_mfma_f32_32x32x16_bf16 v[40:55], v[148:151], v[140:143], 0
    v_mfma_f32_32x32x8_bf16 v[40:55], v[152:153], v[146:147], v[40:55]
    s_nop 9
    v_exp_f32 v24, v24
    v_exp_f32 v25, v25
    v_exp_f32 v26, v26
    v_exp_f32 v27, v27
    v_exp_f32 v28, v28
    v_exp_f32 v29, v29
    v_exp_f32 v30, v30
    v_exp_f32 v31, v31
    v_exp_f32 v32, v32
    v_exp_f32 v33, v33
    v_exp_f32 v34, v34
    v_exp_f32 v35, v35
    v_exp_f32 v36, v36
    v_exp_f32 v37, v37
    v_exp_f32 v38, v38
    v_exp_f32 v39, v39
    v_cvt_pk_bf16_f32 v56, v24, v25
    v_cvt_pk_bf16_f32 v57, v26, v27
    v_cvt_pk_bf16_f32 v58, v28, v29
    v_cvt_pk_bf16_f32 v59, v30, v31
    v_cvt_pk_bf16_f32 v60, v32, v33
    v_cvt_pk_bf16_f32 v61, v34, v35
    v_cvt_pk_bf16_f32 v62, v36, v37
    v_cvt_pk_bf16_f32 v63, v38, v39
    v_mfma_f32_32x32x16_bf16 v[72:87], v[164:167], v[56:59], v[72:87]
    s_nop 0
    v_mfma_f32_32x32x16_bf16 v[72:87], v[168:171], v[60:63], v[72:87]
    v_exp_f32 v40, v40
    v_exp_f32 v41, v41
    v_exp_f32 v42, v42
    v_exp_f32 v43, v43
    v_exp_f32 v44, v44
    v_exp_f32 v45, v45
    v_exp_f32 v46, v46
    v_exp_f32 v47, v47
    v_exp_f32 v48, v48
    v_exp_f32 v49, v49
    v_exp_f32 v50, v50
    v_exp_f32 v51, v51
    v_exp_f32 v52, v52
    v_exp_f32 v53, v53
    v_exp_f32 v54, v54
    v_exp_f32 v55, v55
    v_cvt_pk_bf16_f32 v64, v40, v41
    v_cvt_pk_bf16_f32 v65, v42, v43
    v_cvt_pk_bf16_f32 v66, v44, v45
    v_cvt_pk_bf16_f32 v67, v46, v47
    v_cvt_pk_bf16_f32 v68, v48, v49
    v_cvt_pk_bf16_f32 v69, v50, v51
    v_cvt_pk_bf16_f32 v70, v52, v53
    v_cvt_pk_bf16_f32 v71, v54, v55
    v_mfma_f32_32x32x16_bf16 v[88:103], v[164:167], v[64:67], v[88:103]
    s_nop 0
    v_mfma_f32_32x32x16_bf16 v[88:103], v[168:171], v[68:71], v[88:103]
    s_mov_b32 s63, s64
    s_add_u32 s64, s64, 3072
    s_cmp_lt_u32 s64, 196608
    s_cbranch_scc1 M_fb2
    s_nop 15
    v_mov_b32 v16, v80
    v_mov_b32 v84, v80
    s_nop 1
    v_permlane32_swap_b32 v16, v84
    v_mov_b32 v16, v96
    v_mov_b32 v100, v96
    s_nop 1
    v_permlane32_swap_b32 v16, v100
    s_branch M_epi
CODE_END:
.section .rodata,"a"
.p2align 6
.amdhsa_kernel gated_mix__grouped_kv_mqa__mixer_gmlp__prompt_kernel
  .amdhsa_next_free_vgpr 424
  .amdhsa_next_free_sgpr 102
  .amdhsa_accum_offset 256
  .amdhsa_group_segment_fixed_size 0
  .amdhsa_kernarg_size 112
  .amdhsa_user_sgpr_count 2
  .amdhsa_user_sgpr_kernarg_segment_ptr 1
  .amdhsa_system_sgpr_workgroup_id_x 1
.end_amdhsa_kernel
```
